```python
import torch

def _softmax(x, axis=-1):
    return torch.softmax(x, dim=axis)
def _gelu(x):
    return torch.nn.functional.gelu(x, approximate="tanh")
def _silu(x):
    return torch.nn.functional.silu(x)
def _sigmoid(x):
    return torch.sigmoid(x)
def _layernorm(x, axis=-1, eps=1e-5):
    m = x.mean(dim=axis, keepdim=True)
    v = x.var(dim=axis, keepdim=True, unbiased=False)
    return (x - m) / torch.sqrt(v + eps)
def _scatter_add(tgt, idx, src, axis=0):
    return tgt.clone().index_add_(axis, idx, src)
def _segment_sum(src, seg, n):
    out = torch.zeros((n,) + src.shape[1:], dtype=src.dtype)
    return out.index_add_(0, seg, src)
def _pad(x, pw):
    flat = tuple(v for pair in reversed(pw) for v in pair)
    return torch.nn.functional.pad(x, flat)

kernel_name = 'recurrent_scan__mha_block__geglu_ffn__prompt'

def setup_inputs():

    _w = (lambda a: (lambda t: t.to(torch.bfloat16) if t.is_floating_point() else t)(torch.as_tensor(a)))
    def _A_setup():
        B, S, D, H = 1, 2048, 576, 32
        return {
            "x": _w((lambda *s: torch.randn(*s, dtype=torch.bfloat16) * 0.05)(B, S, D)),
            "wqkv": _w((lambda *s: torch.randn(*s, dtype=torch.bfloat16) * 0.05)(D, 3 * D)),
            "wo": _w((lambda *s: torch.randn(*s, dtype=torch.bfloat16) * 0.05)(D, D)),
        }
    _A_in = _A_setup()

    def _B_setup():
        B, S, D, F = 1, 2048, 576, 4608
        return {
            "x": _w((lambda *s: torch.randn(*s, dtype=torch.bfloat16) * 0.05)(B, S, D)),
            "w_gate": _w((lambda *s: torch.randn(*s, dtype=torch.bfloat16) * 0.05)(D, F)),
            "w_up": _w((lambda *s: torch.randn(*s, dtype=torch.bfloat16) * 0.05)(D, F)),
            "w_down": _w((lambda *s: torch.randn(*s, dtype=torch.bfloat16) * 0.05)(F, D)),
        }
    _B_in = _B_setup()

    return {
        "A_x": _A_in["x"],
        "A_wqkv": _A_in["wqkv"],
        "A_wo": _A_in["wo"],
        "B_x": _B_in["x"],
        "B_w_gate": _B_in["w_gate"],
        "B_w_up": _B_in["w_up"],
        "B_w_down": _B_in["w_down"],
    }

def reference(A_x, A_wqkv, A_wo, B_x, B_w_gate, B_w_up, B_w_down):
    def _A_ref(x, wqkv, wo):
        B, S, D = x.shape
        H = 32
        Dh = D // H
        qkv = (lambda x, *d: x.permute(*d))((x @ wqkv).reshape(B, S, 3, H, Dh), 2, 0, 3, 1, 4)
        q, k, v = qkv[0], qkv[1], qkv[2]
        scores = torch.einsum("bhqd,bhkd->bhqk", q, k) * (Dh ** -0.5)
        p = _softmax(scores, axis=-1)
        o = torch.einsum("bhqk,bhkd->bhqd", p, v)
        return (lambda x, *d: x.permute(*d))(o, 0, 2, 1, 3).reshape(B, S, D) @ wo

    def _B_ref(x, w_gate, w_up, w_down):
        return (_gelu(x @ w_gate) * (x @ w_up)) @ w_down

    x = A_x
    xn = _layernorm(x, axis=-1)
    s = _A_ref(xn, A_wqkv, A_wo)
    g = _silu(_B_ref(xn, B_w_gate, B_w_up, B_w_down))
    return x + s * g
```

```asm
; @launch kernel=gemm1_kernel grid=(256,1,1) block=(512,1,1) lds=147520
; @launch kernel=attn_down_kernel grid=(256,1,1) block=(768,1,1) lds=155648
.amdgcn_target "amdgcn-amd-amdhsa--gfx950"
.text
.globl gemm1_kernel
.p2align 8
.type gemm1_kernel,@function
gemm1_kernel:
    s_cmp_ge_u32 s2, 256
    s_cbranch_scc1 LB_end
    s_load_dwordx4 s[36:39], s[0:1], 0
    s_load_dwordx4 s[4:7], s[0:1], 32
    s_load_dwordx2 s[8:9], s[0:1], 48
    s_load_dwordx4 s[92:95], s[0:1], 64
    v_lshrrev_b32 v1, 6, v0
    v_and_b32 v0, 63, v0
    v_readfirstlane_b32 s3, v1
    v_lshlrev_b32 v1, 4, v0
    s_cmp_lt_u32 s3, 4
    s_cbranch_scc1 LB_ln
    s_and_b32 s15, s3, 3
    s_lshl_b32 s57, s15, 6
    s_getpc_b64 s[44:45]
LT_M:
    v_add_u32 v96, s57, v0
    v_lshlrev_b32 v96, 7, v96
    v_min_u32 v96, LB_end-LT_M, v96
    global_load_dword v110, v96, s[44:45]
    s_lshr_b32 s46, s2, 3
    s_and_b32 s47, s2, 7
    v_add_u32 v34, 0, v0
    v_mul_u32_u24 v35, 0x97c, v34
    v_lshrrev_b32 v35, 16, v35
    v_mul_u32_u24 v36, 27, v35
    v_sub_u32 v36, v34, v36
    v_mul_u32_u24 v37, 0x1c72, v36
    v_lshrrev_b32 v37, 16, v37
    v_mul_u32_u24 v37, 1008, v37
    v_lshl_add_u32 v37, v36, 4, v37
    v_mul_u32_u24 v38, 3456, v35
    v_add_u32 v40, v37, v38
    v_mul_u32_u24 v38, 688, v35
    v_lshl_add_u32 v42, v36, 4, v38
    v_add_u32 v34, 64, v0
    v_mul_u32_u24 v35, 0x97c, v34
    v_lshrrev_b32 v35, 16, v35
    v_mul_u32_u24 v36, 27, v35
    v_sub_u32 v36, v34, v36
    v_mul_u32_u24 v37, 0x1c72, v36
    v_lshrrev_b32 v37, 16, v37
    v_mul_u32_u24 v37, 1008, v37
    v_lshl_add_u32 v37, v36, 4, v37
    v_mul_u32_u24 v38, 3456, v35
    v_add_u32 v41, v37, v38
    v_mul_u32_u24 v38, 688, v35
    v_lshl_add_u32 v43, v36, 4, v38
    v_bfe_u32 v35, v0, 3, 2
    v_and_b32 v36, 7, v0
    v_mul_u32_u24 v37, 9216, v35
    v_lshl_add_u32 v44, v36, 4, v37
    v_mul_u32_u24 v37, 688, v35
    v_lshl_add_u32 v45, v36, 4, v37
    v_lshrrev_b32 v37, 5, v0
    v_lshl_add_u32 v45, v37, 7, v45
    s_lshl_b32 s96, s46, 2
    s_add_u32 s96, s96, s15
    s_lshl_b32 s96, s96, 2
    s_mul_i32 s97, s96, 3456
    s_mul_i32 s57, s47, 144
    s_add_u32 s97, s97, s57
    s_mul_i32 s96, s96, 9216
    s_lshl_b32 s57, s47, 7
    s_add_u32 s96, s96, s57
    s_add_u32 s96, s96, 8192
    s_waitcnt lgkmcnt(0)
    s_mov_b32 s32, s38
    s_mov_b32 s33, s39
    s_mov_b32 s34, 1990656
    s_mov_b32 s35, 0x20000
    s_mov_b32 s20, s4
    s_mov_b32 s21, s5
    s_mov_b32 s22, 5308416
    s_mov_b32 s23, 0x20000
    s_mov_b32 s24, s6
    s_mov_b32 s25, s7
    s_mov_b32 s26, 5308416
    s_mov_b32 s27, 0x20000
    buffer_load_dwordx4 v[48:51], v40, s[32:35], s97 offen
    s_mov_b32 exec_hi, 0xfff
    buffer_load_dwordx4 v[52:55], v41, s[32:35], s97 offen
    s_mov_b32 exec_hi, 0
    buffer_load_dwordx4 v[56:59], v44, s[20:23], s96 offen
    s_mov_b32 exec_hi, -1
    s_mov_b32 exec_lo, 0
    buffer_load_dwordx4 v[56:59], v44, s[24:27], s96 offen
    s_mov_b64 exec, -1
    s_cmp_ge_u32 s2, 32
    s_cbranch_scc1 LB_j1
    s_add_u32 s97, s97, 1769472
    s_add_u32 s96, s96, 4718592
    buffer_load_dwordx4 v[60:63], v40, s[32:35], s97 offen
    s_mov_b32 exec_hi, 0xfff
    buffer_load_dwordx4 v[64:67], v41, s[32:35], s97 offen
    s_mov_b32 exec_hi, 0
    buffer_load_dwordx4 v[68:71], v44, s[20:23], s96 offen
    s_mov_b32 exec_hi, -1
    s_mov_b32 exec_lo, 0
    buffer_load_dwordx4 v[68:71], v44, s[24:27], s96 offen
    s_mov_b64 exec, -1
LB_j1:
    s_cmp_eq_u32 s3, 7
    s_cbranch_scc0 LB_nn
    s_memrealtime s[40:41]
    s_mov_b32 s32, s92
    s_mov_b32 s33, s93
    s_mov_b32 s34, 256
    s_mov_b32 s35, 0x20000
    s_lshr_b32 s57, s2, 5
    s_lshl_b32 s57, s57, 5
    s_waitcnt lgkmcnt(0)
    s_or_b32 s40, s40, 0x80000000
    v_mov_b32 v100, s40
    v_mov_b32 v101, 0
    s_mov_b64 exec, 1
    buffer_atomic_cmpswap v[100:101], off, s[32:35], s57 sc0
    s_mov_b64 exec, -1
LB_nn:
    s_barrier
    s_mov_b32 s16, s94
    s_mov_b32 s17, s95
    s_mov_b32 s18, 48848896
    s_mov_b32 s19, 0x20000
    s_lshl_b32 s12, s47, 2
    s_and_b32 s13, s46, 3
    s_add_u32 s12, s12, s13
    s_lshr_b32 s57, s2, 5
    s_mul_i32 s57, s57, 72
    s_mul_i32 s13, s15, 18
    s_add_u32 s57, s57, s13
    v_add_u32 v30, s57, v0
    v_mul_u32_u24 v30, 9216, v30
    s_lshl_b32 s61, s12, 7
    s_mov_b64 exec, 262143
    buffer_load_dword v111, v30, s[20:23], s61 offen
    buffer_load_dword v111, v30, s[24:27], s61 offen
    s_mov_b64 exec, -1
    s_lshl_b32 s57, s47, 2
    s_add_u32 s57, s57, s15
    s_mul_i32 s57, s57, 36
    s_add_u32 s57, s57, s46
    s_mul_i32 s57, s57, 3072
    s_add_u32 s57, s57, 2359296
    buffer_load_dword v110, off, s[16:19], s57 sc1
    v_lshrrev_b32 v96, 3, v0
    v_and_b32 v97, 7, v0
    v_and_b32 v98, 2, v96
    v_xor_b32 v97, v97, v98
    v_mul_u32_u24 v96, 9216, v96
    v_lshl_add_u32 v2, v97, 4, v96
    v_xor_b32 v3, 64, v2
    s_mul_i32 s57, s15, 2752
    s_add_u32 s57, s57, 98304
    v_add_u32 v42, s57, v42
    v_add_u32 v43, s57, v43
    v_add_u32 v45, s57, v45
    v_and_b32 v34, 31, v0
    v_lshrrev_b32 v35, 5, v0
    v_mul_u32_u24 v35, 5504, v35
    v_add_u32 v35, 98304, v35
    v_and_b32 v36, 15, v0
    v_lshl_add_u32 v36, v36, 1, v35
    v_bfe_u32 v37, v0, 4, 1
    s_lshl_b32 s57, s15, 5
    s_add_u32 s57, s57, 432
    v_lshl_add_u32 v38, v37, 7, v36
    v_add_u32 v38, s57, v38
    s_mul_i32 s57, s15, 36
    v_mul_u32_u24 v37, 144, v37
    v_add3_u32 v39, v36, v37, s57
    v_lshlrev_b32 v34, 1, v34
    v_add_u32 v46, 288, v34
    v_mov_b32 v47, 0
    v_cmp_gt_u32 vcc, 36, v34
    s_nop 1
    v_cndmask_b32 v47, v47, -1, vcc
    v_lshrrev_b32 v36, 2, v34
    v_subrev_u32 v37, 16, v34
    v_cmp_eq_u32 vcc, 12, v36
    s_nop 1
    v_cndmask_b32 v46, v46, v37, vcc
    v_cndmask_b32 v47, v47, -1, vcc
    v_add_u32 v37, 124, v34
    v_cmp_eq_u32 vcc, 13, v36
    s_nop 1
    v_cndmask_b32 v46, v46, v37, vcc
    v_cndmask_b32 v47, v47, -1, vcc
    v_add3_u32 v46, v46, v35, s57
    s_lshl_b32 s96, s47, 2
    s_add_u32 s96, s96, s15
    s_mul_i32 s96, s96, 36
    s_add_u32 s96, s96, s46
    s_mul_i32 s96, s96, 3072
    s_add_u32 s96, s96, 2359296
    s_cmp_eq_u32 s3, 7
    s_cbranch_scc1 LB_w7
    s_waitcnt vmcnt(3)
LB_w7:
    s_waitcnt vmcnt(4)
    ds_write_b128 v42, v[48:51] offset:0
    s_mov_b32 exec_hi, 0xfff
    ds_write_b128 v43, v[52:55] offset:0
    s_mov_b64 exec, -1
    ds_write_b128 v45, v[56:59] offset:432
    s_cmp_ge_u32 s2, 32
    s_cbranch_scc1 LB_j2
    ds_write_b128 v42, v[60:63] offset:11008
    s_mov_b32 exec_hi, 0xfff
    ds_write_b128 v43, v[64:67] offset:11008
    s_mov_b64 exec, -1
    ds_write_b128 v45, v[68:71] offset:11440
LB_j2:
    v_mov_b32 v101, 0
    v_mov_b32 v102, 147456
    ds_write_b32 v102, v101
    s_waitcnt lgkmcnt(0)
    s_barrier
    s_cmp_eq_u32 s3, 7
    s_cbranch_scc0 LB_nn2
    s_waitcnt vmcnt(3)
    v_readfirstlane_b32 s41, v100
    s_nop 0
    s_cmp_eq_u32 s41, 0
    s_cselect_b32 s40, s40, s41
    v_mov_b32 v100, s40
    ds_write_b32 v102, v100
    s_waitcnt lgkmcnt(0)
LB_nn2:
    ds_read_u16 v48, v38 offset:0
    ds_read_u16 v49, v38 offset:688
    ds_read_u16 v50, v38 offset:1376
    ds_read_u16 v51, v38 offset:2064
    ds_read_u16 v52, v38 offset:2752
    ds_read_u16 v53, v38 offset:3440
    ds_read_u16 v54, v38 offset:4128
    ds_read_u16 v55, v38 offset:4816
    ds_read_u16 v56, v39 offset:0
    ds_read_u16 v57, v39 offset:688
    ds_read_u16 v58, v39 offset:1376
    ds_read_u16 v59, v39 offset:2064
    ds_read_u16 v60, v39 offset:2752
    ds_read_u16 v61, v39 offset:3440
    ds_read_u16 v62, v39 offset:4128
    ds_read_u16 v63, v39 offset:4816
    ds_read_u16 v64, v46 offset:0
    ds_read_u16 v65, v46 offset:688
    ds_read_u16 v66, v46 offset:1376
    ds_read_u16 v67, v46 offset:2064
    ds_read_u16 v68, v46 offset:2752
    ds_read_u16 v69, v46 offset:3440
    ds_read_u16 v70, v46 offset:4128
    ds_read_u16 v71, v46 offset:4816
    s_waitcnt lgkmcnt(15)
    v_lshl_or_b32 v48, v49, 16, v48
    v_lshl_or_b32 v49, v51, 16, v50
    v_lshl_or_b32 v50, v53, 16, v52
    v_lshl_or_b32 v51, v55, 16, v54
    buffer_store_dwordx4 v[48:51], v1, s[16:19], s96 offen offset:0 sc1
    s_waitcnt lgkmcnt(8)
    v_lshl_or_b32 v56, v57, 16, v56
    v_lshl_or_b32 v57, v59, 16, v58
    v_lshl_or_b32 v58, v61, 16, v60
    v_lshl_or_b32 v59, v63, 16, v62
    buffer_store_dwordx4 v[56:59], v1, s[16:19], s96 offen offset:1024 sc1
    s_waitcnt lgkmcnt(0)
    v_lshl_or_b32 v64, v65, 16, v64
    v_and_b32 v64, v47, v64
    v_lshl_or_b32 v65, v67, 16, v66
    v_and_b32 v65, v47, v65
    v_lshl_or_b32 v66, v69, 16, v68
    v_and_b32 v66, v47, v66
    v_lshl_or_b32 v67, v71, 16, v70
    v_and_b32 v67, v47, v67
    buffer_store_dwordx4 v[64:67], v1, s[16:19], s96 offen offset:2048 sc1
    s_cmp_ge_u32 s2, 32
    s_cbranch_scc1 LB_j3
    s_add_u32 s96, s96, 98304
    s_nop 1
    ds_read_u16 v48, v38 offset:11008
    ds_read_u16 v49, v38 offset:11696
    ds_read_u16 v50, v38 offset:12384
    ds_read_u16 v51, v38 offset:13072
    ds_read_u16 v52, v38 offset:13760
    ds_read_u16 v53, v38 offset:14448
    ds_read_u16 v54, v38 offset:15136
    ds_read_u16 v55, v38 offset:15824
    ds_read_u16 v56, v39 offset:11008
    ds_read_u16 v57, v39 offset:11696
    ds_read_u16 v58, v39 offset:12384
    ds_read_u16 v59, v39 offset:13072
    ds_read_u16 v60, v39 offset:13760
    ds_read_u16 v61, v39 offset:14448
    ds_read_u16 v62, v39 offset:15136
    ds_read_u16 v63, v39 offset:15824
    ds_read_u16 v64, v46 offset:11008
    ds_read_u16 v65, v46 offset:11696
    ds_read_u16 v66, v46 offset:12384
    ds_read_u16 v67, v46 offset:13072
    ds_read_u16 v68, v46 offset:13760
    ds_read_u16 v69, v46 offset:14448
    ds_read_u16 v70, v46 offset:15136
    ds_read_u16 v71, v46 offset:15824
    s_waitcnt lgkmcnt(15)
    v_lshl_or_b32 v48, v49, 16, v48
    v_lshl_or_b32 v49, v51, 16, v50
    v_lshl_or_b32 v50, v53, 16, v52
    v_lshl_or_b32 v51, v55, 16, v54
    buffer_store_dwordx4 v[48:51], v1, s[16:19], s96 offen offset:0 sc1
    s_waitcnt lgkmcnt(8)
    v_lshl_or_b32 v56, v57, 16, v56
    v_lshl_or_b32 v57, v59, 16, v58
    v_lshl_or_b32 v58, v61, 16, v60
    v_lshl_or_b32 v59, v63, 16, v62
    buffer_store_dwordx4 v[56:59], v1, s[16:19], s96 offen offset:1024 sc1
    s_waitcnt lgkmcnt(0)
    v_lshl_or_b32 v64, v65, 16, v64
    v_and_b32 v64, v47, v64
    v_lshl_or_b32 v65, v67, 16, v66
    v_and_b32 v65, v47, v65
    v_lshl_or_b32 v66, v69, 16, v68
    v_and_b32 v66, v47, v66
    v_lshl_or_b32 v67, v71, 16, v70
    v_and_b32 v67, v47, v67
    buffer_store_dwordx4 v[64:67], v1, s[16:19], s96 offen offset:2048 sc1
LB_j3:
    s_branch LB_common
LB_ln:
    s_lshl_b32 s46, s2, 3
    s_lshl_b32 s47, s3, 1
    s_add_u32 s46, s46, s47
    v_lshrrev_b32 v34, 5, v0
    v_add_u32 v37, s47, v34
    v_add_u32 v34, s46, v34
    v_and_b32 v35, 31, v0
    v_mul_u32_u24 v36, 1152, v34
    v_lshl_add_u32 v36, v35, 2, v36
    s_waitcnt lgkmcnt(0)
    s_mov_b32 s32, s36
    s_mov_b32 s33, s37
    s_mov_b32 s34, 2359296
    s_mov_b32 s35, 0x20000
    buffer_load_dword v42, v36, s[32:35], 0 offen offset:0
    buffer_load_dword v43, v36, s[32:35], 0 offen offset:128
    buffer_load_dword v44, v36, s[32:35], 0 offen offset:256
    buffer_load_dword v45, v36, s[32:35], 0 offen offset:384
    buffer_load_dword v46, v36, s[32:35], 0 offen offset:512
    buffer_load_dword v47, v36, s[32:35], 0 offen offset:640
    buffer_load_dword v48, v36, s[32:35], 0 offen offset:768
    buffer_load_dword v49, v36, s[32:35], 0 offen offset:896
    buffer_load_dword v50, v36, s[32:35], 0 offen offset:1024
    s_mov_b32 s16, s94
    s_mov_b32 s17, s95
    s_mov_b32 s18, 48848896
    s_mov_b32 s19, 0x20000
    s_lshr_b32 s46, s2, 2
    s_mul_i32 s46, s46, 36864
    s_mul_i32 s47, s3, 12288
    s_add_u32 s46, s46, s47
    s_lshl_b32 s47, s2, 7
    s_add_u32 s47, s47, 36995072
    s_cmp_eq_u32 s3, 3
    s_cselect_b32 s46, s47, s46
    buffer_load_dword v110, off, s[16:19], s46 sc1
    s_barrier
    s_mov_b32 s20, s4
    s_mov_b32 s21, s5
    s_mov_b32 s22, 5308416
    s_mov_b32 s23, 0x20000
    s_mov_b32 s24, s6
    s_mov_b32 s25, s7
    s_mov_b32 s26, 5308416
    s_mov_b32 s27, 0x20000
    v_lshrrev_b32 v96, 3, v0
    v_and_b32 v97, 7, v0
    v_and_b32 v98, 2, v96
    v_xor_b32 v97, v97, v98
    v_mul_u32_u24 v96, 9216, v96
    v_lshl_add_u32 v2, v97, 4, v96
    v_xor_b32 v3, 64, v2
    v_mov_b32 v30, 0
    v_lshrrev_b32 v38, 2, v35
    v_lshlrev_b32 v37, 4, v37
    v_lshl_add_u32 v37, v38, 7, v37
    v_and_b32 v38, 3, v35
    v_lshl_add_u32 v37, v38, 2, v37
    v_add_u32 v37, 120320, v37
    s_waitcnt vmcnt(9)
    v_lshlrev_b32 v52, 16, v42
    v_and_b32 v53, 0xffff0000, v42
    v_add_f32 v38, v52, v53
    s_waitcnt vmcnt(8)
    v_lshlrev_b32 v54, 16, v43
    v_and_b32 v55, 0xffff0000, v43
    v_add_f32 v38, v38, v54
    v_add_f32 v38, v38, v55
    s_waitcnt vmcnt(7)
    v_lshlrev_b32 v56, 16, v44
    v_and_b32 v57, 0xffff0000, v44
    v_add_f32 v38, v38, v56
    v_add_f32 v38, v38, v57
    s_waitcnt vmcnt(6)
    v_lshlrev_b32 v58, 16, v45
    v_and_b32 v59, 0xffff0000, v45
    v_add_f32 v38, v38, v58
    v_add_f32 v38, v38, v59
    s_waitcnt vmcnt(5)
    v_lshlrev_b32 v60, 16, v46
    v_and_b32 v61, 0xffff0000, v46
    v_add_f32 v38, v38, v60
    v_add_f32 v38, v38, v61
    s_waitcnt vmcnt(4)
    v_lshlrev_b32 v62, 16, v47
    v_and_b32 v63, 0xffff0000, v47
    v_add_f32 v38, v38, v62
    v_add_f32 v38, v38, v63
    s_waitcnt vmcnt(3)
    v_lshlrev_b32 v64, 16, v48
    v_and_b32 v65, 0xffff0000, v48
    v_add_f32 v38, v38, v64
    v_add_f32 v38, v38, v65
    s_waitcnt vmcnt(2)
    v_lshlrev_b32 v66, 16, v49
    v_and_b32 v67, 0xffff0000, v49
    v_add_f32 v38, v38, v66
    v_add_f32 v38, v38, v67
    s_waitcnt vmcnt(1)
    v_lshlrev_b32 v68, 16, v50
    v_and_b32 v69, 0xffff0000, v50
    v_add_f32 v38, v38, v68
    v_add_f32 v38, v38, v69
    s_nop 1
    v_add_f32_dpp v38, v38, v38 row_ror:8 row_mask:0xf bank_mask:0xf
    s_nop 1
    v_add_f32_dpp v38, v38, v38 row_ror:4 row_mask:0xf bank_mask:0xf
    s_nop 1
    v_add_f32_dpp v38, v38, v38 row_ror:2 row_mask:0xf bank_mask:0xf
    s_nop 1
    v_add_f32_dpp v38, v38, v38 row_ror:1 row_mask:0xf bank_mask:0xf
    v_mov_b32 v39, v38
    s_nop 1
    v_permlane16_swap_b32 v38, v39
    v_add_f32 v38, v38, v39
    v_mul_f32 v38, 0x3ae38e39, v38
    v_sub_f32 v40, v52, v38
    v_mul_f32 v39, v40, v40
    v_sub_f32 v40, v53, v38
    v_fmac_f32 v39, v40, v40
    v_sub_f32 v40, v54, v38
    v_fmac_f32 v39, v40, v40
    v_sub_f32 v40, v55, v38
    v_fmac_f32 v39, v40, v40
    v_sub_f32 v40, v56, v38
    v_fmac_f32 v39, v40, v40
    v_sub_f32 v40, v57, v38
    v_fmac_f32 v39, v40, v40
    v_sub_f32 v40, v58, v38
    v_fmac_f32 v39, v40, v40
    v_sub_f32 v40, v59, v38
    v_fmac_f32 v39, v40, v40
    v_sub_f32 v40, v60, v38
    v_fmac_f32 v39, v40, v40
    v_sub_f32 v40, v61, v38
    v_fmac_f32 v39, v40, v40
    v_sub_f32 v40, v62, v38
    v_fmac_f32 v39, v40, v40
    v_sub_f32 v40, v63, v38
    v_fmac_f32 v39, v40, v40
    v_sub_f32 v40, v64, v38
    v_fmac_f32 v39, v40, v40
    v_sub_f32 v40, v65, v38
    v_fmac_f32 v39, v40, v40
    v_sub_f32 v40, v66, v38
    v_fmac_f32 v39, v40, v40
    v_sub_f32 v40, v67, v38
    v_fmac_f32 v39, v40, v40
    v_sub_f32 v40, v68, v38
    v_fmac_f32 v39, v40, v40
    v_sub_f32 v40, v69, v38
    v_fmac_f32 v39, v40, v40
    s_nop 1
    v_add_f32_dpp v39, v39, v39 row_ror:8 row_mask:0xf bank_mask:0xf
    s_nop 1
    v_add_f32_dpp v39, v39, v39 row_ror:4 row_mask:0xf bank_mask:0xf
    s_nop 1
    v_add_f32_dpp v39, v39, v39 row_ror:2 row_mask:0xf bank_mask:0xf
    s_nop 1
    v_add_f32_dpp v39, v39, v39 row_ror:1 row_mask:0xf bank_mask:0xf
    v_mov_b32 v40, v39
    s_nop 1
    v_permlane16_swap_b32 v39, v40
    v_add_f32 v39, v39, v40
    v_mul_f32 v39, 0x3ae38e39, v39
    v_cvt_pk_bf16_f32 v38, v38, v38
    v_and_b32 v38, 0xffff0000, v38
    v_cvt_pk_bf16_f32 v39, v39, v39
    v_and_b32 v39, 0xffff0000, v39
    v_add_f32 v39, 0x3727c5ac, v39
    v_cvt_pk_bf16_f32 v39, v39, v39
    v_and_b32 v39, 0xffff0000, v39
    v_sqrt_f32 v39, v39
    s_nop 0
    v_cvt_pk_bf16_f32 v39, v39, v39
    v_and_b32 v39, 0xffff0000, v39
    v_rcp_f32 v39, v39
    v_sub_f32 v52, v52, v38
    v_sub_f32 v53, v53, v38
    v_cvt_pk_bf16_f32 v42, v52, v53
    v_lshlrev_b32 v52, 16, v42
    v_and_b32 v53, 0xffff0000, v42
    v_mul_f32 v52, v52, v39
    v_mul_f32 v53, v53, v39
    v_cvt_pk_bf16_f32 v42, v52, v53
    ds_write_b32 v37, v42 offset:0
    v_sub_f32 v54, v54, v38
    v_sub_f32 v55, v55, v38
    v_cvt_pk_bf16_f32 v43, v54, v55
    v_lshlrev_b32 v54, 16, v43
    v_and_b32 v55, 0xffff0000, v43
    v_mul_f32 v54, v54, v39
    v_mul_f32 v55, v55, v39
    v_cvt_pk_bf16_f32 v43, v54, v55
    ds_write_b32 v37, v43 offset:1024
    v_sub_f32 v56, v56, v38
    v_sub_f32 v57, v57, v38
    v_cvt_pk_bf16_f32 v44, v56, v57
    v_lshlrev_b32 v56, 16, v44
    v_and_b32 v57, 0xffff0000, v44
    v_mul_f32 v56, v56, v39
    v_mul_f32 v57, v57, v39
    v_cvt_pk_bf16_f32 v44, v56, v57
    ds_write_b32 v37, v44 offset:2048
    v_sub_f32 v58, v58, v38
    v_sub_f32 v59, v59, v38
    v_cvt_pk_bf16_f32 v45, v58, v59
    v_lshlrev_b32 v58, 16, v45
    v_and_b32 v59, 0xffff0000, v45
    v_mul_f32 v58, v58, v39
    v_mul_f32 v59, v59, v39
    v_cvt_pk_bf16_f32 v45, v58, v59
    ds_write_b32 v37, v45 offset:3072
    v_sub_f32 v60, v60, v38
    v_sub_f32 v61, v61, v38
    v_cvt_pk_bf16_f32 v46, v60, v61
    v_lshlrev_b32 v60, 16, v46
    v_and_b32 v61, 0xffff0000, v46
    v_mul_f32 v60, v60, v39
    v_mul_f32 v61, v61, v39
    v_cvt_pk_bf16_f32 v46, v60, v61
    ds_write_b32 v37, v46 offset:4096
    v_sub_f32 v62, v62, v38
    v_sub_f32 v63, v63, v38
    v_cvt_pk_bf16_f32 v47, v62, v63
    v_lshlrev_b32 v62, 16, v47
    v_and_b32 v63, 0xffff0000, v47
    v_mul_f32 v62, v62, v39
    v_mul_f32 v63, v63, v39
    v_cvt_pk_bf16_f32 v47, v62, v63
    ds_write_b32 v37, v47 offset:5120
    v_sub_f32 v64, v64, v38
    v_sub_f32 v65, v65, v38
    v_cvt_pk_bf16_f32 v48, v64, v65
    v_lshlrev_b32 v64, 16, v48
    v_and_b32 v65, 0xffff0000, v48
    v_mul_f32 v64, v64, v39
    v_mul_f32 v65, v65, v39
    v_cvt_pk_bf16_f32 v48, v64, v65
    ds_write_b32 v37, v48 offset:6144
    v_sub_f32 v66, v66, v38
    v_sub_f32 v67, v67, v38
    v_cvt_pk_bf16_f32 v49, v66, v67
    v_lshlrev_b32 v66, 16, v49
    v_and_b32 v67, 0xffff0000, v49
    v_mul_f32 v66, v66, v39
    v_mul_f32 v67, v67, v39
    v_cvt_pk_bf16_f32 v49, v66, v67
    ds_write_b32 v37, v49 offset:7168
    v_sub_f32 v68, v68, v38
    v_sub_f32 v69, v69, v38
    v_cvt_pk_bf16_f32 v50, v68, v69
    v_lshlrev_b32 v68, 16, v50
    v_and_b32 v69, 0xffff0000, v50
    v_mul_f32 v68, v68, v39
    v_mul_f32 v69, v69, v39
    v_cvt_pk_bf16_f32 v50, v68, v69
    ds_write_b32 v37, v50 offset:8192
    v_add_u32 v34, 120320, v1
    v_lshrrev_b32 v35, 3, v0
    v_and_b32 v36, 7, v0
    v_lshlrev_b32 v36, 4, v36
    v_lshl_add_u32 v35, v35, 9, v36
    s_lshr_b32 s46, s2, 2
    s_mul_i32 s46, s46, 36864
    s_and_b32 s47, s2, 3
    s_lshl_b32 s47, s47, 7
    s_add_u32 s46, s46, s47
    s_waitcnt lgkmcnt(0)
    s_barrier
    s_cmp_eq_u32 s3, 0
    s_cbranch_scc0 LB_np
    ds_read_b128 v[40:43], v34 offset:0
    ds_read_b128 v[44:47], v34 offset:1024
    ds_read_b128 v[48:51], v34 offset:2048
    ds_read_b128 v[52:55], v34 offset:3072
    ds_read_b128 v[56:59], v34 offset:4096
    ds_read_b128 v[60:63], v34 offset:5120
    ds_read_b128 v[64:67], v34 offset:6144
    ds_read_b128 v[68:71], v34 offset:7168
    ds_read_b128 v[72:75], v34 offset:8192
    s_waitcnt lgkmcnt(8)
    buffer_store_dwordx4 v[40:43], v35, s[16:19], s46 offen sc1
    s_add_u32 s46, s46, 4096
    s_waitcnt lgkmcnt(7)
    buffer_store_dwordx4 v[44:47], v35, s[16:19], s46 offen sc1
    s_add_u32 s46, s46, 4096
    s_waitcnt lgkmcnt(6)
    buffer_store_dwordx4 v[48:51], v35, s[16:19], s46 offen sc1
    s_add_u32 s46, s46, 4096
    s_waitcnt lgkmcnt(5)
    buffer_store_dwordx4 v[52:55], v35, s[16:19], s46 offen sc1
    s_add_u32 s46, s46, 4096
    s_waitcnt lgkmcnt(4)
    buffer_store_dwordx4 v[56:59], v35, s[16:19], s46 offen sc1
    s_add_u32 s46, s46, 4096
    s_waitcnt lgkmcnt(3)
    buffer_store_dwordx4 v[60:63], v35, s[16:19], s46 offen sc1
    s_add_u32 s46, s46, 4096
    s_waitcnt lgkmcnt(2)
    buffer_store_dwordx4 v[64:67], v35, s[16:19], s46 offen sc1
    s_add_u32 s46, s46, 4096
    s_waitcnt lgkmcnt(1)
    buffer_store_dwordx4 v[68:71], v35, s[16:19], s46 offen sc1
    s_add_u32 s46, s46, 4096
    s_waitcnt lgkmcnt(0)
    buffer_store_dwordx4 v[72:75], v35, s[16:19], s46 offen sc1
    s_branch LB_l2
LB_np:
    s_cmp_lt_u32 s2, 5
    s_cbranch_scc0 LB_l2
    s_cmp_eq_u32 s3, 2
    s_cbranch_scc0 LB_l2
    s_mul_i32 s57, s2, 3940352
    s_add_u32 s57, s57, 37089280
    s_lshl_b32 s47, s2, 13
    s_add_u32 s47, s47, 36954112
    s_mov_b32 s46, 61568
    s_cmp_ge_u32 s2, 3
    s_cselect_b32 s46, 128, s46
    s_cselect_b32 s47, s47, s57
    v_mul_u32_u24 v74, s46, v0
    v_mov_b32 v75, 0
    buffer_store_dword v75, v74, s[16:19], s47 offen
LB_l2:
LB_common:
    s_and_b32 s12, s2, 7
    s_lshl_b32 s12, s12, 2
    s_lshr_b32 s13, s2, 3
    s_and_b32 s13, s13, 3
    s_add_u32 s12, s12, s13
    s_lshr_b32 s13, s2, 5
    s_mov_b32 s32, s92
    s_mov_b32 s33, s93
    s_mov_b32 s34, 256
    s_mov_b32 s35, 0x20000
    s_lshl_b32 s96, s13, 5
    s_and_b32 s97, s2, 7
    s_lshl_b32 s97, s97, 5
    s_add_u32 s97, s97, 16
    v_mov_b32 v104, 1
    v_mov_b32 v102, 147456
    s_waitcnt lgkmcnt(0)
    s_cmp_eq_u32 s3, 0
    s_cbranch_scc0 LB_n0
    s_lshl_b32 s96, s13, 12
    s_and_b32 s57, s2, 31
    s_lshl_b32 s57, s57, 2
    s_add_u32 s96, s96, s57
    s_add_u32 s96, s96, 36995072
    v_lshlrev_b32 v100, 7, v0
    s_mov_b32 exec_hi, 0
    s_waitcnt vmcnt(0)
LB_tag:
    ds_read_b32 v105, v102
    s_waitcnt lgkmcnt(0)
    v_cmp_eq_u32 vcc, 0, v105
    s_cbranch_vccnz LB_tag
    buffer_store_dword v105, v100, s[16:19], s96 offen sc1
    s_mov_b32 exec_hi, -1
LB_n0:
    s_cmp_lt_u32 s3, 4
    s_cbranch_scc1 LB_nw
    s_waitcnt vmcnt(0)
LB_nw:
    s_barrier
    s_cmp_eq_u32 s3, 4
    s_cbranch_scc0 LB_n4
    s_mov_b64 exec, 1
    buffer_atomic_add v104, off, s[32:35], s97
    s_mov_b64 exec, -1
LB_n4:
    ds_read_b32 v105, v102
    s_waitcnt lgkmcnt(0)
    s_lshl_b32 s13, s13, 3
    s_add_u32 s13, s13, s3
    s_mul_i32 s50, s3, 221184
    s_lshl_b32 s61, s12, 7
    s_add_u32 s50, s50, s61
    s_mul_i32 s55, s3, 3072
    s_add_u32 m0, s55, 0
    s_add_u32 s56, s50, 0
    buffer_load_dwordx4 v2, s[20:23], s56 offen lds
    s_add_u32 m0, s55, 1024
    s_add_u32 s56, s50, 73728
    buffer_load_dwordx4 v2, s[20:23], s56 offen lds
    s_add_u32 m0, s55, 2048
    s_add_u32 s56, s50, 147456
    buffer_load_dwordx4 v2, s[20:23], s56 offen lds
    s_add_u32 m0, s55, 24576
    s_add_u32 s56, s50, 0
    buffer_load_dwordx4 v3, s[24:27], s56 offen lds
    s_add_u32 m0, s55, 25600
    s_add_u32 s56, s50, 73728
    buffer_load_dwordx4 v3, s[24:27], s56 offen lds
    s_add_u32 m0, s55, 26624
    s_add_u32 s56, s50, 147456
    buffer_load_dwordx4 v3, s[24:27], s56 offen lds
    s_add_u32 m0, s55, 49152
    s_add_u32 s56, s50, 1769472
    buffer_load_dwordx4 v2, s[20:23], s56 offen lds
    s_add_u32 m0, s55, 50176
    s_add_u32 s56, s50, 1843200
    buffer_load_dwordx4 v2, s[20:23], s56 offen lds
    s_add_u32 m0, s55, 51200
    s_add_u32 s56, s50, 1916928
    buffer_load_dwordx4 v2, s[20:23], s56 offen lds
    s_add_u32 m0, s55, 73728
    s_add_u32 s56, s50, 1769472
    buffer_load_dwordx4 v3, s[24:27], s56 offen lds
    s_add_u32 m0, s55, 74752
    s_add_u32 s56, s50, 1843200
    buffer_load_dwordx4 v3, s[24:27], s56 offen lds
    s_add_u32 m0, s55, 75776
    s_add_u32 s56, s50, 1916928
    buffer_load_dwordx4 v3, s[24:27], s56 offen lds
    s_add_u32 m0, s55, 98304
    s_add_u32 s56, s50, 3538944
    buffer_load_dwordx4 v2, s[20:23], s56 offen lds
    s_add_u32 m0, s55, 99328
    s_add_u32 s56, s50, 3612672
    buffer_load_dwordx4 v2, s[20:23], s56 offen lds
    s_add_u32 m0, s55, 100352
    s_add_u32 s56, s50, 3686400
    buffer_load_dwordx4 v2, s[20:23], s56 offen lds
    s_add_u32 m0, s55, 122880
    s_add_u32 s56, s50, 3538944
    buffer_load_dwordx4 v3, s[24:27], s56 offen lds
    s_add_u32 m0, s55, 123904
    s_add_u32 s56, s50, 3612672
    buffer_load_dwordx4 v3, s[24:27], s56 offen lds
    s_add_u32 m0, s55, 124928
    s_add_u32 s56, s50, 3686400
    buffer_load_dwordx4 v3, s[24:27], s56 offen lds
    s_mul_i32 s48, s13, 36864
    s_mul_i32 s49, s12, 110592
    s_mul_i32 s14, s3, 5120
    s_add_u32 s49, s49, s14
    s_add_u32 s49, s49, 2359296
    s_mov_b32 s28, s8
    s_mov_b32 s29, s9
    s_mov_b32 s30, 5308416
    s_mov_b32 s31, 0x20000
    s_lshl_b32 s15, s2, 3
    s_add_u32 s15, s15, s3
    s_mul_i32 s57, s15, 21
    v_add_u32 v31, s57, v0
    v_lshlrev_b32 v31, 7, v31
    s_add_u32 s61, s61, 4096
    v_bfe_u32 v96, v0, 4, 1
    v_lshrrev_b32 v97, 5, v0
    v_bfe_u32 v98, v0, 2, 2
    v_and_b32 v99, 3, v0
    v_mul_u32_u24 v100, 24576, v96
    v_lshl_add_u32 v100, v97, 10, v100
    v_lshl_add_u32 v100, v98, 7, v100
    v_lshl_add_u32 v100, v99, 3, v100
    v_lshrrev_b32 v98, 1, v98
    v_lshl_or_b32 v98, v96, 1, v98
    v_xor_b32 v99, 0, v98
    v_lshl_add_u32 v4, v99, 5, v100
    v_xor_b32 v99, 1, v98
    v_lshl_add_u32 v5, v99, 5, v100
    v_xor_b32 v99, 2, v98
    v_lshl_add_u32 v6, v99, 5, v100
    v_xor_b32 v99, 3, v98
    v_lshl_add_u32 v7, v99, 5, v100
    v_mov_b32 v8, v1
    v_and_b32 v96, 31, v0
    v_subrev_u32 v98, 24, v96
    v_lshlrev_b32 v98, 12, v98
    v_lshl_add_u32 v9, v97, 3, v98
    v_lshrrev_b32 v96, 1, v96
    v_cmp_eq_u32 vcc, 12, v96
    v_mov_b32 v10, 1.0
    v_mov_b32 v98, 0x3eae1a93
    v_cndmask_b32 v10, v10, v98, vcc
    v_mov_b32 v11, v10
    v_mov_b32 v28, 0xc0135761
    v_mov_b32 v29, 0x3f803f80
    s_mov_b32 s40, 0xbdd2d3e8
    s_mov_b32 s41, 0xbdd2d3e8
    s_mov_b32 s42, 0x3eae1a93
    s_mov_b32 s43, 0x3eae1a93
    s_mov_b32 s44, 4456448
    s_mov_b32 s45, 4456448
    s_mul_i32 s51, s13, 294912
    s_lshl_b32 s57, s12, 10
    s_add_u32 s51, s51, 6569984
    s_add_u32 s62, s51, s57
    s_add_u32 s62, s62, 262144
    s_lshl_b32 s57, s12, 12
    s_add_u32 s51, s51, s57
    s_add_u32 s63, s51, 131072
    s_lshl_b32 s57, s12, 6
    s_add_u32 s57, s57, s13
    s_lshl_b32 s52, s57, 10
    s_add_u32 s52, s52, 25444352
    s_mul_i32 s53, s57, 3072
    s_add_u32 s53, s53, 27541504
    s_lshl_b32 s54, s12, 14
    s_lshl_b32 s57, s13, 6
    s_add_u32 s54, s54, s57
    s_add_u32 s54, s54, 33832960
    s_cmp_eq_u32 s3, 1
    s_cbranch_scc0 LB_pdX
    s_lshl_b32 s96, s2, 7
    s_add_u32 s96, s96, 36995072
    v_and_b32 v100, 31, v0
    v_lshlrev_b32 v100, 2, v100
    s_mov_b32 s47, 0x40000
LB_pollX:
    buffer_load_dword v101, v100, s[16:19], s96 offen sc1
    s_waitcnt vmcnt(0)
    v_cmp_ne_u32 vcc, v101, v105
    s_cbranch_vccz LB_pdX
    s_sub_u32 s47, s47, 1
    s_cmp_lg_u32 s47, 0
    s_cbranch_scc1 LB_pollX
LB_pdX:
    s_waitcnt vmcnt(12)
    s_barrier
    buffer_load_dwordx4 a[0:3], v1, s[16:19], s48 offen offset:0 sc1
    buffer_load_dwordx4 a[4:7], v1, s[16:19], s48 offen offset:1024 sc1
    buffer_load_dwordx4 a[8:11], v1, s[16:19], s48 offen offset:2048 sc1
    buffer_load_dwordx4 a[12:15], v1, s[16:19], s48 offen offset:3072 sc1
    s_add_u32 s48, s48, 4096
    buffer_load_dwordx4 a[16:19], v1, s[16:19], s48 offen offset:0 sc1
    buffer_load_dwordx4 a[20:23], v1, s[16:19], s48 offen offset:1024 sc1
    ds_read_b64_tr_b16 v[12:13], v4 offset:0
    ds_read_b64_tr_b16 v[14:15], v4 offset:512
    ds_read_b64_tr_b16 v[16:17], v5 offset:0
    ds_read_b64_tr_b16 v[18:19], v5 offset:512
    ds_read_b64_tr_b16 v[20:21], v6 offset:0
    ds_read_b64_tr_b16 v[22:23], v6 offset:512
    ds_read_b64_tr_b16 v[24:25], v7 offset:0
    ds_read_b64_tr_b16 v[26:27], v7 offset:512
    s_waitcnt vmcnt(5) lgkmcnt(6)
    v_mfma_f32_32x32x16_bf16 v[32:47], v[12:15], a[0:3], 0
    buffer_load_dwordx4 a[24:27], v1, s[16:19], s48 offen offset:2048 sc1
    ds_read_b64_tr_b16 v[12:13], v4 offset:2048
    ds_read_b64_tr_b16 v[14:15], v4 offset:2560
    s_waitcnt lgkmcnt(6)
    v_mfma_f32_32x32x16_bf16 v[48:63], v[16:19], a[0:3], 0
    ds_read_b64_tr_b16 v[16:17], v5 offset:2048
    ds_read_b64_tr_b16 v[18:19], v5 offset:2560
    s_waitcnt lgkmcnt(6)
    v_mfma_f32_32x32x16_bf16 v[64:79], v[20:23], a[0:3], 0
    buffer_load_dwordx4 a[28:31], v1, s[16:19], s48 offen offset:3072 sc1
    ds_read_b64_tr_b16 v[20:21], v6 offset:2048
    ds_read_b64_tr_b16 v[22:23], v6 offset:2560
    s_waitcnt lgkmcnt(6)
    v_mfma_f32_32x32x16_bf16 v[80:95], v[24:27], a[0:3], 0
    ds_read_b64_tr_b16 v[24:25], v7 offset:2048
    ds_read_b64_tr_b16 v[26:27], v7 offset:2560
    s_waitcnt vmcnt(6) lgkmcnt(6)
    v_mfma_f32_32x32x16_bf16 v[32:47], v[12:15], a[4:7], v[32:47]
    s_add_u32 s48, s48, 4096
    buffer_load_dwordx4 a[32:35], v1, s[16:19], s48 offen offset:0 sc1
    ds_read_b64_tr_b16 v[12:13], v4 offset:4096
    ds_read_b64_tr_b16 v[14:15], v4 offset:4608
    s_waitcnt lgkmcnt(6)
    v_mfma_f32_32x32x16_bf16 v[48:63], v[16:19], a[4:7], v[48:63]
    ds_read_b64_tr_b16 v[16:17], v5 offset:4096
    ds_read_b64_tr_b16 v[18:19], v5 offset:4608
    s_waitcnt lgkmcnt(6)
    v_mfma_f32_32x32x16_bf16 v[64:79], v[20:23], a[4:7], v[64:79]
    buffer_load_dwordx4 a[36:39], v1, s[16:19], s48 offen offset:1024 sc1
    ds_read_b64_tr_b16 v[20:21], v6 offset:4096
    ds_read_b64_tr_b16 v[22:23], v6 offset:4608
    s_waitcnt lgkmcnt(6)
    v_mfma_f32_32x32x16_bf16 v[80:95], v[24:27], a[4:7], v[80:95]
    ds_read_b64_tr_b16 v[24:25], v7 offset:4096
    ds_read_b64_tr_b16 v[26:27], v7 offset:4608
    s_waitcnt vmcnt(7) lgkmcnt(6)
    v_mfma_f32_32x32x16_bf16 v[32:47], v[12:15], a[8:11], v[32:47]
    buffer_load_dwordx4 a[40:43], v1, s[16:19], s48 offen offset:2048 sc1
    ds_read_b64_tr_b16 v[12:13], v4 offset:6144
    ds_read_b64_tr_b16 v[14:15], v4 offset:6656
    s_waitcnt lgkmcnt(6)
    v_mfma_f32_32x32x16_bf16 v[48:63], v[16:19], a[8:11], v[48:63]
    ds_read_b64_tr_b16 v[16:17], v5 offset:6144
    ds_read_b64_tr_b16 v[18:19], v5 offset:6656
    s_waitcnt lgkmcnt(6)
    v_mfma_f32_32x32x16_bf16 v[64:79], v[20:23], a[8:11], v[64:79]
    buffer_load_dwordx4 a[44:47], v1, s[16:19], s48 offen offset:3072 sc1
    ds_read_b64_tr_b16 v[20:21], v6 offset:6144
    ds_read_b64_tr_b16 v[22:23], v6 offset:6656
    s_waitcnt lgkmcnt(6)
    v_mfma_f32_32x32x16_bf16 v[80:95], v[24:27], a[8:11], v[80:95]
    ds_read_b64_tr_b16 v[24:25], v7 offset:6144
    ds_read_b64_tr_b16 v[26:27], v7 offset:6656
    s_waitcnt vmcnt(8) lgkmcnt(6)
    v_mfma_f32_32x32x16_bf16 v[32:47], v[12:15], a[12:15], v[32:47]
    s_add_u32 s48, s48, 4096
    buffer_load_dwordx4 a[48:51], v1, s[16:19], s48 offen offset:0 sc1
    ds_read_b64_tr_b16 v[12:13], v4 offset:8192
    ds_read_b64_tr_b16 v[14:15], v4 offset:8704
    s_waitcnt lgkmcnt(6)
    v_mfma_f32_32x32x16_bf16 v[48:63], v[16:19], a[12:15], v[48:63]
    ds_read_b64_tr_b16 v[16:17], v5 offset:8192
    ds_read_b64_tr_b16 v[18:19], v5 offset:8704
    s_waitcnt lgkmcnt(6)
    v_mfma_f32_32x32x16_bf16 v[64:79], v[20:23], a[12:15], v[64:79]
    buffer_load_dwordx4 a[52:55], v1, s[16:19], s48 offen offset:1024 sc1
    ds_read_b64_tr_b16 v[20:21], v6 offset:8192
    ds_read_b64_tr_b16 v[22:23], v6 offset:8704
    s_waitcnt lgkmcnt(6)
    v_mfma_f32_32x32x16_bf16 v[80:95], v[24:27], a[12:15], v[80:95]
    ds_read_b64_tr_b16 v[24:25], v7 offset:8192
    ds_read_b64_tr_b16 v[26:27], v7 offset:8704
    s_waitcnt vmcnt(9) lgkmcnt(6)
    v_mfma_f32_32x32x16_bf16 v[32:47], v[12:15], a[16:19], v[32:47]
    buffer_load_dwordx4 a[56:59], v1, s[16:19], s48 offen offset:2048 sc1
    ds_read_b64_tr_b16 v[12:13], v4 offset:10240
    ds_read_b64_tr_b16 v[14:15], v4 offset:10752
    s_waitcnt lgkmcnt(6)
    v_mfma_f32_32x32x16_bf16 v[48:63], v[16:19], a[16:19], v[48:63]
    ds_read_b64_tr_b16 v[16:17], v5 offset:10240
    ds_read_b64_tr_b16 v[18:19], v5 offset:10752
    s_waitcnt lgkmcnt(6)
    v_mfma_f32_32x32x16_bf16 v[64:79], v[20:23], a[16:19], v[64:79]
    buffer_load_dwordx4 a[60:63], v1, s[16:19], s48 offen offset:3072 sc1
    ds_read_b64_tr_b16 v[20:21], v6 offset:10240
    ds_read_b64_tr_b16 v[22:23], v6 offset:10752
    s_waitcnt lgkmcnt(6)
    v_mfma_f32_32x32x16_bf16 v[80:95], v[24:27], a[16:19], v[80:95]
    ds_read_b64_tr_b16 v[24:25], v7 offset:10240
    ds_read_b64_tr_b16 v[26:27], v7 offset:10752
    s_waitcnt vmcnt(10) lgkmcnt(6)
    v_mfma_f32_32x32x16_bf16 v[32:47], v[12:15], a[20:23], v[32:47]
    s_add_u32 s48, s48, 4096
    buffer_load_dwordx4 a[64:67], v1, s[16:19], s48 offen offset:0 sc1
    ds_read_b64_tr_b16 v[12:13], v4 offset:12288
    ds_read_b64_tr_b16 v[14:15], v4 offset:12800
    s_waitcnt lgkmcnt(6)
    v_mfma_f32_32x32x16_bf16 v[48:63], v[16:19], a[20:23], v[48:63]
    ds_read_b64_tr_b16 v[16:17], v5 offset:12288
    ds_read_b64_tr_b16 v[18:19], v5 offset:12800
    s_waitcnt lgkmcnt(6)
    v_mfma_f32_32x32x16_bf16 v[64:79], v[20:23], a[20:23], v[64:79]
    buffer_load_dwordx4 a[68:71], v1, s[16:19], s48 offen offset:1024 sc1
    ds_read_b64_tr_b16 v[20:21], v6 offset:12288
    ds_read_b64_tr_b16 v[22:23], v6 offset:12800
    s_waitcnt lgkmcnt(6)
    v_mfma_f32_32x32x16_bf16 v[80:95], v[24:27], a[20:23], v[80:95]
    ds_read_b64_tr_b16 v[24:25], v7 offset:12288
    ds_read_b64_tr_b16 v[26:27], v7 offset:12800
    s_waitcnt vmcnt(11) lgkmcnt(6)
    v_mfma_f32_32x32x16_bf16 v[32:47], v[12:15], a[24:27], v[32:47]
    buffer_load_dwordx4 a[72:75], v1, s[16:19], s48 offen offset:2048 sc1
    ds_read_b64_tr_b16 v[12:13], v4 offset:14336
    ds_read_b64_tr_b16 v[14:15], v4 offset:14848
    s_waitcnt lgkmcnt(6)
    v_mfma_f32_32x32x16_bf16 v[48:63], v[16:19], a[24:27], v[48:63]
    ds_read_b64_tr_b16 v[16:17], v5 offset:14336
    ds_read_b64_tr_b16 v[18:19], v5 offset:14848
    s_waitcnt lgkmcnt(6)
    v_mfma_f32_32x32x16_bf16 v[64:79], v[20:23], a[24:27], v[64:79]
    buffer_load_dwordx4 a[76:79], v1, s[16:19], s48 offen offset:3072 sc1
    ds_read_b64_tr_b16 v[20:21], v6 offset:14336
    ds_read_b64_tr_b16 v[22:23], v6 offset:14848
    s_waitcnt lgkmcnt(6)
    v_mfma_f32_32x32x16_bf16 v[80:95], v[24:27], a[24:27], v[80:95]
    ds_read_b64_tr_b16 v[24:25], v7 offset:14336
    ds_read_b64_tr_b16 v[26:27], v7 offset:14848
    s_waitcnt vmcnt(12) lgkmcnt(6)
    v_mfma_f32_32x32x16_bf16 v[32:47], v[12:15], a[28:31], v[32:47]
    s_add_u32 s48, s48, 4096
    buffer_load_dwordx4 a[80:83], v1, s[16:19], s48 offen offset:0 sc1
    ds_read_b64_tr_b16 v[12:13], v4 offset:16384
    ds_read_b64_tr_b16 v[14:15], v4 offset:16896
    s_waitcnt lgkmcnt(6)
    v_mfma_f32_32x32x16_bf16 v[48:63], v[16:19], a[28:31], v[48:63]
    ds_read_b64_tr_b16 v[16:17], v5 offset:16384
    ds_read_b64_tr_b16 v[18:19], v5 offset:16896
    s_waitcnt lgkmcnt(6)
    v_mfma_f32_32x32x16_bf16 v[64:79], v[20:23], a[28:31], v[64:79]
    buffer_load_dwordx4 a[84:87], v1, s[16:19], s48 offen offset:1024 sc1
    s_cmp_eq_u32 s3, 4
    s_cbranch_scc0 LB_npp
    buffer_load_dword v0, off, s[32:35], s97 sc1
LB_npp:
    ds_read_b64_tr_b16 v[20:21], v6 offset:16384
    ds_read_b64_tr_b16 v[22:23], v6 offset:16896
    s_waitcnt lgkmcnt(6)
    v_mfma_f32_32x32x16_bf16 v[80:95], v[24:27], a[28:31], v[80:95]
    ds_read_b64_tr_b16 v[24:25], v7 offset:16384
    ds_read_b64_tr_b16 v[26:27], v7 offset:16896
    s_waitcnt vmcnt(13) lgkmcnt(6)
    v_mfma_f32_32x32x16_bf16 v[32:47], v[12:15], a[32:35], v[32:47]
    buffer_load_dwordx4 a[88:91], v1, s[16:19], s48 offen offset:2048 sc1
    ds_read_b64_tr_b16 v[12:13], v4 offset:18432
    ds_read_b64_tr_b16 v[14:15], v4 offset:18944
    s_waitcnt lgkmcnt(6)
    v_mfma_f32_32x32x16_bf16 v[48:63], v[16:19], a[32:35], v[48:63]
    ds_read_b64_tr_b16 v[16:17], v5 offset:18432
    ds_read_b64_tr_b16 v[18:19], v5 offset:18944
    s_waitcnt lgkmcnt(6)
    v_mfma_f32_32x32x16_bf16 v[64:79], v[20:23], a[32:35], v[64:79]
    buffer_load_dwordx4 a[92:95], v1, s[16:19], s48 offen offset:3072 sc1
    ds_read_b64_tr_b16 v[20:21], v6 offset:18432
    ds_read_b64_tr_b16 v[22:23], v6 offset:18944
    s_waitcnt lgkmcnt(6)
    v_mfma_f32_32x32x16_bf16 v[80:95], v[24:27], a[32:35], v[80:95]
    ds_read_b64_tr_b16 v[24:25], v7 offset:18432
    ds_read_b64_tr_b16 v[26:27], v7 offset:18944
    s_waitcnt vmcnt(14) lgkmcnt(6)
    v_mfma_f32_32x32x16_bf16 v[32:47], v[12:15], a[36:39], v[32:47]
    s_add_u32 s48, s48, 4096
    buffer_load_dwordx4 a[96:99], v1, s[16:19], s48 offen offset:0 sc1
    ds_read_b64_tr_b16 v[12:13], v4 offset:20480
    ds_read_b64_tr_b16 v[14:15], v4 offset:20992
    s_waitcnt lgkmcnt(6)
    v_mfma_f32_32x32x16_bf16 v[48:63], v[16:19], a[36:39], v[48:63]
    ds_read_b64_tr_b16 v[16:17], v5 offset:20480
    ds_read_b64_tr_b16 v[18:19], v5 offset:20992
    s_waitcnt lgkmcnt(6)
    v_mfma_f32_32x32x16_bf16 v[64:79], v[20:23], a[36:39], v[64:79]
    buffer_load_dwordx4 a[100:103], v1, s[16:19], s48 offen offset:1024 sc1
    ds_read_b64_tr_b16 v[20:21], v6 offset:20480
    ds_read_b64_tr_b16 v[22:23], v6 offset:20992
    s_waitcnt lgkmcnt(6)
    v_mfma_f32_32x32x16_bf16 v[80:95], v[24:27], a[36:39], v[80:95]
    ds_read_b64_tr_b16 v[24:25], v7 offset:20480
    ds_read_b64_tr_b16 v[26:27], v7 offset:20992
    s_waitcnt vmcnt(15) lgkmcnt(6)
    v_mfma_f32_32x32x16_bf16 v[32:47], v[12:15], a[40:43], v[32:47]
    buffer_load_dwordx4 a[104:107], v1, s[16:19], s48 offen offset:2048 sc1
    ds_read_b64_tr_b16 v[12:13], v4 offset:22528
    ds_read_b64_tr_b16 v[14:15], v4 offset:23040
    s_waitcnt lgkmcnt(6)
    v_mfma_f32_32x32x16_bf16 v[48:63], v[16:19], a[40:43], v[48:63]
    ds_read_b64_tr_b16 v[16:17], v5 offset:22528
    ds_read_b64_tr_b16 v[18:19], v5 offset:23040
    s_waitcnt lgkmcnt(6)
    v_mfma_f32_32x32x16_bf16 v[64:79], v[20:23], a[40:43], v[64:79]
    buffer_load_dwordx4 a[108:111], v1, s[16:19], s48 offen offset:3072 sc1
    ds_read_b64_tr_b16 v[20:21], v6 offset:22528
    ds_read_b64_tr_b16 v[22:23], v6 offset:23040
    s_waitcnt lgkmcnt(6)
    v_mfma_f32_32x32x16_bf16 v[80:95], v[24:27], a[40:43], v[80:95]
    ds_read_b64_tr_b16 v[24:25], v7 offset:22528
    ds_read_b64_tr_b16 v[26:27], v7 offset:23040
    s_waitcnt vmcnt(16) lgkmcnt(6)
    v_mfma_f32_32x32x16_bf16 v[32:47], v[12:15], a[44:47], v[32:47]
    s_add_u32 s48, s48, 4096
    buffer_load_dwordx4 a[112:115], v1, s[16:19], s48 offen offset:0 sc1
    s_cmp_eq_u32 s3, 4
    s_cbranch_scc0 LB_pdW
    s_waitcnt vmcnt(7)
    v_readfirstlane_b32 s46, v0
    s_nop 0
    s_cmp_ge_u32 s46, 32
    s_cbranch_scc1 LB_pdW
    s_mov_b32 s47, 0x40000
LB_pollW:
    buffer_load_dword v0, off, s[32:35], s97 sc1
    s_waitcnt vmcnt(0)
    v_readfirstlane_b32 s46, v0
    s_nop 0
    s_cmp_ge_u32 s46, 32
    s_cbranch_scc1 LB_pdW
    s_sub_u32 s47, s47, 1
    s_cmp_lg_u32 s47, 0
    s_cbranch_scc1 LB_pollW
LB_pdW:
    s_waitcnt vmcnt(35) lgkmcnt(0)
    s_barrier
    v_add_u32 v4, 49152, v4
    v_add_u32 v5, 49152, v5
    v_add_u32 v6, 49152, v6
    v_add_u32 v7, 49152, v7
    ds_read_b64_tr_b16 v[12:13], v4 offset:0
    ds_read_b64_tr_b16 v[14:15], v4 offset:512
    s_waitcnt lgkmcnt(2)
    v_mfma_f32_32x32x16_bf16 v[48:63], v[16:19], a[44:47], v[48:63]
    ds_read_b64_tr_b16 v[16:17], v5 offset:0
    ds_read_b64_tr_b16 v[18:19], v5 offset:512
    s_waitcnt lgkmcnt(4)
    v_mfma_f32_32x32x16_bf16 v[64:79], v[20:23], a[44:47], v[64:79]
    buffer_load_dwordx4 a[116:119], v1, s[16:19], s48 offen offset:1024 sc1
    ds_read_b64_tr_b16 v[20:21], v6 offset:0
    ds_read_b64_tr_b16 v[22:23], v6 offset:512
    s_waitcnt lgkmcnt(6)
    v_mfma_f32_32x32x16_bf16 v[80:95], v[24:27], a[44:47], v[80:95]
    ds_read_b64_tr_b16 v[24:25], v7 offset:0
    ds_read_b64_tr_b16 v[26:27], v7 offset:512
    s_waitcnt vmcnt(17) lgkmcnt(6)
    v_mfma_f32_32x32x16_bf16 v[32:47], v[12:15], a[48:51], v[32:47]
    buffer_load_dwordx4 a[120:123], v1, s[16:19], s48 offen offset:2048 sc1
    ds_read_b64_tr_b16 v[12:13], v4 offset:2048
    ds_read_b64_tr_b16 v[14:15], v4 offset:2560
    s_waitcnt lgkmcnt(6)
    v_mfma_f32_32x32x16_bf16 v[48:63], v[16:19], a[48:51], v[48:63]
    ds_read_b64_tr_b16 v[16:17], v5 offset:2048
    ds_read_b64_tr_b16 v[18:19], v5 offset:2560
    s_waitcnt lgkmcnt(6)
    v_mfma_f32_32x32x16_bf16 v[64:79], v[20:23], a[48:51], v[64:79]
    buffer_load_dwordx4 a[124:127], v1, s[16:19], s48 offen offset:3072 sc1
    ds_read_b64_tr_b16 v[20:21], v6 offset:2048
    ds_read_b64_tr_b16 v[22:23], v6 offset:2560
    s_waitcnt lgkmcnt(6)
    v_mfma_f32_32x32x16_bf16 v[80:95], v[24:27], a[48:51], v[80:95]
    ds_read_b64_tr_b16 v[24:25], v7 offset:2048
    ds_read_b64_tr_b16 v[26:27], v7 offset:2560
    s_waitcnt vmcnt(18) lgkmcnt(6)
    v_mfma_f32_32x32x16_bf16 v[32:47], v[12:15], a[52:55], v[32:47]
    s_add_u32 s48, s48, 4096
    buffer_load_dwordx4 a[128:131], v1, s[16:19], s48 offen offset:0 sc1
    ds_read_b64_tr_b16 v[12:13], v4 offset:4096
    ds_read_b64_tr_b16 v[14:15], v4 offset:4608
    s_waitcnt lgkmcnt(6)
    v_mfma_f32_32x32x16_bf16 v[48:63], v[16:19], a[52:55], v[48:63]
    ds_read_b64_tr_b16 v[16:17], v5 offset:4096
    ds_read_b64_tr_b16 v[18:19], v5 offset:4608
    s_waitcnt lgkmcnt(6)
    v_mfma_f32_32x32x16_bf16 v[64:79], v[20:23], a[52:55], v[64:79]
    buffer_load_dwordx4 a[132:135], v1, s[16:19], s48 offen offset:1024 sc1
    ds_read_b64_tr_b16 v[20:21], v6 offset:4096
    ds_read_b64_tr_b16 v[22:23], v6 offset:4608
    s_waitcnt lgkmcnt(6)
    v_mfma_f32_32x32x16_bf16 v[80:95], v[24:27], a[52:55], v[80:95]
    ds_read_b64_tr_b16 v[24:25], v7 offset:4096
    ds_read_b64_tr_b16 v[26:27], v7 offset:4608
    s_waitcnt vmcnt(19) lgkmcnt(6)
    v_mfma_f32_32x32x16_bf16 v[32:47], v[12:15], a[56:59], v[32:47]
    buffer_load_dwordx4 a[136:139], v1, s[16:19], s48 offen offset:2048 sc1
    ds_read_b64_tr_b16 v[12:13], v4 offset:6144
    ds_read_b64_tr_b16 v[14:15], v4 offset:6656
    s_waitcnt lgkmcnt(6)
    v_mfma_f32_32x32x16_bf16 v[48:63], v[16:19], a[56:59], v[48:63]
    ds_read_b64_tr_b16 v[16:17], v5 offset:6144
    ds_read_b64_tr_b16 v[18:19], v5 offset:6656
    s_waitcnt lgkmcnt(6)
    v_mfma_f32_32x32x16_bf16 v[64:79], v[20:23], a[56:59], v[64:79]
    buffer_load_dwordx4 a[140:143], v1, s[16:19], s48 offen offset:3072 sc1
    ds_read_b64_tr_b16 v[20:21], v6 offset:6144
    ds_read_b64_tr_b16 v[22:23], v6 offset:6656
    s_waitcnt lgkmcnt(6)
    v_mfma_f32_32x32x16_bf16 v[80:95], v[24:27], a[56:59], v[80:95]
    ds_read_b64_tr_b16 v[24:25], v7 offset:6144
    ds_read_b64_tr_b16 v[26:27], v7 offset:6656
    s_waitcnt vmcnt(20) lgkmcnt(6)
    v_mfma_f32_32x32x16_bf16 v[32:47], v[12:15], a[60:63], v[32:47]
    s_add_u32 m0, s14, 0
    s_add_u32 s56, s49, 0
    buffer_load_dwordx4 v1, s[16:19], s56 offen sc1 lds
    ds_read_b64_tr_b16 v[12:13], v4 offset:8192
    ds_read_b64_tr_b16 v[14:15], v4 offset:8704
    s_waitcnt lgkmcnt(6)
    v_mfma_f32_32x32x16_bf16 v[48:63], v[16:19], a[60:63], v[48:63]
    ds_read_b64_tr_b16 v[16:17], v5 offset:8192
    ds_read_b64_tr_b16 v[18:19], v5 offset:8704
    s_waitcnt lgkmcnt(6)
    v_mfma_f32_32x32x16_bf16 v[64:79], v[20:23], a[60:63], v[64:79]
    s_add_u32 m0, s14, 1024
    s_add_u32 s56, s49, 1024
    buffer_load_dwordx4 v1, s[16:19], s56 offen sc1 lds
    ds_read_b64_tr_b16 v[20:21], v6 offset:8192
    ds_read_b64_tr_b16 v[22:23], v6 offset:8704
    s_waitcnt lgkmcnt(6)
    v_mfma_f32_32x32x16_bf16 v[80:95], v[24:27], a[60:63], v[80:95]
    ds_read_b64_tr_b16 v[24:25], v7 offset:8192
    ds_read_b64_tr_b16 v[26:27], v7 offset:8704
    s_waitcnt vmcnt(21) lgkmcnt(6)
    v_mfma_f32_32x32x16_bf16 v[32:47], v[12:15], a[64:67], v[32:47]
    s_add_u32 m0, s14, 2048
    s_add_u32 s56, s49, 2048
    buffer_load_dwordx4 v1, s[16:19], s56 offen sc1 lds
    ds_read_b64_tr_b16 v[12:13], v4 offset:10240
    ds_read_b64_tr_b16 v[14:15], v4 offset:10752
    s_waitcnt lgkmcnt(6)
    v_mfma_f32_32x32x16_bf16 v[48:63], v[16:19], a[64:67], v[48:63]
    ds_read_b64_tr_b16 v[16:17], v5 offset:10240
    ds_read_b64_tr_b16 v[18:19], v5 offset:10752
    s_waitcnt lgkmcnt(6)
    v_mfma_f32_32x32x16_bf16 v[64:79], v[20:23], a[64:67], v[64:79]
    s_add_u32 m0, s14, 3072
    s_add_u32 s56, s49, 3072
    buffer_load_dwordx4 v1, s[16:19], s56 offen sc1 lds
    ds_read_b64_tr_b16 v[20:21], v6 offset:10240
    ds_read_b64_tr_b16 v[22:23], v6 offset:10752
    s_waitcnt lgkmcnt(6)
    v_mfma_f32_32x32x16_bf16 v[80:95], v[24:27], a[64:67], v[80:95]
    ds_read_b64_tr_b16 v[24:25], v7 offset:10240
    ds_read_b64_tr_b16 v[26:27], v7 offset:10752
    s_waitcnt vmcnt(22) lgkmcnt(6)
    v_mfma_f32_32x32x16_bf16 v[32:47], v[12:15], a[68:71], v[32:47]
    s_add_u32 m0, s14, 4096
    s_add_u32 s56, s49, 4096
    buffer_load_dwordx4 v1, s[16:19], s56 offen sc1 lds
    ds_read_b64_tr_b16 v[12:13], v4 offset:12288
    ds_read_b64_tr_b16 v[14:15], v4 offset:12800
    s_waitcnt lgkmcnt(6)
    v_mfma_f32_32x32x16_bf16 v[48:63], v[16:19], a[68:71], v[48:63]
    ds_read_b64_tr_b16 v[16:17], v5 offset:12288
    ds_read_b64_tr_b16 v[18:19], v5 offset:12800
    s_waitcnt lgkmcnt(6)
    v_mfma_f32_32x32x16_bf16 v[64:79], v[20:23], a[68:71], v[64:79]
    ds_read_b64_tr_b16 v[20:21], v6 offset:12288
    ds_read_b64_tr_b16 v[22:23], v6 offset:12800
    s_waitcnt lgkmcnt(6)
    v_mfma_f32_32x32x16_bf16 v[80:95], v[24:27], a[68:71], v[80:95]
    ds_read_b64_tr_b16 v[24:25], v7 offset:12288
    ds_read_b64_tr_b16 v[26:27], v7 offset:12800
    s_waitcnt vmcnt(22) lgkmcnt(6)
    v_mfma_f32_32x32x16_bf16 v[32:47], v[12:15], a[72:75], v[32:47]
    ds_read_b64_tr_b16 v[12:13], v4 offset:14336
    ds_read_b64_tr_b16 v[14:15], v4 offset:14848
    s_waitcnt lgkmcnt(6)
    v_mfma_f32_32x32x16_bf16 v[48:63], v[16:19], a[72:75], v[48:63]
    ds_read_b64_tr_b16 v[16:17], v5 offset:14336
    ds_read_b64_tr_b16 v[18:19], v5 offset:14848
    s_waitcnt lgkmcnt(6)
    v_mfma_f32_32x32x16_bf16 v[64:79], v[20:23], a[72:75], v[64:79]
    ds_read_b64_tr_b16 v[20:21], v6 offset:14336
    ds_read_b64_tr_b16 v[22:23], v6 offset:14848
    s_waitcnt lgkmcnt(6)
    v_mfma_f32_32x32x16_bf16 v[80:95], v[24:27], a[72:75], v[80:95]
    ds_read_b64_tr_b16 v[24:25], v7 offset:14336
    ds_read_b64_tr_b16 v[26:27], v7 offset:14848
    s_waitcnt vmcnt(21) lgkmcnt(6)
    v_mfma_f32_32x32x16_bf16 v[32:47], v[12:15], a[76:79], v[32:47]
    ds_read_b64_tr_b16 v[12:13], v4 offset:16384
    ds_read_b64_tr_b16 v[14:15], v4 offset:16896
    s_waitcnt lgkmcnt(6)
    v_mfma_f32_32x32x16_bf16 v[48:63], v[16:19], a[76:79], v[48:63]
    ds_read_b64_tr_b16 v[16:17], v5 offset:16384
    ds_read_b64_tr_b16 v[18:19], v5 offset:16896
    s_waitcnt lgkmcnt(6)
    v_mfma_f32_32x32x16_bf16 v[64:79], v[20:23], a[76:79], v[64:79]
    ds_read_b64_tr_b16 v[20:21], v6 offset:16384
    ds_read_b64_tr_b16 v[22:23], v6 offset:16896
    s_waitcnt lgkmcnt(6)
    v_mfma_f32_32x32x16_bf16 v[80:95], v[24:27], a[76:79], v[80:95]
    ds_read_b64_tr_b16 v[24:25], v7 offset:16384
    ds_read_b64_tr_b16 v[26:27], v7 offset:16896
    s_waitcnt vmcnt(20) lgkmcnt(6)
    v_mfma_f32_32x32x16_bf16 v[32:47], v[12:15], a[80:83], v[32:47]
    ds_read_b64_tr_b16 v[12:13], v4 offset:18432
    ds_read_b64_tr_b16 v[14:15], v4 offset:18944
    s_waitcnt lgkmcnt(6)
    v_mfma_f32_32x32x16_bf16 v[48:63], v[16:19], a[80:83], v[48:63]
    ds_read_b64_tr_b16 v[16:17], v5 offset:18432
    ds_read_b64_tr_b16 v[18:19], v5 offset:18944
    s_waitcnt lgkmcnt(6)
    v_mfma_f32_32x32x16_bf16 v[64:79], v[20:23], a[80:83], v[64:79]
    ds_read_b64_tr_b16 v[20:21], v6 offset:18432
    ds_read_b64_tr_b16 v[22:23], v6 offset:18944
    s_waitcnt lgkmcnt(6)
    v_mfma_f32_32x32x16_bf16 v[80:95], v[24:27], a[80:83], v[80:95]
    ds_read_b64_tr_b16 v[24:25], v7 offset:18432
    ds_read_b64_tr_b16 v[26:27], v7 offset:18944
    s_waitcnt vmcnt(19) lgkmcnt(6)
    v_mfma_f32_32x32x16_bf16 v[32:47], v[12:15], a[84:87], v[32:47]
    ds_read_b64_tr_b16 v[12:13], v4 offset:20480
    ds_read_b64_tr_b16 v[14:15], v4 offset:20992
    s_waitcnt lgkmcnt(6)
    v_mfma_f32_32x32x16_bf16 v[48:63], v[16:19], a[84:87], v[48:63]
    ds_read_b64_tr_b16 v[16:17], v5 offset:20480
    ds_read_b64_tr_b16 v[18:19], v5 offset:20992
    s_waitcnt lgkmcnt(6)
    v_mfma_f32_32x32x16_bf16 v[64:79], v[20:23], a[84:87], v[64:79]
    ds_read_b64_tr_b16 v[20:21], v6 offset:20480
    ds_read_b64_tr_b16 v[22:23], v6 offset:20992
    s_waitcnt lgkmcnt(6)
    v_mfma_f32_32x32x16_bf16 v[80:95], v[24:27], a[84:87], v[80:95]
    ds_read_b64_tr_b16 v[24:25], v7 offset:20480
    ds_read_b64_tr_b16 v[26:27], v7 offset:20992
    s_waitcnt vmcnt(18) lgkmcnt(6)
    v_mfma_f32_32x32x16_bf16 v[32:47], v[12:15], a[88:91], v[32:47]
    ds_read_b64_tr_b16 v[12:13], v4 offset:22528
    ds_read_b64_tr_b16 v[14:15], v4 offset:23040
    s_waitcnt lgkmcnt(6)
    v_mfma_f32_32x32x16_bf16 v[48:63], v[16:19], a[88:91], v[48:63]
    ds_read_b64_tr_b16 v[16:17], v5 offset:22528
    ds_read_b64_tr_b16 v[18:19], v5 offset:23040
    s_waitcnt lgkmcnt(6)
    v_mfma_f32_32x32x16_bf16 v[64:79], v[20:23], a[88:91], v[64:79]
    ds_read_b64_tr_b16 v[20:21], v6 offset:22528
    ds_read_b64_tr_b16 v[22:23], v6 offset:23040
    s_waitcnt lgkmcnt(6)
    v_mfma_f32_32x32x16_bf16 v[80:95], v[24:27], a[88:91], v[80:95]
    ds_read_b64_tr_b16 v[24:25], v7 offset:22528
    ds_read_b64_tr_b16 v[26:27], v7 offset:23040
    s_waitcnt vmcnt(17) lgkmcnt(6)
    v_mfma_f32_32x32x16_bf16 v[32:47], v[12:15], a[92:95], v[32:47]
    s_waitcnt vmcnt(41) lgkmcnt(0)
    s_barrier
    v_add_u32 v4, 49152, v4
    v_add_u32 v5, 49152, v5
    v_add_u32 v6, 49152, v6
    v_add_u32 v7, 49152, v7
    ds_read_b64_tr_b16 v[12:13], v4 offset:0
    ds_read_b64_tr_b16 v[14:15], v4 offset:512
    s_waitcnt lgkmcnt(2)
    v_mfma_f32_32x32x16_bf16 v[48:63], v[16:19], a[92:95], v[48:63]
    ds_read_b64_tr_b16 v[16:17], v4 offset:2048
    ds_read_b64_tr_b16 v[18:19], v4 offset:2560
    s_waitcnt lgkmcnt(4)
    v_mfma_f32_32x32x16_bf16 v[64:79], v[20:23], a[92:95], v[64:79]
    s_add_u32 m0, s14, 49152
    s_add_u32 s56, s49, 36864
    buffer_load_dwordx4 v1, s[16:19], s56 offen sc1 lds
    ds_read_b64_tr_b16 v[20:21], v4 offset:4096
    ds_read_b64_tr_b16 v[22:23], v4 offset:4608
    s_waitcnt lgkmcnt(6)
    v_mfma_f32_32x32x16_bf16 v[80:95], v[24:27], a[92:95], v[80:95]
    ds_read_b64_tr_b16 v[24:25], v4 offset:6144
    ds_read_b64_tr_b16 v[26:27], v4 offset:6656
    s_waitcnt vmcnt(17) lgkmcnt(6)
    v_mfma_f32_32x32x16_bf16 v[32:47], v[12:15], a[96:99], v[32:47]
    s_add_u32 m0, s14, 50176
    s_add_u32 s56, s49, 37888
    buffer_load_dwordx4 v1, s[16:19], s56 offen sc1 lds
    ds_read_b64_tr_b16 v[12:13], v4 offset:8192
    ds_read_b64_tr_b16 v[14:15], v4 offset:8704
    s_waitcnt vmcnt(17) lgkmcnt(6)
    v_mfma_f32_32x32x16_bf16 v[32:47], v[16:19], a[100:103], v[32:47]
    ds_read_b64_tr_b16 v[16:17], v4 offset:10240
    ds_read_b64_tr_b16 v[18:19], v4 offset:10752
    s_waitcnt vmcnt(16) lgkmcnt(6)
    v_mfma_f32_32x32x16_bf16 v[32:47], v[20:23], a[104:107], v[32:47]
    s_add_u32 m0, s14, 51200
    s_add_u32 s56, s49, 38912
    buffer_load_dwordx4 v1, s[16:19], s56 offen sc1 lds
    ds_read_b64_tr_b16 v[20:21], v4 offset:12288
    ds_read_b64_tr_b16 v[22:23], v4 offset:12800
    s_waitcnt vmcnt(16) lgkmcnt(6)
    v_mfma_f32_32x32x16_bf16 v[32:47], v[24:27], a[108:111], v[32:47]
    ds_read_b64_tr_b16 v[24:25], v4 offset:14336
    ds_read_b64_tr_b16 v[26:27], v4 offset:14848
    s_waitcnt vmcnt(15) lgkmcnt(6)
    v_mfma_f32_32x32x16_bf16 v[32:47], v[12:15], a[112:115], v[32:47]
    s_add_u32 m0, s14, 52224
    s_add_u32 s56, s49, 39936
    buffer_load_dwordx4 v1, s[16:19], s56 offen sc1 lds
    s_cmp_lt_u32 s3, 4
    s_cbranch_scc1 LB_nt1
    s_mov_b64 exec, 262143
    buffer_load_dword v0, v30, s[20:23], s61 offen
    buffer_load_dword v0, v30, s[24:27], s61 offen
    s_mov_b64 exec, -1
LB_nt1:
    ds_read_b64_tr_b16 v[12:13], v4 offset:16384
    ds_read_b64_tr_b16 v[14:15], v4 offset:16896
    s_waitcnt vmcnt(15) lgkmcnt(6)
    v_mfma_f32_32x32x16_bf16 v[32:47], v[16:19], a[116:119], v[32:47]
    ds_read_b64_tr_b16 v[16:17], v4 offset:18432
    ds_read_b64_tr_b16 v[18:19], v4 offset:18944
    s_waitcnt vmcnt(14) lgkmcnt(6)
    v_mfma_f32_32x32x16_bf16 v[32:47], v[20:23], a[120:123], v[32:47]
    s_add_u32 m0, s14, 53248
    s_add_u32 s56, s49, 40960
    buffer_load_dwordx4 v1, s[16:19], s56 offen sc1 lds
    ds_read_b64_tr_b16 v[20:21], v4 offset:20480
    ds_read_b64_tr_b16 v[22:23], v4 offset:20992
    s_waitcnt vmcnt(14) lgkmcnt(6)
    v_mfma_f32_32x32x16_bf16 v[32:47], v[24:27], a[124:127], v[32:47]
    ds_read_b64_tr_b16 v[24:25], v4 offset:22528
    ds_read_b64_tr_b16 v[26:27], v4 offset:23040
    s_waitcnt vmcnt(13) lgkmcnt(6)
    v_mfma_f32_32x32x16_bf16 v[32:47], v[12:15], a[128:131], v[32:47]
    ds_read_b64_tr_b16 v[12:13], v5 offset:0
    ds_read_b64_tr_b16 v[14:15], v5 offset:512
    s_waitcnt vmcnt(12) lgkmcnt(6)
    v_mfma_f32_32x32x16_bf16 v[32:47], v[16:19], a[132:135], v[32:47]
    ds_read_b64_tr_b16 v[16:17], v5 offset:2048
    ds_read_b64_tr_b16 v[18:19], v5 offset:2560
    s_waitcnt vmcnt(11) lgkmcnt(6)
    v_mfma_f32_32x32x16_bf16 v[32:47], v[20:23], a[136:139], v[32:47]
    ds_read_b64_tr_b16 v[20:21], v5 offset:4096
    ds_read_b64_tr_b16 v[22:23], v5 offset:4608
    s_waitcnt vmcnt(10) lgkmcnt(6)
    v_mfma_f32_32x32x16_bf16 v[32:47], v[24:27], a[140:143], v[32:47]
    ds_read_b64_tr_b16 v[24:25], v5 offset:6144
    ds_read_b64_tr_b16 v[26:27], v5 offset:6656
    s_waitcnt lgkmcnt(6)
    v_mfma_f32_32x32x16_bf16 v[48:63], v[12:15], a[96:99], v[48:63]
    ds_read_b64_tr_b16 v[12:13], v5 offset:8192
    ds_read_b64_tr_b16 v[14:15], v5 offset:8704
    s_waitcnt lgkmcnt(6)
    v_mfma_f32_32x32x16_bf16 v[48:63], v[16:19], a[100:103], v[48:63]
    ds_read_b64_tr_b16 v[16:17], v5 offset:10240
    ds_read_b64_tr_b16 v[18:19], v5 offset:10752
    s_waitcnt lgkmcnt(6)
    v_mfma_f32_32x32x16_bf16 v[48:63], v[20:23], a[104:107], v[48:63]
    v_mul_f32 v96, v32, v32
    v_mul_f32 v97, v33, v33
    v_mul_f32 v98, v34, v34
    v_mul_f32 v99, v35, v35
    ds_read_b64_tr_b16 v[20:21], v5 offset:12288
    ds_read_b64_tr_b16 v[22:23], v5 offset:12800
    s_waitcnt lgkmcnt(6)
    v_mfma_f32_32x32x16_bf16 v[48:63], v[24:27], a[108:111], v[48:63]
    v_fma_f32 v96, v96, s40, v28
    v_fma_f32 v97, v97, s40, v28
    v_fma_f32 v98, v98, s40, v28
    v_fma_f32 v99, v99, s40, v28
    ds_read_b64_tr_b16 v[24:25], v5 offset:14336
    ds_read_b64_tr_b16 v[26:27], v5 offset:14848
    s_waitcnt lgkmcnt(6)
    v_mfma_f32_32x32x16_bf16 v[48:63], v[12:15], a[112:115], v[48:63]
    v_mul_f32 v96, v96, v32
    v_mul_f32 v97, v97, v33
    v_mul_f32 v98, v98, v34
    v_mul_f32 v99, v99, v35
    ds_read_b64_tr_b16 v[12:13], v5 offset:16384
    ds_read_b64_tr_b16 v[14:15], v5 offset:16896
    s_waitcnt lgkmcnt(6)
    v_mfma_f32_32x32x16_bf16 v[48:63], v[16:19], a[116:119], v[48:63]
    v_exp_f32 v96, v96
    v_exp_f32 v97, v97
    v_exp_f32 v98, v98
    v_exp_f32 v99, v99
    ds_read_b64_tr_b16 v[16:17], v5 offset:18432
    ds_read_b64_tr_b16 v[18:19], v5 offset:18944
    s_waitcnt lgkmcnt(6)
    v_mfma_f32_32x32x16_bf16 v[48:63], v[20:23], a[120:123], v[48:63]
    v_mul_f32 v40, v32, v40
    v_mul_f32 v41, v33, v41
    v_mul_f32 v42, v34, v42
    v_mul_f32 v43, v35, v43
    ds_read_b64_tr_b16 v[20:21], v5 offset:20480
    ds_read_b64_tr_b16 v[22:23], v5 offset:20992
    s_waitcnt lgkmcnt(6)
    v_mfma_f32_32x32x16_bf16 v[48:63], v[24:27], a[124:127], v[48:63]
    v_add_f32 v96, 1.0, v96
    v_add_f32 v97, 1.0, v97
    v_add_f32 v98, 1.0, v98
    v_add_f32 v99, 1.0, v99
    ds_read_b64_tr_b16 v[24:25], v5 offset:22528
    ds_read_b64_tr_b16 v[26:27], v5 offset:23040
    s_waitcnt lgkmcnt(6)
    v_mfma_f32_32x32x16_bf16 v[48:63], v[12:15], a[128:131], v[48:63]
    v_rcp_f32 v96, v96
    v_rcp_f32 v97, v97
    v_rcp_f32 v98, v98
    v_rcp_f32 v99, v99
    ds_read_b64_tr_b16 v[12:13], v6 offset:0
    ds_read_b64_tr_b16 v[14:15], v6 offset:512
    s_waitcnt lgkmcnt(6)
    v_mfma_f32_32x32x16_bf16 v[48:63], v[16:19], a[132:135], v[48:63]
    v_mul_f32 v40, v40, v96
    v_mul_f32 v41, v41, v97
    v_mul_f32 v42, v42, v98
    v_mul_f32 v43, v43, v99
    ds_read_b64_tr_b16 v[16:17], v6 offset:2048
    ds_read_b64_tr_b16 v[18:19], v6 offset:2560
    s_waitcnt lgkmcnt(6)
    v_mfma_f32_32x32x16_bf16 v[48:63], v[20:23], a[136:139], v[48:63]
    v_cvt_pk_bf16_f32 v104, v40, v41
    v_cvt_pk_bf16_f32 v105, v42, v43
    v_mul_f32 v100, v36, v36
    v_mul_f32 v101, v37, v37
    ds_read_b64_tr_b16 v[20:21], v6 offset:4096
    ds_read_b64_tr_b16 v[22:23], v6 offset:4608
    s_waitcnt lgkmcnt(6)
    v_mfma_f32_32x32x16_bf16 v[48:63], v[24:27], a[140:143], v[48:63]
    v_mul_f32 v102, v38, v38
    v_mul_f32 v103, v39, v39
    v_fma_f32 v100, v100, s40, v28
    v_fma_f32 v101, v101, s40, v28
    ds_read_b64_tr_b16 v[24:25], v6 offset:6144
    ds_read_b64_tr_b16 v[26:27], v6 offset:6656
    s_waitcnt lgkmcnt(6)
    v_mfma_f32_32x32x16_bf16 v[64:79], v[12:15], a[96:99], v[64:79]
    v_fma_f32 v102, v102, s40, v28
    v_fma_f32 v103, v103, s40, v28
    v_mul_f32 v100, v100, v36
    v_mul_f32 v101, v101, v37
    ds_read_b64_tr_b16 v[12:13], v6 offset:8192
    ds_read_b64_tr_b16 v[14:15], v6 offset:8704
    s_waitcnt lgkmcnt(6)
    v_mfma_f32_32x32x16_bf16 v[64:79], v[16:19], a[100:103], v[64:79]
    v_mul_f32 v102, v102, v38
    v_mul_f32 v103, v103, v39
    v_exp_f32 v100, v100
    v_exp_f32 v101, v101
    ds_read_b64_tr_b16 v[16:17], v6 offset:10240
    ds_read_b64_tr_b16 v[18:19], v6 offset:10752
    s_waitcnt lgkmcnt(6)
    v_mfma_f32_32x32x16_bf16 v[64:79], v[20:23], a[104:107], v[64:79]
    v_exp_f32 v102, v102
    v_exp_f32 v103, v103
    v_mul_f32 v44, v36, v44
    v_mul_f32 v45, v37, v45
    ds_read_b64_tr_b16 v[20:21], v6 offset:12288
    ds_read_b64_tr_b16 v[22:23], v6 offset:12800
    s_waitcnt lgkmcnt(6)
    v_mfma_f32_32x32x16_bf16 v[64:79], v[24:27], a[108:111], v[64:79]
    v_mul_f32 v46, v38, v46
    v_mul_f32 v47, v39, v47
    v_add_f32 v100, 1.0, v100
    v_add_f32 v101, 1.0, v101
    ds_read_b64_tr_b16 v[24:25], v6 offset:14336
    ds_read_b64_tr_b16 v[26:27], v6 offset:14848
    s_waitcnt lgkmcnt(6)
    v_mfma_f32_32x32x16_bf16 v[64:79], v[12:15], a[112:115], v[64:79]
    v_add_f32 v102, 1.0, v102
    v_add_f32 v103, 1.0, v103
    v_rcp_f32 v100, v100
    v_rcp_f32 v101, v101
    ds_read_b64_tr_b16 v[12:13], v6 offset:16384
    ds_read_b64_tr_b16 v[14:15], v6 offset:16896
    s_waitcnt lgkmcnt(6)
    v_mfma_f32_32x32x16_bf16 v[64:79], v[16:19], a[116:119], v[64:79]
    v_rcp_f32 v102, v102
    v_rcp_f32 v103, v103
    v_mul_f32 v44, v44, v100
    v_mul_f32 v45, v45, v101
    ds_read_b64_tr_b16 v[16:17], v6 offset:18432
    ds_read_b64_tr_b16 v[18:19], v6 offset:18944
    s_waitcnt lgkmcnt(6)
    v_mfma_f32_32x32x16_bf16 v[64:79], v[20:23], a[120:123], v[64:79]
    v_mul_f32 v46, v46, v102
    v_mul_f32 v47, v47, v103
    v_cvt_pk_bf16_f32 v106, v44, v45
    v_cvt_pk_bf16_f32 v107, v46, v47
    ds_read_b64_tr_b16 v[20:21], v6 offset:20480
    ds_read_b64_tr_b16 v[22:23], v6 offset:20992
    s_waitcnt lgkmcnt(6)
    v_mfma_f32_32x32x16_bf16 v[64:79], v[24:27], a[124:127], v[64:79]
    buffer_store_dwordx4 v[104:107], v1, s[16:19], s51 offen offset:0 sc1
    v_mul_f32 v96, v48, v48
    v_mul_f32 v97, v49, v49
    v_mul_f32 v98, v50, v50
    ds_read_b64_tr_b16 v[24:25], v6 offset:22528
    ds_read_b64_tr_b16 v[26:27], v6 offset:23040
    s_waitcnt lgkmcnt(6)
    v_mfma_f32_32x32x16_bf16 v[64:79], v[12:15], a[128:131], v[64:79]
    v_mul_f32 v99, v51, v51
    v_fma_f32 v96, v96, s40, v28
    v_fma_f32 v97, v97, s40, v28
    v_fma_f32 v98, v98, s40, v28
    ds_read_b64_tr_b16 v[12:13], v7 offset:0
    ds_read_b64_tr_b16 v[14:15], v7 offset:512
    s_waitcnt lgkmcnt(6)
    v_mfma_f32_32x32x16_bf16 v[64:79], v[16:19], a[132:135], v[64:79]
    v_fma_f32 v99, v99, s40, v28
    v_mul_f32 v96, v96, v48
    v_mul_f32 v97, v97, v49
    v_mul_f32 v98, v98, v50
    ds_read_b64_tr_b16 v[16:17], v7 offset:2048
    ds_read_b64_tr_b16 v[18:19], v7 offset:2560
    s_waitcnt lgkmcnt(6)
    v_mfma_f32_32x32x16_bf16 v[64:79], v[20:23], a[136:139], v[64:79]
    v_mul_f32 v99, v99, v51
    v_exp_f32 v96, v96
    v_exp_f32 v97, v97
    v_exp_f32 v98, v98
    ds_read_b64_tr_b16 v[20:21], v7 offset:4096
    ds_read_b64_tr_b16 v[22:23], v7 offset:4608
    s_waitcnt lgkmcnt(6)
    v_mfma_f32_32x32x16_bf16 v[64:79], v[24:27], a[140:143], v[64:79]
    v_exp_f32 v99, v99
    v_mul_f32 v56, v48, v56
    v_mul_f32 v57, v49, v57
    v_mul_f32 v58, v50, v58
    ds_read_b64_tr_b16 v[24:25], v7 offset:6144
    ds_read_b64_tr_b16 v[26:27], v7 offset:6656
    s_waitcnt lgkmcnt(6)
    v_mfma_f32_32x32x16_bf16 v[80:95], v[12:15], a[96:99], v[80:95]
    v_mul_f32 v59, v51, v59
    v_add_f32 v96, 1.0, v96
    v_add_f32 v97, 1.0, v97
    v_add_f32 v98, 1.0, v98
    ds_read_b64_tr_b16 v[12:13], v7 offset:8192
    ds_read_b64_tr_b16 v[14:15], v7 offset:8704
    s_waitcnt lgkmcnt(6)
    v_mfma_f32_32x32x16_bf16 v[80:95], v[16:19], a[100:103], v[80:95]
    v_add_f32 v99, 1.0, v99
    v_rcp_f32 v96, v96
    v_rcp_f32 v97, v97
    v_rcp_f32 v98, v98
    ds_read_b64_tr_b16 v[16:17], v7 offset:10240
    ds_read_b64_tr_b16 v[18:19], v7 offset:10752
    s_waitcnt lgkmcnt(6)
    v_mfma_f32_32x32x16_bf16 v[80:95], v[20:23], a[104:107], v[80:95]
    v_rcp_f32 v99, v99
    v_mul_f32 v56, v56, v96
    v_mul_f32 v57, v57, v97
    v_mul_f32 v58, v58, v98
    ds_read_b64_tr_b16 v[20:21], v7 offset:12288
    ds_read_b64_tr_b16 v[22:23], v7 offset:12800
    s_waitcnt lgkmcnt(6)
    v_mfma_f32_32x32x16_bf16 v[80:95], v[24:27], a[108:111], v[80:95]
    v_mul_f32 v59, v59, v99
    v_cvt_pk_bf16_f32 v108, v56, v57
    v_cvt_pk_bf16_f32 v109, v58, v59
    v_mul_f32 v100, v52, v52
    ds_read_b64_tr_b16 v[24:25], v7 offset:14336
    ds_read_b64_tr_b16 v[26:27], v7 offset:14848
    s_waitcnt lgkmcnt(6)
    v_mfma_f32_32x32x16_bf16 v[80:95], v[12:15], a[112:115], v[80:95]
    v_mul_f32 v101, v53, v53
    v_mul_f32 v102, v54, v54
    v_mul_f32 v103, v55, v55
    v_fma_f32 v100, v100, s40, v28
    ds_read_b64_tr_b16 v[12:13], v7 offset:16384
    ds_read_b64_tr_b16 v[14:15], v7 offset:16896
    s_waitcnt lgkmcnt(6)
    v_mfma_f32_32x32x16_bf16 v[80:95], v[16:19], a[116:119], v[80:95]
    v_fma_f32 v101, v101, s40, v28
    v_fma_f32 v102, v102, s40, v28
    v_fma_f32 v103, v103, s40, v28
    v_mul_f32 v100, v100, v52
    ds_read_b64_tr_b16 v[16:17], v7 offset:18432
    ds_read_b64_tr_b16 v[18:19], v7 offset:18944
    s_waitcnt lgkmcnt(6)
    v_mfma_f32_32x32x16_bf16 v[80:95], v[20:23], a[120:123], v[80:95]
    v_mul_f32 v101, v101, v53
    v_mul_f32 v102, v102, v54
    v_mul_f32 v103, v103, v55
    v_exp_f32 v100, v100
    ds_read_b64_tr_b16 v[20:21], v7 offset:20480
    ds_read_b64_tr_b16 v[22:23], v7 offset:20992
    s_waitcnt lgkmcnt(6)
    v_mfma_f32_32x32x16_bf16 v[80:95], v[24:27], a[124:127], v[80:95]
    v_exp_f32 v101, v101
    v_exp_f32 v102, v102
    v_exp_f32 v103, v103
    v_mul_f32 v60, v52, v60
    ds_read_b64_tr_b16 v[24:25], v7 offset:22528
    ds_read_b64_tr_b16 v[26:27], v7 offset:23040
    s_waitcnt lgkmcnt(6)
    v_mfma_f32_32x32x16_bf16 v[80:95], v[12:15], a[128:131], v[80:95]
    v_mul_f32 v61, v53, v61
    v_mul_f32 v62, v54, v62
    v_mul_f32 v63, v55, v63
    v_add_f32 v100, 1.0, v100
    s_waitcnt vmcnt(6) lgkmcnt(0)
    s_barrier
    ds_read_b128 v[12:15], v8 offset:1024
    s_waitcnt lgkmcnt(1)
    v_mfma_f32_32x32x16_bf16 v[80:95], v[16:19], a[132:135], v[80:95]
    v_add_f32 v101, 1.0, v101
    v_add_f32 v102, 1.0, v102
    v_add_f32 v103, 1.0, v103
    v_rcp_f32 v100, v100
    ds_read_b128 v[16:19], v8 offset:4096
    s_waitcnt lgkmcnt(2)
    v_mfma_f32_32x32x16_bf16 v[80:95], v[20:23], a[136:139], v[80:95]
    s_add_u32 m0, s14, 98304
    s_add_u32 s56, s49, 73728
    buffer_load_dwordx4 v1, s[16:19], s56 offen sc1 lds
    v_rcp_f32 v101, v101
    v_rcp_f32 v102, v102
    v_rcp_f32 v103, v103
    v_mul_f32 v60, v60, v100
    ds_read_b128 v[20:23], v8 offset:7168
    s_waitcnt lgkmcnt(3)
    v_mfma_f32_32x32x16_bf16 v[80:95], v[24:27], a[140:143], v[80:95]
    v_mul_f32 v61, v61, v101
    v_mul_f32 v62, v62, v102
    v_mul_f32 v63, v63, v103
    v_cvt_pk_bf16_f32 v110, v60, v61
    ds_read_b128 v[24:27], v8 offset:10240
    s_waitcnt lgkmcnt(3)
    v_mfma_f32_32x32x16_bf16 v[32:47], v[12:15], a[0:3], 0
    s_add_u32 m0, s14, 99328
    s_add_u32 s56, s49, 74752
    buffer_load_dwordx4 v1, s[16:19], s56 offen sc1 lds
    v_cvt_pk_bf16_f32 v111, v62, v63
    buffer_store_dwordx4 v[108:111], v1, s[16:19], s51 offen offset:1024 sc1
    v_mul_f32 v96, v64, v64
    v_mul_f32 v97, v65, v65
    ds_read_b128 v[12:15], v8 offset:13312
    s_waitcnt lgkmcnt(3)
    v_mfma_f32_32x32x16_bf16 v[32:47], v[16:19], a[4:7], v[32:47]
    v_mul_f32 v98, v66, v66
    v_mul_f32 v99, v67, v67
    v_fma_f32 v96, v96, s40, v28
    v_fma_f32 v97, v97, s40, v28
    ds_read_b128 v[16:19], v8 offset:16384
    s_waitcnt lgkmcnt(3)
    v_mfma_f32_32x32x16_bf16 v[32:47], v[20:23], a[8:11], v[32:47]
    s_add_u32 m0, s14, 100352
    s_add_u32 s56, s49, 75776
    buffer_load_dwordx4 v1, s[16:19], s56 offen sc1 lds
    v_fma_f32 v98, v98, s40, v28
    v_fma_f32 v99, v99, s40, v28
    v_mul_f32 v96, v96, v64
    v_mul_f32 v97, v97, v65
    ds_read_b128 v[20:23], v8 offset:19456
    s_waitcnt lgkmcnt(3)
    v_mfma_f32_32x32x16_bf16 v[32:47], v[24:27], a[12:15], v[32:47]
    v_mul_f32 v98, v98, v66
    v_mul_f32 v99, v99, v67
    v_exp_f32 v96, v96
    v_exp_f32 v97, v97
    ds_read_b128 v[24:27], v8 offset:22528
    s_waitcnt lgkmcnt(3)
    v_mfma_f32_32x32x16_bf16 v[32:47], v[12:15], a[16:19], v[32:47]
    s_add_u32 m0, s14, 101376
    s_add_u32 s56, s49, 76800
    buffer_load_dwordx4 v1, s[16:19], s56 offen sc1 lds
    v_exp_f32 v98, v98
    v_exp_f32 v99, v99
    v_mul_f32 v72, v64, v72
    v_mul_f32 v73, v65, v73
    ds_read_b128 v[12:15], v8 offset:25600
    s_waitcnt lgkmcnt(3)
    v_mfma_f32_32x32x16_bf16 v[32:47], v[16:19], a[20:23], v[32:47]
    v_mul_f32 v74, v66, v74
    v_mul_f32 v75, v67, v75
    v_add_f32 v96, 1.0, v96
    v_add_f32 v97, 1.0, v97
    ds_read_b128 v[16:19], v8 offset:28672
    s_waitcnt lgkmcnt(3)
    v_mfma_f32_32x32x16_bf16 v[32:47], v[20:23], a[24:27], v[32:47]
    s_add_u32 m0, s14, 102400
    s_add_u32 s56, s49, 77824
    buffer_load_dwordx4 v1, s[16:19], s56 offen sc1 lds
    v_add_f32 v98, 1.0, v98
    v_add_f32 v99, 1.0, v99
    v_rcp_f32 v96, v96
    v_rcp_f32 v97, v97
    ds_read_b128 v[20:23], v8 offset:31744
    s_waitcnt lgkmcnt(3)
    v_mfma_f32_32x32x16_bf16 v[32:47], v[24:27], a[28:31], v[32:47]
    v_rcp_f32 v98, v98
    v_rcp_f32 v99, v99
    v_mul_f32 v72, v72, v96
    v_mul_f32 v73, v73, v97
    ds_read_b128 v[24:27], v8 offset:34816
    s_waitcnt lgkmcnt(3)
    v_mfma_f32_32x32x16_bf16 v[32:47], v[12:15], a[32:35], v[32:47]
    v_mul_f32 v74, v74, v98
    v_mul_f32 v75, v75, v99
    v_cvt_pk_bf16_f32 v104, v72, v73
    v_cvt_pk_bf16_f32 v105, v74, v75
    ds_read_b128 v[12:15], v8 offset:2048
    s_waitcnt lgkmcnt(3)
    v_mfma_f32_32x32x16_bf16 v[32:47], v[16:19], a[36:39], v[32:47]
    v_mul_f32 v100, v68, v68
    v_mul_f32 v101, v69, v69
    v_mul_f32 v102, v70, v70
    v_mul_f32 v103, v71, v71
    ds_read_b128 v[16:19], v8 offset:5120
    s_waitcnt lgkmcnt(3)
    v_mfma_f32_32x32x16_bf16 v[32:47], v[20:23], a[40:43], v[32:47]
    v_fma_f32 v100, v100, s40, v28
    v_fma_f32 v101, v101, s40, v28
    v_fma_f32 v102, v102, s40, v28
    v_fma_f32 v103, v103, s40, v28
    ds_read_b128 v[20:23], v8 offset:8192
    s_waitcnt lgkmcnt(3)
    v_mfma_f32_32x32x16_bf16 v[32:47], v[24:27], a[44:47], v[32:47]
    v_mul_f32 v100, v100, v68
    v_mul_f32 v101, v101, v69
    v_mul_f32 v102, v102, v70
    v_mul_f32 v103, v103, v71
    ds_read_b128 v[24:27], v8 offset:11264
    s_waitcnt lgkmcnt(3)
    v_mfma_f32_32x32x16_bf16 v[48:63], a[0:3], v[12:15], 0
    v_exp_f32 v100, v100
    v_exp_f32 v101, v101
    v_exp_f32 v102, v102
    v_exp_f32 v103, v103
    ds_read_b128 v[12:15], v8 offset:14336
    s_waitcnt lgkmcnt(3)
    v_mfma_f32_32x32x16_bf16 v[48:63], a[4:7], v[16:19], v[48:63]
    v_mul_f32 v76, v68, v76
    v_mul_f32 v77, v69, v77
    v_mul_f32 v78, v70, v78
    v_mul_f32 v79, v71, v79
    ds_read_b128 v[16:19], v8 offset:17408
    s_waitcnt lgkmcnt(3)
    v_mfma_f32_32x32x16_bf16 v[48:63], a[8:11], v[20:23], v[48:63]
    v_add_f32 v100, 1.0, v100
    v_add_f32 v101, 1.0, v101
    v_add_f32 v102, 1.0, v102
    v_add_f32 v103, 1.0, v103
    ds_read_b128 v[20:23], v8 offset:20480
    s_waitcnt lgkmcnt(3)
    v_mfma_f32_32x32x16_bf16 v[48:63], a[12:15], v[24:27], v[48:63]
    v_rcp_f32 v100, v100
    v_rcp_f32 v101, v101
    v_rcp_f32 v102, v102
    v_rcp_f32 v103, v103
    ds_read_b128 v[24:27], v8 offset:23552
    s_waitcnt lgkmcnt(3)
    v_mfma_f32_32x32x16_bf16 v[48:63], a[16:19], v[12:15], v[48:63]
    v_mul_f32 v76, v76, v100
    v_mul_f32 v77, v77, v101
    v_mul_f32 v78, v78, v102
    v_mul_f32 v79, v79, v103
    ds_read_b128 v[12:15], v8 offset:26624
    s_waitcnt lgkmcnt(3)
    v_mfma_f32_32x32x16_bf16 v[48:63], a[20:23], v[16:19], v[48:63]
    v_cvt_pk_bf16_f32 v106, v76, v77
    v_cvt_pk_bf16_f32 v107, v78, v79
    buffer_store_dwordx4 v[104:107], v1, s[16:19], s51 offen offset:2048 sc1
    v_mul_f32 v96, v80, v80
    ds_read_b128 v[16:19], v8 offset:29696
    s_waitcnt lgkmcnt(3)
    v_mfma_f32_32x32x16_bf16 v[48:63], a[24:27], v[20:23], v[48:63]
    v_mul_f32 v97, v81, v81
    v_mul_f32 v98, v82, v82
    v_mul_f32 v99, v83, v83
    v_fma_f32 v96, v96, s40, v28
    ds_read_b128 v[20:23], v8 offset:32768
    s_waitcnt lgkmcnt(3)
    v_mfma_f32_32x32x16_bf16 v[48:63], a[28:31], v[24:27], v[48:63]
    v_fma_f32 v97, v97, s40, v28
    v_fma_f32 v98, v98, s40, v28
    v_fma_f32 v99, v99, s40, v28
    v_mul_f32 v96, v96, v80
    ds_read_b128 v[24:27], v8 offset:35840
    s_waitcnt lgkmcnt(3)
    v_mfma_f32_32x32x16_bf16 v[48:63], a[32:35], v[12:15], v[48:63]
    v_mul_f32 v97, v97, v81
    v_mul_f32 v98, v98, v82
    v_mul_f32 v99, v99, v83
    v_exp_f32 v96, v96
    ds_read_b128 v[12:15], v8 offset:0
    s_waitcnt lgkmcnt(3)
    v_mfma_f32_32x32x16_bf16 v[48:63], a[36:39], v[16:19], v[48:63]
    v_exp_f32 v97, v97
    v_exp_f32 v98, v98
    v_exp_f32 v99, v99
    v_mul_f32 v88, v80, v88
    ds_read_b128 v[16:19], v8 offset:3072
    s_waitcnt lgkmcnt(3)
    v_mfma_f32_32x32x16_bf16 v[48:63], a[40:43], v[20:23], v[48:63]
    v_mul_f32 v89, v81, v89
    v_mul_f32 v90, v82, v90
    v_mul_f32 v91, v83, v91
    v_add_f32 v96, 1.0, v96
    ds_read_b128 v[20:23], v8 offset:6144
    s_waitcnt lgkmcnt(3)
    v_mfma_f32_32x32x16_bf16 v[48:63], a[44:47], v[24:27], v[48:63]
    v_add_f32 v97, 1.0, v97
    v_add_f32 v98, 1.0, v98
    v_add_f32 v99, 1.0, v99
    v_rcp_f32 v96, v96
    ds_read_b128 v[24:27], v8 offset:9216
    s_waitcnt lgkmcnt(3)
    v_mfma_f32_32x32x16_bf16 v[64:79], v[12:15], a[0:3], 0
    v_rcp_f32 v97, v97
    v_rcp_f32 v98, v98
    v_rcp_f32 v99, v99
    v_mul_f32 v88, v88, v96
    ds_read_b128 v[12:15], v8 offset:12288
    s_waitcnt lgkmcnt(3)
    v_mfma_f32_32x32x16_bf16 v[64:79], v[16:19], a[4:7], v[64:79]
    v_mul_f32 v89, v89, v97
    v_mul_f32 v90, v90, v98
    v_mul_f32 v91, v91, v99
    v_cvt_pk_bf16_f32 v108, v88, v89
    ds_read_b128 v[16:19], v8 offset:15360
    s_waitcnt lgkmcnt(3)
    v_mfma_f32_32x32x16_bf16 v[64:79], v[20:23], a[8:11], v[64:79]
    v_cvt_pk_bf16_f32 v109, v90, v91
    v_mul_f32 v100, v84, v84
    v_mul_f32 v101, v85, v85
    v_mul_f32 v102, v86, v86
    ds_read_b128 v[20:23], v8 offset:18432
    s_waitcnt lgkmcnt(3)
    v_mfma_f32_32x32x16_bf16 v[64:79], v[24:27], a[12:15], v[64:79]
    v_mul_f32 v103, v87, v87
    v_fma_f32 v100, v100, s40, v28
    v_fma_f32 v101, v101, s40, v28
    v_fma_f32 v102, v102, s40, v28
    ds_read_b128 v[24:27], v8 offset:21504
    s_waitcnt lgkmcnt(3)
    v_mfma_f32_32x32x16_bf16 v[64:79], v[12:15], a[16:19], v[64:79]
    v_fma_f32 v103, v103, s40, v28
    v_mul_f32 v100, v100, v84
    v_mul_f32 v101, v101, v85
    v_mul_f32 v102, v102, v86
    ds_read_b128 v[12:15], v8 offset:24576
    s_waitcnt lgkmcnt(3)
    v_mfma_f32_32x32x16_bf16 v[64:79], v[16:19], a[20:23], v[64:79]
    v_mul_f32 v103, v103, v87
    v_exp_f32 v100, v100
    v_exp_f32 v101, v101
    v_exp_f32 v102, v102
    ds_read_b128 v[16:19], v8 offset:27648
    s_waitcnt lgkmcnt(3)
    v_mfma_f32_32x32x16_bf16 v[64:79], v[20:23], a[24:27], v[64:79]
    v_exp_f32 v103, v103
    v_mul_f32 v92, v84, v92
    v_mul_f32 v93, v85, v93
    v_mul_f32 v94, v86, v94
    ds_read_b128 v[20:23], v8 offset:30720
    s_waitcnt lgkmcnt(3)
    v_mfma_f32_32x32x16_bf16 v[64:79], v[24:27], a[28:31], v[64:79]
    v_mul_f32 v95, v87, v95
    v_add_f32 v100, 1.0, v100
    v_add_f32 v101, 1.0, v101
    v_add_f32 v102, 1.0, v102
    ds_read_b128 v[24:27], v8 offset:33792
    s_waitcnt lgkmcnt(3)
    v_mfma_f32_32x32x16_bf16 v[64:79], v[12:15], a[32:35], v[64:79]
    v_add_f32 v103, 1.0, v103
    v_rcp_f32 v100, v100
    v_rcp_f32 v101, v101
    v_rcp_f32 v102, v102
    s_waitcnt vmcnt(8) lgkmcnt(0)
    s_barrier
    v_add_u32 v8, 49152, v8
    ds_read_b128 v[12:15], v8 offset:1024
    s_waitcnt lgkmcnt(1)
    v_mfma_f32_32x32x16_bf16 v[64:79], v[16:19], a[36:39], v[64:79]
    v_rcp_f32 v103, v103
    v_mul_f32 v92, v92, v100
    v_mul_f32 v93, v93, v101
    v_mul_f32 v94, v94, v102
    ds_read_b128 v[16:19], v8 offset:2048
    s_waitcnt lgkmcnt(2)
    v_mfma_f32_32x32x16_bf16 v[64:79], v[20:23], a[40:43], v[64:79]
    s_add_u32 m0, s55, 0
    s_add_u32 s56, s50, 4096
    buffer_load_dwordx4 v2, s[20:23], s56 offen lds
    v_mul_f32 v95, v95, v103
    v_cvt_pk_bf16_f32 v110, v92, v93
    v_cvt_pk_bf16_f32 v111, v94, v95
    buffer_store_dwordx4 v[108:111], v1, s[16:19], s51 offen offset:3072 sc1
    ds_read_b128 v[20:23], v8 offset:0
    s_waitcnt lgkmcnt(3)
    v_mfma_f32_32x32x16_bf16 v[64:79], v[24:27], a[44:47], v[64:79]
    ds_read_b128 v[24:27], v8 offset:4096
    s_waitcnt lgkmcnt(3)
    v_mfma_f32_32x32x16_bf16 v[32:47], v[12:15], a[48:51], v[32:47]
    s_add_u32 m0, s55, 1024
    s_add_u32 s56, s50, 77824
    buffer_load_dwordx4 v2, s[20:23], s56 offen lds
    ds_read_b128 v[12:15], v8 offset:5120
    s_waitcnt lgkmcnt(3)
    v_mfma_f32_32x32x16_bf16 v[48:63], a[48:51], v[16:19], v[48:63]
    ds_read_b128 v[16:19], v8 offset:3072
    s_waitcnt lgkmcnt(3)
    v_mfma_f32_32x32x16_bf16 v[64:79], v[20:23], a[48:51], v[64:79]
    s_add_u32 m0, s55, 2048
    s_add_u32 s56, s50, 151552
    buffer_load_dwordx4 v2, s[20:23], s56 offen lds
    ds_read_b128 v[20:23], v8 offset:7168
    s_waitcnt lgkmcnt(3)
    v_mfma_f32_32x32x16_bf16 v[32:47], v[24:27], a[52:55], v[32:47]
    ds_read_b128 v[24:27], v8 offset:8192
    s_waitcnt lgkmcnt(3)
    v_mfma_f32_32x32x16_bf16 v[48:63], a[52:55], v[12:15], v[48:63]
    s_add_u32 m0, s55, 24576
    s_add_u32 s56, s50, 4096
    buffer_load_dwordx4 v3, s[24:27], s56 offen lds
    ds_read_b128 v[12:15], v8 offset:6144
    s_waitcnt lgkmcnt(3)
    v_mfma_f32_32x32x16_bf16 v[64:79], v[16:19], a[52:55], v[64:79]
    ds_read_b128 v[16:19], v8 offset:10240
    s_waitcnt lgkmcnt(3)
    v_mfma_f32_32x32x16_bf16 v[32:47], v[20:23], a[56:59], v[32:47]
    s_add_u32 m0, s55, 25600
    s_add_u32 s56, s50, 77824
    buffer_load_dwordx4 v3, s[24:27], s56 offen lds
    ds_read_b128 v[20:23], v8 offset:11264
    s_waitcnt lgkmcnt(3)
    v_mfma_f32_32x32x16_bf16 v[48:63], a[56:59], v[24:27], v[48:63]
    ds_read_b128 v[24:27], v8 offset:9216
    s_waitcnt lgkmcnt(3)
    v_mfma_f32_32x32x16_bf16 v[64:79], v[12:15], a[56:59], v[64:79]
    s_add_u32 m0, s55, 26624
    s_add_u32 s56, s50, 151552
    buffer_load_dwordx4 v3, s[24:27], s56 offen lds
    ds_read_b128 v[12:15], v8 offset:13312
    s_waitcnt lgkmcnt(3)
    v_mfma_f32_32x32x16_bf16 v[32:47], v[16:19], a[60:63], v[32:47]
    ds_read_b128 v[16:19], v8 offset:14336
    s_waitcnt lgkmcnt(3)
    v_mfma_f32_32x32x16_bf16 v[48:63], a[60:63], v[20:23], v[48:63]
    ds_read_b128 v[20:23], v8 offset:12288
    s_waitcnt lgkmcnt(3)
    v_mfma_f32_32x32x16_bf16 v[64:79], v[24:27], a[60:63], v[64:79]
    ds_read_b128 v[24:27], v8 offset:16384
    s_waitcnt lgkmcnt(3)
    v_mfma_f32_32x32x16_bf16 v[32:47], v[12:15], a[64:67], v[32:47]
    ds_read_b128 v[12:15], v8 offset:17408
    s_waitcnt lgkmcnt(3)
    v_mfma_f32_32x32x16_bf16 v[48:63], a[64:67], v[16:19], v[48:63]
    ds_read_b128 v[16:19], v8 offset:15360
    s_waitcnt lgkmcnt(3)
    v_mfma_f32_32x32x16_bf16 v[64:79], v[20:23], a[64:67], v[64:79]
    ds_read_b128 v[20:23], v8 offset:19456
    s_waitcnt lgkmcnt(3)
    v_mfma_f32_32x32x16_bf16 v[32:47], v[24:27], a[68:71], v[32:47]
    ds_read_b128 v[24:27], v8 offset:20480
    s_waitcnt lgkmcnt(3)
    v_mfma_f32_32x32x16_bf16 v[48:63], a[68:71], v[12:15], v[48:63]
    ds_read_b128 v[12:15], v8 offset:18432
    s_waitcnt lgkmcnt(3)
    v_mfma_f32_32x32x16_bf16 v[64:79], v[16:19], a[68:71], v[64:79]
    ds_read_b128 v[16:19], v8 offset:22528
    s_waitcnt lgkmcnt(3)
    v_mfma_f32_32x32x16_bf16 v[32:47], v[20:23], a[72:75], v[32:47]
    ds_read_b128 v[20:23], v8 offset:23552
    s_waitcnt lgkmcnt(3)
    v_mfma_f32_32x32x16_bf16 v[48:63], a[72:75], v[24:27], v[48:63]
    ds_read_b128 v[24:27], v8 offset:21504
    s_waitcnt lgkmcnt(3)
    v_mfma_f32_32x32x16_bf16 v[64:79], v[12:15], a[72:75], v[64:79]
    ds_read_b128 v[12:15], v8 offset:25600
    s_waitcnt lgkmcnt(3)
    v_mfma_f32_32x32x16_bf16 v[32:47], v[16:19], a[76:79], v[32:47]
    ds_read_b128 v[16:19], v8 offset:26624
    s_waitcnt lgkmcnt(3)
    v_mfma_f32_32x32x16_bf16 v[48:63], a[76:79], v[20:23], v[48:63]
    ds_read_b128 v[20:23], v8 offset:24576
    s_waitcnt lgkmcnt(3)
    v_mfma_f32_32x32x16_bf16 v[64:79], v[24:27], a[76:79], v[64:79]
    ds_read_b128 v[24:27], v8 offset:28672
    s_waitcnt lgkmcnt(3)
    v_mfma_f32_32x32x16_bf16 v[32:47], v[12:15], a[80:83], v[32:47]
    ds_read_b128 v[12:15], v8 offset:29696
    s_waitcnt lgkmcnt(3)
    v_mfma_f32_32x32x16_bf16 v[48:63], a[80:83], v[16:19], v[48:63]
    ds_read_b128 v[16:19], v8 offset:27648
    s_waitcnt lgkmcnt(3)
    v_mfma_f32_32x32x16_bf16 v[64:79], v[20:23], a[80:83], v[64:79]
    ds_read_b128 v[20:23], v8 offset:31744
    s_waitcnt lgkmcnt(3)
    v_mfma_f32_32x32x16_bf16 v[32:47], v[24:27], a[84:87], v[32:47]
    ds_read_b128 v[24:27], v8 offset:32768
    s_waitcnt lgkmcnt(3)
    v_mfma_f32_32x32x16_bf16 v[48:63], a[84:87], v[12:15], v[48:63]
    ds_read_b128 v[12:15], v8 offset:30720
    s_waitcnt lgkmcnt(3)
    v_mfma_f32_32x32x16_bf16 v[64:79], v[16:19], a[84:87], v[64:79]
    ds_read_b128 v[16:19], v8 offset:34816
    s_waitcnt lgkmcnt(3)
    v_mfma_f32_32x32x16_bf16 v[32:47], v[20:23], a[88:91], v[32:47]
    ds_read_b128 v[20:23], v8 offset:35840
    s_waitcnt lgkmcnt(3)
    v_mfma_f32_32x32x16_bf16 v[48:63], a[88:91], v[24:27], v[48:63]
    ds_read_b128 v[24:27], v8 offset:33792
    s_waitcnt lgkmcnt(3)
    v_mfma_f32_32x32x16_bf16 v[64:79], v[12:15], a[88:91], v[64:79]
    s_waitcnt vmcnt(8) lgkmcnt(0)
    s_barrier
    v_add_u32 v8, 49152, v8
    ds_read_b128 v[12:15], v8 offset:1024
    s_waitcnt lgkmcnt(1)
    v_mfma_f32_32x32x16_bf16 v[32:47], v[16:19], a[92:95], v[32:47]
    ds_read_b128 v[16:19], v8 offset:2048
    s_waitcnt lgkmcnt(2)
    v_mfma_f32_32x32x16_bf16 v[48:63], a[92:95], v[20:23], v[48:63]
    s_add_u32 m0, s55, 49152
    s_add_u32 s56, s50, 1773568
    buffer_load_dwordx4 v2, s[20:23], s56 offen lds
    ds_read_b128 v[20:23], v8 offset:0
    s_waitcnt lgkmcnt(3)
    v_mfma_f32_32x32x16_bf16 v[64:79], v[24:27], a[92:95], v[64:79]
    ds_read_b128 v[24:27], v8 offset:4096
    s_waitcnt lgkmcnt(3)
    v_mfma_f32_32x32x16_bf16 v[32:47], v[12:15], a[96:99], v[32:47]
    s_add_u32 m0, s55, 50176
    s_add_u32 s56, s50, 1847296
    buffer_load_dwordx4 v2, s[20:23], s56 offen lds
    ds_read_b128 v[12:15], v8 offset:5120
    s_waitcnt lgkmcnt(3)
    v_mfma_f32_32x32x16_bf16 v[48:63], a[96:99], v[16:19], v[48:63]
    ds_read_b128 v[16:19], v8 offset:3072
    s_waitcnt lgkmcnt(3)
    v_mfma_f32_32x32x16_bf16 v[64:79], v[20:23], a[96:99], v[64:79]
    s_add_u32 m0, s55, 51200
    s_add_u32 s56, s50, 1921024
    buffer_load_dwordx4 v2, s[20:23], s56 offen lds
    ds_read_b128 v[20:23], v8 offset:7168
    s_waitcnt lgkmcnt(3)
    v_mfma_f32_32x32x16_bf16 v[32:47], v[24:27], a[100:103], v[32:47]
    ds_read_b128 v[24:27], v8 offset:8192
    s_waitcnt lgkmcnt(3)
    v_mfma_f32_32x32x16_bf16 v[48:63], a[100:103], v[12:15], v[48:63]
    s_add_u32 m0, s55, 73728
    s_add_u32 s56, s50, 1773568
    buffer_load_dwordx4 v3, s[24:27], s56 offen lds
    ds_read_b128 v[12:15], v8 offset:6144
    s_waitcnt lgkmcnt(3)
    v_mfma_f32_32x32x16_bf16 v[64:79], v[16:19], a[100:103], v[64:79]
    ds_read_b128 v[16:19], v8 offset:10240
    s_waitcnt lgkmcnt(3)
    v_mfma_f32_32x32x16_bf16 v[32:47], v[20:23], a[104:107], v[32:47]
    s_add_u32 m0, s55, 74752
    s_add_u32 s56, s50, 1847296
    buffer_load_dwordx4 v3, s[24:27], s56 offen lds
    ds_read_b128 v[20:23], v8 offset:11264
    s_waitcnt lgkmcnt(3)
    v_mfma_f32_32x32x16_bf16 v[48:63], a[104:107], v[24:27], v[48:63]
    ds_read_b128 v[24:27], v8 offset:9216
    s_waitcnt lgkmcnt(3)
    v_mfma_f32_32x32x16_bf16 v[64:79], v[12:15], a[104:107], v[64:79]
    s_add_u32 m0, s55, 75776
    s_add_u32 s56, s50, 1921024
    buffer_load_dwordx4 v3, s[24:27], s56 offen lds
    ds_read_b128 v[12:15], v8 offset:13312
    s_waitcnt lgkmcnt(3)
    v_mfma_f32_32x32x16_bf16 v[32:47], v[16:19], a[108:111], v[32:47]
    ds_read_b128 v[16:19], v8 offset:14336
    s_waitcnt lgkmcnt(3)
    v_mfma_f32_32x32x16_bf16 v[48:63], a[108:111], v[20:23], v[48:63]
    ds_read_b128 v[20:23], v8 offset:12288
    s_waitcnt lgkmcnt(3)
    v_mfma_f32_32x32x16_bf16 v[64:79], v[24:27], a[108:111], v[64:79]
    ds_read_b128 v[24:27], v8 offset:16384
    s_waitcnt lgkmcnt(3)
    v_mfma_f32_32x32x16_bf16 v[32:47], v[12:15], a[112:115], v[32:47]
    ds_read_b128 v[12:15], v8 offset:17408
    s_waitcnt lgkmcnt(3)
    v_mfma_f32_32x32x16_bf16 v[48:63], a[112:115], v[16:19], v[48:63]
    ds_read_b128 v[16:19], v8 offset:15360
    s_waitcnt lgkmcnt(3)
    v_mfma_f32_32x32x16_bf16 v[64:79], v[20:23], a[112:115], v[64:79]
    ds_read_b128 v[20:23], v8 offset:19456
    s_waitcnt lgkmcnt(3)
    v_mfma_f32_32x32x16_bf16 v[32:47], v[24:27], a[116:119], v[32:47]
    ds_read_b128 v[24:27], v8 offset:20480
    s_waitcnt lgkmcnt(3)
    v_mfma_f32_32x32x16_bf16 v[48:63], a[116:119], v[12:15], v[48:63]
    ds_read_b128 v[12:15], v8 offset:18432
    s_waitcnt lgkmcnt(3)
    v_mfma_f32_32x32x16_bf16 v[64:79], v[16:19], a[116:119], v[64:79]
    ds_read_b128 v[16:19], v8 offset:22528
    s_waitcnt lgkmcnt(3)
    v_mfma_f32_32x32x16_bf16 v[32:47], v[20:23], a[120:123], v[32:47]
    ds_read_b128 v[20:23], v8 offset:23552
    s_waitcnt lgkmcnt(3)
    v_mfma_f32_32x32x16_bf16 v[48:63], a[120:123], v[24:27], v[48:63]
    ds_read_b128 v[24:27], v8 offset:21504
    s_waitcnt lgkmcnt(3)
    v_mfma_f32_32x32x16_bf16 v[64:79], v[12:15], a[120:123], v[64:79]
    ds_read_b128 v[12:15], v8 offset:25600
    s_waitcnt lgkmcnt(3)
    v_mfma_f32_32x32x16_bf16 v[32:47], v[16:19], a[124:127], v[32:47]
    ds_read_b128 v[16:19], v8 offset:26624
    s_waitcnt lgkmcnt(3)
    v_mfma_f32_32x32x16_bf16 v[48:63], a[124:127], v[20:23], v[48:63]
    ds_read_b128 v[20:23], v8 offset:24576
    s_waitcnt lgkmcnt(3)
    v_mfma_f32_32x32x16_bf16 v[64:79], v[24:27], a[124:127], v[64:79]
    ds_read_b128 v[24:27], v8 offset:28672
    s_waitcnt lgkmcnt(3)
    v_mfma_f32_32x32x16_bf16 v[32:47], v[12:15], a[128:131], v[32:47]
    ds_read_b128 v[12:15], v8 offset:29696
    s_waitcnt lgkmcnt(3)
    v_mfma_f32_32x32x16_bf16 v[48:63], a[128:131], v[16:19], v[48:63]
    ds_read_b128 v[16:19], v8 offset:27648
    s_waitcnt lgkmcnt(3)
    v_mfma_f32_32x32x16_bf16 v[64:79], v[20:23], a[128:131], v[64:79]
    ds_read_b128 v[20:23], v8 offset:31744
    s_waitcnt lgkmcnt(3)
    v_mfma_f32_32x32x16_bf16 v[32:47], v[24:27], a[132:135], v[32:47]
    ds_read_b128 v[24:27], v8 offset:32768
    s_waitcnt lgkmcnt(3)
    v_mfma_f32_32x32x16_bf16 v[48:63], a[132:135], v[12:15], v[48:63]
    ds_read_b128 v[12:15], v8 offset:30720
    s_waitcnt lgkmcnt(3)
    v_mfma_f32_32x32x16_bf16 v[64:79], v[16:19], a[132:135], v[64:79]
    ds_read_b128 v[16:19], v8 offset:34816
    s_waitcnt lgkmcnt(3)
    v_mfma_f32_32x32x16_bf16 v[32:47], v[20:23], a[136:139], v[32:47]
    ds_read_b128 v[20:23], v8 offset:35840
    s_waitcnt lgkmcnt(3)
    v_mfma_f32_32x32x16_bf16 v[48:63], a[136:139], v[24:27], v[48:63]
    ds_read_b128 v[24:27], v8 offset:33792
    s_waitcnt lgkmcnt(3)
    v_mfma_f32_32x32x16_bf16 v[64:79], v[12:15], a[136:139], v[64:79]
    s_waitcnt vmcnt(6) lgkmcnt(0)
    s_barrier
    v_add_u32 v4, 4294868992, v4
    v_add_u32 v5, 4294868992, v5
    v_add_u32 v6, 4294868992, v6
    v_add_u32 v7, 4294868992, v7
    ds_read_b64_tr_b16 v[12:13], v4 offset:0
    ds_read_b64_tr_b16 v[14:15], v4 offset:512
    s_waitcnt lgkmcnt(2)
    v_mfma_f32_32x32x16_bf16 v[32:47], v[16:19], a[140:143], v[32:47]
    ds_read_b64_tr_b16 v[16:17], v4 offset:2048
    ds_read_b64_tr_b16 v[18:19], v4 offset:2560
    s_waitcnt lgkmcnt(4)
    v_mfma_f32_32x32x16_bf16 v[48:63], a[140:143], v[20:23], v[48:63]
    s_add_u32 m0, s55, 98304
    s_add_u32 s56, s50, 3543040
    buffer_load_dwordx4 v2, s[20:23], s56 offen lds
    ds_read_b64_tr_b16 v[20:21], v4 offset:4096
    ds_read_b64_tr_b16 v[22:23], v4 offset:4608
    s_waitcnt lgkmcnt(6)
    v_mfma_f32_32x32x16_bf16 v[64:79], v[24:27], a[140:143], v[64:79]
    ds_read_b64_tr_b16 v[24:25], v4 offset:6144
    ds_read_b64_tr_b16 v[26:27], v4 offset:6656
    s_waitcnt lgkmcnt(6)
    v_mfma_f32_32x32x16_bf16 v[80:95], v[12:15], a[0:3], 0
    s_add_u32 m0, s55, 99328
    s_add_u32 s56, s50, 3616768
    buffer_load_dwordx4 v2, s[20:23], s56 offen lds
    v_pk_mul_f32 v[32:33], v[32:33], s[42:43]
    v_pk_mul_f32 v[34:35], v[34:35], s[42:43]
    v_pk_mul_f32 v[36:37], v[36:37], s[42:43]
    v_pk_mul_f32 v[38:39], v[38:39], s[42:43]
    ds_read_b64_tr_b16 v[12:13], v4 offset:8192
    ds_read_b64_tr_b16 v[14:15], v4 offset:8704
    s_waitcnt lgkmcnt(6)
    v_mfma_f32_32x32x16_bf16 v[80:95], v[16:19], a[4:7], v[80:95]
    v_cvt_pk_bf16_f32 v100, v40, v41
    v_cvt_pk_bf16_f32 v101, v42, v43
    v_cvt_pk_bf16_f32 v102, v44, v45
    v_cvt_pk_bf16_f32 v103, v46, v47
    ds_read_b64_tr_b16 v[16:17], v4 offset:10240
    ds_read_b64_tr_b16 v[18:19], v4 offset:10752
    s_waitcnt lgkmcnt(6)
    v_mfma_f32_32x32x16_bf16 v[80:95], v[20:23], a[8:11], v[80:95]
    s_add_u32 m0, s55, 100352
    s_add_u32 s56, s50, 3690496
    buffer_load_dwordx4 v2, s[20:23], s56 offen lds
    buffer_store_dwordx4 v[100:103], v1, s[16:19], s53 offen offset:0 sc1
    v_cvt_pk_bf16_f32 v96, v32, v33
    v_cvt_pk_bf16_f32 v97, v34, v35
    v_cvt_pk_bf16_f32 v98, v36, v37
    ds_read_b64_tr_b16 v[20:21], v4 offset:12288
    ds_read_b64_tr_b16 v[22:23], v4 offset:12800
    s_waitcnt lgkmcnt(6)
    v_mfma_f32_32x32x16_bf16 v[80:95], v[24:27], a[12:15], v[80:95]
    v_cvt_pk_bf16_f32 v99, v38, v39
    buffer_store_dwordx4 v[96:99], v1, s[16:19], s52 offen offset:0 sc1
    v_pk_mul_f32 v[48:49], v[48:49], v[10:11]
    v_pk_mul_f32 v[50:51], v[50:51], v[10:11]
    ds_read_b64_tr_b16 v[24:25], v4 offset:14336
    ds_read_b64_tr_b16 v[26:27], v4 offset:14848
    s_waitcnt lgkmcnt(6)
    v_mfma_f32_32x32x16_bf16 v[80:95], v[12:15], a[16:19], v[80:95]
    s_add_u32 m0, s55, 122880
    s_add_u32 s56, s50, 3543040
    buffer_load_dwordx4 v3, s[24:27], s56 offen lds
    v_pk_mul_f32 v[52:53], v[52:53], v[10:11]
    v_pk_mul_f32 v[54:55], v[54:55], v[10:11]
    v_pk_mul_f32 v[56:57], v[56:57], v[10:11]
    v_pk_mul_f32 v[58:59], v[58:59], v[10:11]
    ds_read_b64_tr_b16 v[12:13], v4 offset:16384
    ds_read_b64_tr_b16 v[14:15], v4 offset:16896
    s_waitcnt lgkmcnt(6)
    v_mfma_f32_32x32x16_bf16 v[80:95], v[16:19], a[20:23], v[80:95]
    v_pk_mul_f32 v[60:61], v[60:61], v[10:11]
    v_pk_mul_f32 v[62:63], v[62:63], v[10:11]
    v_cvt_pk_bf16_f32 v48, v48, v49
    v_cvt_pk_bf16_f32 v49, v50, v51
    ds_read_b64_tr_b16 v[16:17], v4 offset:18432
    ds_read_b64_tr_b16 v[18:19], v4 offset:18944
    s_waitcnt lgkmcnt(6)
    v_mfma_f32_32x32x16_bf16 v[80:95], v[20:23], a[24:27], v[80:95]
    s_add_u32 m0, s55, 123904
    s_add_u32 s56, s50, 3616768
    buffer_load_dwordx4 v3, s[24:27], s56 offen lds
    v_cvt_pk_bf16_f32 v50, v52, v53
    v_cvt_pk_bf16_f32 v51, v54, v55
    v_cvt_pk_bf16_f32 v52, v56, v57
    v_cvt_pk_bf16_f32 v53, v58, v59
    ds_read_b64_tr_b16 v[20:21], v4 offset:20480
    ds_read_b64_tr_b16 v[22:23], v4 offset:20992
    s_waitcnt lgkmcnt(6)
    v_mfma_f32_32x32x16_bf16 v[80:95], v[24:27], a[28:31], v[80:95]
    v_cvt_pk_bf16_f32 v54, v60, v61
    v_cvt_pk_bf16_f32 v55, v62, v63
    s_mov_b32 exec_lo, 0x0f000000
    s_mov_b32 exec_hi, 0x0f000000
    buffer_store_dwordx2 v[48:49], v9, s[16:19], s54 offen offset:0
    buffer_store_dwordx2 v[50:51], v9, s[16:19], s54 offen offset:16
    buffer_store_dwordx2 v[52:53], v9, s[16:19], s54 offen offset:32
    buffer_store_dwordx2 v[54:55], v9, s[16:19], s54 offen offset:48
    s_mov_b64 exec, -1
    v_cndmask_b32 v56, v48, v29, s[44:45]
    ds_read_b64_tr_b16 v[24:25], v4 offset:22528
    ds_read_b64_tr_b16 v[26:27], v4 offset:23040
    s_waitcnt lgkmcnt(6)
    v_mfma_f32_32x32x16_bf16 v[80:95], v[12:15], a[32:35], v[80:95]
    s_add_u32 m0, s55, 124928
    s_add_u32 s56, s50, 3690496
    buffer_load_dwordx4 v3, s[24:27], s56 offen lds
    v_cndmask_b32 v57, v49, v29, s[44:45]
    v_cndmask_b32 v58, v50, v29, s[44:45]
    v_cndmask_b32 v59, v51, v29, s[44:45]
    v_cndmask_b32 v60, v52, v29, s[44:45]
    ds_read_b64_tr_b16 v[12:13], v5 offset:0
    ds_read_b64_tr_b16 v[14:15], v5 offset:512
    s_waitcnt lgkmcnt(6)
    v_mfma_f32_32x32x16_bf16 v[80:95], v[16:19], a[36:39], v[80:95]
    v_cndmask_b32 v61, v53, v29, s[44:45]
    v_cndmask_b32 v62, v54, v29, s[44:45]
    v_cndmask_b32 v63, v55, v29, s[44:45]
    buffer_store_dwordx4 v[56:59], v1, s[16:19], s53 offen offset:1024 sc1
    ds_read_b64_tr_b16 v[16:17], v5 offset:2048
    ds_read_b64_tr_b16 v[18:19], v5 offset:2560
    s_waitcnt lgkmcnt(6)
    v_mfma_f32_32x32x16_bf16 v[80:95], v[20:23], a[40:43], v[80:95]
    buffer_store_dwordx4 v[60:63], v1, s[16:19], s53 offen offset:2048 sc1
    v_mul_f32 v96, v64, v64
    v_mul_f32 v97, v65, v65
    v_mul_f32 v98, v66, v66
    ds_read_b64_tr_b16 v[20:21], v5 offset:4096
    ds_read_b64_tr_b16 v[22:23], v5 offset:4608
    s_waitcnt lgkmcnt(6)
    v_mfma_f32_32x32x16_bf16 v[80:95], v[24:27], a[44:47], v[80:95]
    v_mul_f32 v99, v67, v67
    v_fma_f32 v96, v96, s40, v28
    v_fma_f32 v97, v97, s40, v28
    v_fma_f32 v98, v98, s40, v28
    ds_read_b64_tr_b16 v[24:25], v5 offset:6144
    ds_read_b64_tr_b16 v[26:27], v5 offset:6656
    s_waitcnt lgkmcnt(6)
    v_mfma_f32_32x32x16_bf16 v[32:47], v[12:15], a[0:3], 0
    v_fma_f32 v99, v99, s40, v28
    v_mul_f32 v96, v96, v64
    v_mul_f32 v97, v97, v65
    v_mul_f32 v98, v98, v66
    ds_read_b64_tr_b16 v[12:13], v5 offset:8192
    ds_read_b64_tr_b16 v[14:15], v5 offset:8704
    s_waitcnt lgkmcnt(6)
    v_mfma_f32_32x32x16_bf16 v[32:47], v[16:19], a[4:7], v[32:47]
    v_mul_f32 v99, v99, v67
    v_exp_f32 v96, v96
    v_exp_f32 v97, v97
    v_exp_f32 v98, v98
    ds_read_b64_tr_b16 v[16:17], v5 offset:10240
    ds_read_b64_tr_b16 v[18:19], v5 offset:10752
    s_waitcnt lgkmcnt(6)
    v_mfma_f32_32x32x16_bf16 v[32:47], v[20:23], a[8:11], v[32:47]
    v_exp_f32 v99, v99
    v_mul_f32 v72, v64, v72
    v_mul_f32 v73, v65, v73
    v_mul_f32 v74, v66, v74
    ds_read_b64_tr_b16 v[20:21], v5 offset:12288
    ds_read_b64_tr_b16 v[22:23], v5 offset:12800
    s_waitcnt lgkmcnt(6)
    v_mfma_f32_32x32x16_bf16 v[32:47], v[24:27], a[12:15], v[32:47]
    v_mul_f32 v75, v67, v75
    v_add_f32 v96, 1.0, v96
    v_add_f32 v97, 1.0, v97
    v_add_f32 v98, 1.0, v98
    ds_read_b64_tr_b16 v[24:25], v5 offset:14336
    ds_read_b64_tr_b16 v[26:27], v5 offset:14848
    s_waitcnt lgkmcnt(6)
    v_mfma_f32_32x32x16_bf16 v[32:47], v[12:15], a[16:19], v[32:47]
    v_add_f32 v99, 1.0, v99
    v_rcp_f32 v96, v96
    v_rcp_f32 v97, v97
    v_rcp_f32 v98, v98
    ds_read_b64_tr_b16 v[12:13], v5 offset:16384
    ds_read_b64_tr_b16 v[14:15], v5 offset:16896
    s_waitcnt lgkmcnt(6)
    v_mfma_f32_32x32x16_bf16 v[32:47], v[16:19], a[20:23], v[32:47]
    v_rcp_f32 v99, v99
    v_mul_f32 v72, v72, v96
    v_mul_f32 v73, v73, v97
    v_mul_f32 v74, v74, v98
    ds_read_b64_tr_b16 v[16:17], v5 offset:18432
    ds_read_b64_tr_b16 v[18:19], v5 offset:18944
    s_waitcnt lgkmcnt(6)
    v_mfma_f32_32x32x16_bf16 v[32:47], v[20:23], a[24:27], v[32:47]
    v_mul_f32 v75, v75, v99
    v_cvt_pk_bf16_f32 v104, v72, v73
    v_cvt_pk_bf16_f32 v105, v74, v75
    v_mul_f32 v100, v68, v68
    ds_read_b64_tr_b16 v[20:21], v5 offset:20480
    ds_read_b64_tr_b16 v[22:23], v5 offset:20992
    s_waitcnt lgkmcnt(6)
    v_mfma_f32_32x32x16_bf16 v[32:47], v[24:27], a[28:31], v[32:47]
    v_mul_f32 v101, v69, v69
    v_mul_f32 v102, v70, v70
    v_mul_f32 v103, v71, v71
    v_fma_f32 v100, v100, s40, v28
    ds_read_b64_tr_b16 v[24:25], v5 offset:22528
    ds_read_b64_tr_b16 v[26:27], v5 offset:23040
    s_waitcnt lgkmcnt(6)
    v_mfma_f32_32x32x16_bf16 v[32:47], v[12:15], a[32:35], v[32:47]
    v_fma_f32 v101, v101, s40, v28
    v_fma_f32 v102, v102, s40, v28
    v_fma_f32 v103, v103, s40, v28
    v_mul_f32 v100, v100, v68
    ds_read_b64_tr_b16 v[12:13], v6 offset:0
    ds_read_b64_tr_b16 v[14:15], v6 offset:512
    s_waitcnt lgkmcnt(6)
    v_mfma_f32_32x32x16_bf16 v[32:47], v[16:19], a[36:39], v[32:47]
    v_mul_f32 v101, v101, v69
    v_mul_f32 v102, v102, v70
    v_mul_f32 v103, v103, v71
    v_exp_f32 v100, v100
    ds_read_b64_tr_b16 v[16:17], v6 offset:2048
    ds_read_b64_tr_b16 v[18:19], v6 offset:2560
    s_waitcnt lgkmcnt(6)
    v_mfma_f32_32x32x16_bf16 v[32:47], v[20:23], a[40:43], v[32:47]
    v_exp_f32 v101, v101
    v_exp_f32 v102, v102
    v_exp_f32 v103, v103
    v_mul_f32 v76, v68, v76
    ds_read_b64_tr_b16 v[20:21], v6 offset:4096
    ds_read_b64_tr_b16 v[22:23], v6 offset:4608
    s_waitcnt lgkmcnt(6)
    v_mfma_f32_32x32x16_bf16 v[32:47], v[24:27], a[44:47], v[32:47]
    v_mul_f32 v77, v69, v77
    v_mul_f32 v78, v70, v78
    v_mul_f32 v79, v71, v79
    v_add_f32 v100, 1.0, v100
    ds_read_b64_tr_b16 v[24:25], v6 offset:6144
    ds_read_b64_tr_b16 v[26:27], v6 offset:6656
    s_waitcnt lgkmcnt(6)
    v_mfma_f32_32x32x16_bf16 v[48:63], v[12:15], a[0:3], 0
    v_add_f32 v101, 1.0, v101
    v_add_f32 v102, 1.0, v102
    v_add_f32 v103, 1.0, v103
    v_rcp_f32 v100, v100
    ds_read_b64_tr_b16 v[12:13], v6 offset:8192
    ds_read_b64_tr_b16 v[14:15], v6 offset:8704
    s_waitcnt lgkmcnt(6)
    v_mfma_f32_32x32x16_bf16 v[48:63], v[16:19], a[4:7], v[48:63]
    v_rcp_f32 v101, v101
    v_rcp_f32 v102, v102
    v_rcp_f32 v103, v103
    v_mul_f32 v76, v76, v100
    ds_read_b64_tr_b16 v[16:17], v6 offset:10240
    ds_read_b64_tr_b16 v[18:19], v6 offset:10752
    s_waitcnt lgkmcnt(6)
    v_mfma_f32_32x32x16_bf16 v[48:63], v[20:23], a[8:11], v[48:63]
    v_mul_f32 v77, v77, v101
    v_mul_f32 v78, v78, v102
    v_mul_f32 v79, v79, v103
    v_cvt_pk_bf16_f32 v106, v76, v77
    ds_read_b64_tr_b16 v[20:21], v6 offset:12288
    ds_read_b64_tr_b16 v[22:23], v6 offset:12800
    s_waitcnt lgkmcnt(6)
    v_mfma_f32_32x32x16_bf16 v[48:63], v[24:27], a[12:15], v[48:63]
    v_cvt_pk_bf16_f32 v107, v78, v79
    buffer_store_dwordx4 v[104:107], v1, s[16:19], s62 offen offset:0 sc1
    ds_read_b64_tr_b16 v[24:25], v6 offset:14336
    ds_read_b64_tr_b16 v[26:27], v6 offset:14848
    s_waitcnt lgkmcnt(6)
    v_mfma_f32_32x32x16_bf16 v[48:63], v[12:15], a[16:19], v[48:63]
    ds_read_b64_tr_b16 v[12:13], v6 offset:16384
    ds_read_b64_tr_b16 v[14:15], v6 offset:16896
    s_waitcnt lgkmcnt(6)
    v_mfma_f32_32x32x16_bf16 v[48:63], v[16:19], a[20:23], v[48:63]
    ds_read_b64_tr_b16 v[16:17], v6 offset:18432
    ds_read_b64_tr_b16 v[18:19], v6 offset:18944
    s_waitcnt lgkmcnt(6)
    v_mfma_f32_32x32x16_bf16 v[48:63], v[20:23], a[24:27], v[48:63]
    ds_read_b64_tr_b16 v[20:21], v6 offset:20480
    ds_read_b64_tr_b16 v[22:23], v6 offset:20992
    s_waitcnt lgkmcnt(6)
    v_mfma_f32_32x32x16_bf16 v[48:63], v[24:27], a[28:31], v[48:63]
    ds_read_b64_tr_b16 v[24:25], v6 offset:22528
    ds_read_b64_tr_b16 v[26:27], v6 offset:23040
    s_waitcnt lgkmcnt(6)
    v_mfma_f32_32x32x16_bf16 v[48:63], v[12:15], a[32:35], v[48:63]
    ds_read_b64_tr_b16 v[12:13], v7 offset:0
    ds_read_b64_tr_b16 v[14:15], v7 offset:512
    s_waitcnt lgkmcnt(6)
    v_mfma_f32_32x32x16_bf16 v[48:63], v[16:19], a[36:39], v[48:63]
    ds_read_b64_tr_b16 v[16:17], v7 offset:2048
    ds_read_b64_tr_b16 v[18:19], v7 offset:2560
    s_waitcnt lgkmcnt(6)
    v_mfma_f32_32x32x16_bf16 v[48:63], v[20:23], a[40:43], v[48:63]
    ds_read_b64_tr_b16 v[20:21], v7 offset:4096
    ds_read_b64_tr_b16 v[22:23], v7 offset:4608
    s_waitcnt lgkmcnt(6)
    v_mfma_f32_32x32x16_bf16 v[48:63], v[24:27], a[44:47], v[48:63]
    ds_read_b64_tr_b16 v[24:25], v7 offset:6144
    ds_read_b64_tr_b16 v[26:27], v7 offset:6656
    s_waitcnt lgkmcnt(6)
    v_mfma_f32_32x32x16_bf16 v[64:79], v[12:15], a[0:3], 0
    ds_read_b64_tr_b16 v[12:13], v7 offset:8192
    ds_read_b64_tr_b16 v[14:15], v7 offset:8704
    s_waitcnt lgkmcnt(6)
    v_mfma_f32_32x32x16_bf16 v[64:79], v[16:19], a[4:7], v[64:79]
    ds_read_b64_tr_b16 v[16:17], v7 offset:10240
    ds_read_b64_tr_b16 v[18:19], v7 offset:10752
    s_waitcnt lgkmcnt(6)
    v_mfma_f32_32x32x16_bf16 v[64:79], v[20:23], a[8:11], v[64:79]
    ds_read_b64_tr_b16 v[20:21], v7 offset:12288
    ds_read_b64_tr_b16 v[22:23], v7 offset:12800
    s_waitcnt lgkmcnt(6)
    v_mfma_f32_32x32x16_bf16 v[64:79], v[24:27], a[12:15], v[64:79]
    ds_read_b64_tr_b16 v[24:25], v7 offset:14336
    ds_read_b64_tr_b16 v[26:27], v7 offset:14848
    s_waitcnt lgkmcnt(6)
    v_mfma_f32_32x32x16_bf16 v[64:79], v[12:15], a[16:19], v[64:79]
    ds_read_b64_tr_b16 v[12:13], v7 offset:16384
    ds_read_b64_tr_b16 v[14:15], v7 offset:16896
    s_waitcnt lgkmcnt(6)
    v_mfma_f32_32x32x16_bf16 v[64:79], v[16:19], a[20:23], v[64:79]
    ds_read_b64_tr_b16 v[16:17], v7 offset:18432
    ds_read_b64_tr_b16 v[18:19], v7 offset:18944
    s_waitcnt lgkmcnt(6)
    v_mfma_f32_32x32x16_bf16 v[64:79], v[20:23], a[24:27], v[64:79]
    ds_read_b64_tr_b16 v[20:21], v7 offset:20480
    ds_read_b64_tr_b16 v[22:23], v7 offset:20992
    s_waitcnt lgkmcnt(6)
    v_mfma_f32_32x32x16_bf16 v[64:79], v[24:27], a[28:31], v[64:79]
    ds_read_b64_tr_b16 v[24:25], v7 offset:22528
    ds_read_b64_tr_b16 v[26:27], v7 offset:23040
    s_waitcnt lgkmcnt(6)
    v_mfma_f32_32x32x16_bf16 v[64:79], v[12:15], a[32:35], v[64:79]
    s_waitcnt vmcnt(15) lgkmcnt(0)
    s_barrier
    v_add_u32 v4, 49152, v4
    v_add_u32 v5, 49152, v5
    v_add_u32 v6, 49152, v6
    v_add_u32 v7, 49152, v7
    ds_read_b64_tr_b16 v[12:13], v4 offset:0
    ds_read_b64_tr_b16 v[14:15], v4 offset:512
    s_waitcnt lgkmcnt(2)
    v_mfma_f32_32x32x16_bf16 v[64:79], v[16:19], a[36:39], v[64:79]
    ds_read_b64_tr_b16 v[16:17], v4 offset:2048
    ds_read_b64_tr_b16 v[18:19], v4 offset:2560
    s_waitcnt lgkmcnt(4)
    v_mfma_f32_32x32x16_bf16 v[64:79], v[20:23], a[40:43], v[64:79]
    s_and_b32 s57, s3, 3
    s_lshl_b32 s57, s57, 13
    s_getpc_b64 s[46:47]
LT_B:
    s_add_u32 s46, s46, attn_down_kernel-LT_B
    s_addc_u32 s47, s47, 0
    v_lshl_add_u32 v96, v1, 3, s57
    v_min_u32 v96, LC_end-attn_down_kernel, v96
    v_mov_b32 v97, s47
    v_add_co_u32 v96, vcc, s46, v96
    s_nop 1
    v_addc_co_u32 v97, vcc, 0, v97, vcc
    global_load_dword v0, v[96:97], off
    s_mov_b64 exec, 0x1fffff
    buffer_load_dword v0, v31, s[28:31], 0 offen
    s_mov_b64 exec, -1
    ds_read_b64_tr_b16 v[20:21], v4 offset:4096
    ds_read_b64_tr_b16 v[22:23], v4 offset:4608
    s_waitcnt lgkmcnt(6)
    v_mfma_f32_32x32x16_bf16 v[64:79], v[24:27], a[44:47], v[64:79]
    ds_read_b64_tr_b16 v[24:25], v4 offset:6144
    ds_read_b64_tr_b16 v[26:27], v4 offset:6656
    s_waitcnt lgkmcnt(6)
    v_mfma_f32_32x32x16_bf16 v[80:95], v[12:15], a[48:51], v[80:95]
    ds_read_b64_tr_b16 v[12:13], v4 offset:8192
    ds_read_b64_tr_b16 v[14:15], v4 offset:8704
    s_waitcnt lgkmcnt(6)
    v_mfma_f32_32x32x16_bf16 v[80:95], v[16:19], a[52:55], v[80:95]
    ds_read_b64_tr_b16 v[16:17], v4 offset:10240
    ds_read_b64_tr_b16 v[18:19], v4 offset:10752
    s_waitcnt lgkmcnt(6)
    v_mfma_f32_32x32x16_bf16 v[80:95], v[20:23], a[56:59], v[80:95]
    ds_read_b64_tr_b16 v[20:21], v4 offset:12288
    ds_read_b64_tr_b16 v[22:23], v4 offset:12800
    s_waitcnt lgkmcnt(6)
    v_mfma_f32_32x32x16_bf16 v[80:95], v[24:27], a[60:63], v[80:95]
    ds_read_b64_tr_b16 v[24:25], v4 offset:14336
    ds_read_b64_tr_b16 v[26:27], v4 offset:14848
    s_waitcnt lgkmcnt(6)
    v_mfma_f32_32x32x16_bf16 v[80:95], v[12:15], a[64:67], v[80:95]
    ds_read_b64_tr_b16 v[12:13], v4 offset:16384
    ds_read_b64_tr_b16 v[14:15], v4 offset:16896
    s_waitcnt lgkmcnt(6)
    v_mfma_f32_32x32x16_bf16 v[80:95], v[16:19], a[68:71], v[80:95]
    ds_read_b64_tr_b16 v[16:17], v4 offset:18432
    ds_read_b64_tr_b16 v[18:19], v4 offset:18944
    s_waitcnt lgkmcnt(6)
    v_mfma_f32_32x32x16_bf16 v[80:95], v[20:23], a[72:75], v[80:95]
    ds_read_b64_tr_b16 v[20:21], v4 offset:20480
    ds_read_b64_tr_b16 v[22:23], v4 offset:20992
    s_waitcnt lgkmcnt(6)
    v_mfma_f32_32x32x16_bf16 v[80:95], v[24:27], a[76:79], v[80:95]
    ds_read_b64_tr_b16 v[24:25], v4 offset:22528
    ds_read_b64_tr_b16 v[26:27], v4 offset:23040
    s_waitcnt lgkmcnt(6)
    v_mfma_f32_32x32x16_bf16 v[80:95], v[12:15], a[80:83], v[80:95]
    ds_read_b64_tr_b16 v[12:13], v5 offset:0
    ds_read_b64_tr_b16 v[14:15], v5 offset:512
    s_waitcnt lgkmcnt(6)
    v_mfma_f32_32x32x16_bf16 v[80:95], v[16:19], a[84:87], v[80:95]
    ds_read_b64_tr_b16 v[16:17], v5 offset:2048
    ds_read_b64_tr_b16 v[18:19], v5 offset:2560
    s_waitcnt lgkmcnt(6)
    v_mfma_f32_32x32x16_bf16 v[80:95], v[20:23], a[88:91], v[80:95]
    ds_read_b64_tr_b16 v[20:21], v5 offset:4096
    ds_read_b64_tr_b16 v[22:23], v5 offset:4608
    s_waitcnt lgkmcnt(6)
    v_mfma_f32_32x32x16_bf16 v[80:95], v[24:27], a[92:95], v[80:95]
    ds_read_b64_tr_b16 v[24:25], v5 offset:6144
    ds_read_b64_tr_b16 v[26:27], v5 offset:6656
    s_waitcnt lgkmcnt(6)
    v_mfma_f32_32x32x16_bf16 v[32:47], v[12:15], a[48:51], v[32:47]
    ds_read_b64_tr_b16 v[12:13], v5 offset:8192
    ds_read_b64_tr_b16 v[14:15], v5 offset:8704
    s_waitcnt lgkmcnt(6)
    v_mfma_f32_32x32x16_bf16 v[32:47], v[16:19], a[52:55], v[32:47]
    ds_read_b64_tr_b16 v[16:17], v5 offset:10240
    ds_read_b64_tr_b16 v[18:19], v5 offset:10752
    s_waitcnt lgkmcnt(6)
    v_mfma_f32_32x32x16_bf16 v[32:47], v[20:23], a[56:59], v[32:47]
    ds_read_b64_tr_b16 v[20:21], v5 offset:12288
    ds_read_b64_tr_b16 v[22:23], v5 offset:12800
    s_waitcnt lgkmcnt(6)
    v_mfma_f32_32x32x16_bf16 v[32:47], v[24:27], a[60:63], v[32:47]
    ds_read_b64_tr_b16 v[24:25], v5 offset:14336
    ds_read_b64_tr_b16 v[26:27], v5 offset:14848
    s_waitcnt lgkmcnt(6)
    v_mfma_f32_32x32x16_bf16 v[32:47], v[12:15], a[64:67], v[32:47]
    ds_read_b64_tr_b16 v[12:13], v5 offset:16384
    ds_read_b64_tr_b16 v[14:15], v5 offset:16896
    s_waitcnt lgkmcnt(6)
    v_mfma_f32_32x32x16_bf16 v[32:47], v[16:19], a[68:71], v[32:47]
    ds_read_b64_tr_b16 v[16:17], v5 offset:18432
    ds_read_b64_tr_b16 v[18:19], v5 offset:18944
    s_waitcnt lgkmcnt(6)
    v_mfma_f32_32x32x16_bf16 v[32:47], v[20:23], a[72:75], v[32:47]
    ds_read_b64_tr_b16 v[20:21], v5 offset:20480
    ds_read_b64_tr_b16 v[22:23], v5 offset:20992
    s_waitcnt lgkmcnt(6)
    v_mfma_f32_32x32x16_bf16 v[32:47], v[24:27], a[76:79], v[32:47]
    ds_read_b64_tr_b16 v[24:25], v5 offset:22528
    ds_read_b64_tr_b16 v[26:27], v5 offset:23040
    s_waitcnt lgkmcnt(6)
    v_mfma_f32_32x32x16_bf16 v[32:47], v[12:15], a[80:83], v[32:47]
    ds_read_b64_tr_b16 v[12:13], v6 offset:0
    ds_read_b64_tr_b16 v[14:15], v6 offset:512
    s_waitcnt lgkmcnt(6)
    v_mfma_f32_32x32x16_bf16 v[32:47], v[16:19], a[84:87], v[32:47]
    ds_read_b64_tr_b16 v[16:17], v6 offset:2048
    ds_read_b64_tr_b16 v[18:19], v6 offset:2560
    s_waitcnt lgkmcnt(6)
    v_mfma_f32_32x32x16_bf16 v[32:47], v[20:23], a[88:91], v[32:47]
    ds_read_b64_tr_b16 v[20:21], v6 offset:4096
    ds_read_b64_tr_b16 v[22:23], v6 offset:4608
    s_waitcnt lgkmcnt(6)
    v_mfma_f32_32x32x16_bf16 v[32:47], v[24:27], a[92:95], v[32:47]
    ds_read_b64_tr_b16 v[24:25], v6 offset:6144
    ds_read_b64_tr_b16 v[26:27], v6 offset:6656
    s_waitcnt lgkmcnt(6)
    v_mfma_f32_32x32x16_bf16 v[48:63], v[12:15], a[48:51], v[48:63]
    ds_read_b64_tr_b16 v[12:13], v6 offset:8192
    ds_read_b64_tr_b16 v[14:15], v6 offset:8704
    s_waitcnt lgkmcnt(6)
    v_mfma_f32_32x32x16_bf16 v[48:63], v[16:19], a[52:55], v[48:63]
    ds_read_b64_tr_b16 v[16:17], v6 offset:10240
    ds_read_b64_tr_b16 v[18:19], v6 offset:10752
    s_waitcnt lgkmcnt(6)
    v_mfma_f32_32x32x16_bf16 v[48:63], v[20:23], a[56:59], v[48:63]
    ds_read_b64_tr_b16 v[20:21], v6 offset:12288
    ds_read_b64_tr_b16 v[22:23], v6 offset:12800
    s_waitcnt lgkmcnt(6)
    v_mfma_f32_32x32x16_bf16 v[48:63], v[24:27], a[60:63], v[48:63]
    ds_read_b64_tr_b16 v[24:25], v6 offset:14336
    ds_read_b64_tr_b16 v[26:27], v6 offset:14848
    s_waitcnt lgkmcnt(6)
    v_mfma_f32_32x32x16_bf16 v[48:63], v[12:15], a[64:67], v[48:63]
    ds_read_b64_tr_b16 v[12:13], v6 offset:16384
    ds_read_b64_tr_b16 v[14:15], v6 offset:16896
    s_waitcnt lgkmcnt(6)
    v_mfma_f32_32x32x16_bf16 v[48:63], v[16:19], a[68:71], v[48:63]
    ds_read_b64_tr_b16 v[16:17], v6 offset:18432
    ds_read_b64_tr_b16 v[18:19], v6 offset:18944
    s_waitcnt lgkmcnt(6)
    v_mfma_f32_32x32x16_bf16 v[48:63], v[20:23], a[72:75], v[48:63]
    ds_read_b64_tr_b16 v[20:21], v6 offset:20480
    ds_read_b64_tr_b16 v[22:23], v6 offset:20992
    s_waitcnt lgkmcnt(6)
    v_mfma_f32_32x32x16_bf16 v[48:63], v[24:27], a[76:79], v[48:63]
    ds_read_b64_tr_b16 v[24:25], v6 offset:22528
    ds_read_b64_tr_b16 v[26:27], v6 offset:23040
    s_waitcnt lgkmcnt(6)
    v_mfma_f32_32x32x16_bf16 v[48:63], v[12:15], a[80:83], v[48:63]
    ds_read_b64_tr_b16 v[12:13], v7 offset:0
    ds_read_b64_tr_b16 v[14:15], v7 offset:512
    s_waitcnt lgkmcnt(6)
    v_mfma_f32_32x32x16_bf16 v[48:63], v[16:19], a[84:87], v[48:63]
    ds_read_b64_tr_b16 v[16:17], v7 offset:2048
    ds_read_b64_tr_b16 v[18:19], v7 offset:2560
    s_waitcnt lgkmcnt(6)
    v_mfma_f32_32x32x16_bf16 v[48:63], v[20:23], a[88:91], v[48:63]
    ds_read_b64_tr_b16 v[20:21], v7 offset:4096
    ds_read_b64_tr_b16 v[22:23], v7 offset:4608
    s_waitcnt lgkmcnt(6)
    v_mfma_f32_32x32x16_bf16 v[48:63], v[24:27], a[92:95], v[48:63]
    ds_read_b64_tr_b16 v[24:25], v7 offset:6144
    ds_read_b64_tr_b16 v[26:27], v7 offset:6656
    s_waitcnt lgkmcnt(6)
    v_mfma_f32_32x32x16_bf16 v[64:79], v[12:15], a[48:51], v[64:79]
    ds_read_b64_tr_b16 v[12:13], v7 offset:8192
    ds_read_b64_tr_b16 v[14:15], v7 offset:8704
    s_waitcnt lgkmcnt(6)
    v_mfma_f32_32x32x16_bf16 v[64:79], v[16:19], a[52:55], v[64:79]
    ds_read_b64_tr_b16 v[16:17], v7 offset:10240
    ds_read_b64_tr_b16 v[18:19], v7 offset:10752
    s_waitcnt lgkmcnt(6)
    v_mfma_f32_32x32x16_bf16 v[64:79], v[20:23], a[56:59], v[64:79]
    ds_read_b64_tr_b16 v[20:21], v7 offset:12288
    ds_read_b64_tr_b16 v[22:23], v7 offset:12800
    s_waitcnt lgkmcnt(6)
    v_mfma_f32_32x32x16_bf16 v[64:79], v[24:27], a[60:63], v[64:79]
    ds_read_b64_tr_b16 v[24:25], v7 offset:14336
    ds_read_b64_tr_b16 v[26:27], v7 offset:14848
    s_waitcnt lgkmcnt(6)
    v_mfma_f32_32x32x16_bf16 v[64:79], v[12:15], a[64:67], v[64:79]
    ds_read_b64_tr_b16 v[12:13], v7 offset:16384
    ds_read_b64_tr_b16 v[14:15], v7 offset:16896
    s_waitcnt lgkmcnt(6)
    v_mfma_f32_32x32x16_bf16 v[64:79], v[16:19], a[68:71], v[64:79]
    ds_read_b64_tr_b16 v[16:17], v7 offset:18432
    ds_read_b64_tr_b16 v[18:19], v7 offset:18944
    s_waitcnt lgkmcnt(6)
    v_mfma_f32_32x32x16_bf16 v[64:79], v[20:23], a[72:75], v[64:79]
    ds_read_b64_tr_b16 v[20:21], v7 offset:20480
    ds_read_b64_tr_b16 v[22:23], v7 offset:20992
    s_waitcnt lgkmcnt(6)
    v_mfma_f32_32x32x16_bf16 v[64:79], v[24:27], a[76:79], v[64:79]
    ds_read_b64_tr_b16 v[24:25], v7 offset:22528
    ds_read_b64_tr_b16 v[26:27], v7 offset:23040
    s_waitcnt lgkmcnt(6)
    v_mfma_f32_32x32x16_bf16 v[64:79], v[12:15], a[80:83], v[64:79]
    s_waitcnt vmcnt(5) lgkmcnt(0)
    s_barrier
    v_add_u32 v4, 49152, v4
    v_add_u32 v5, 49152, v5
    v_add_u32 v6, 49152, v6
    v_add_u32 v7, 49152, v7
    ds_read_b64_tr_b16 v[12:13], v4 offset:0
    ds_read_b64_tr_b16 v[14:15], v4 offset:512
    s_waitcnt lgkmcnt(2)
    v_mfma_f32_32x32x16_bf16 v[64:79], v[16:19], a[84:87], v[64:79]
    ds_read_b64_tr_b16 v[16:17], v4 offset:2048
    ds_read_b64_tr_b16 v[18:19], v4 offset:2560
    s_waitcnt lgkmcnt(4)
    v_mfma_f32_32x32x16_bf16 v[64:79], v[20:23], a[88:91], v[64:79]
    ds_read_b64_tr_b16 v[20:21], v4 offset:4096
    ds_read_b64_tr_b16 v[22:23], v4 offset:4608
    s_waitcnt lgkmcnt(6)
    v_mfma_f32_32x32x16_bf16 v[64:79], v[24:27], a[92:95], v[64:79]
    ds_read_b64_tr_b16 v[24:25], v4 offset:6144
    ds_read_b64_tr_b16 v[26:27], v4 offset:6656
    s_waitcnt lgkmcnt(6)
    v_mfma_f32_32x32x16_bf16 v[80:95], v[12:15], a[96:99], v[80:95]
    ds_read_b64_tr_b16 v[12:13], v4 offset:8192
    ds_read_b64_tr_b16 v[14:15], v4 offset:8704
    s_waitcnt lgkmcnt(6)
    v_mfma_f32_32x32x16_bf16 v[80:95], v[16:19], a[100:103], v[80:95]
    ds_read_b64_tr_b16 v[16:17], v4 offset:10240
    ds_read_b64_tr_b16 v[18:19], v4 offset:10752
    s_waitcnt lgkmcnt(6)
    v_mfma_f32_32x32x16_bf16 v[80:95], v[20:23], a[104:107], v[80:95]
    ds_read_b64_tr_b16 v[20:21], v4 offset:12288
    ds_read_b64_tr_b16 v[22:23], v4 offset:12800
    s_waitcnt lgkmcnt(6)
    v_mfma_f32_32x32x16_bf16 v[80:95], v[24:27], a[108:111], v[80:95]
    ds_read_b64_tr_b16 v[24:25], v4 offset:14336
    ds_read_b64_tr_b16 v[26:27], v4 offset:14848
    s_waitcnt lgkmcnt(6)
    v_mfma_f32_32x32x16_bf16 v[80:95], v[12:15], a[112:115], v[80:95]
    ds_read_b64_tr_b16 v[12:13], v4 offset:16384
    ds_read_b64_tr_b16 v[14:15], v4 offset:16896
    s_waitcnt lgkmcnt(6)
    v_mfma_f32_32x32x16_bf16 v[80:95], v[16:19], a[116:119], v[80:95]
    ds_read_b64_tr_b16 v[16:17], v4 offset:18432
    ds_read_b64_tr_b16 v[18:19], v4 offset:18944
    s_waitcnt lgkmcnt(6)
    v_mfma_f32_32x32x16_bf16 v[80:95], v[20:23], a[120:123], v[80:95]
    ds_read_b64_tr_b16 v[20:21], v4 offset:20480
    ds_read_b64_tr_b16 v[22:23], v4 offset:20992
    s_waitcnt lgkmcnt(6)
    v_mfma_f32_32x32x16_bf16 v[80:95], v[24:27], a[124:127], v[80:95]
    ds_read_b64_tr_b16 v[24:25], v4 offset:22528
    ds_read_b64_tr_b16 v[26:27], v4 offset:23040
    s_waitcnt lgkmcnt(6)
    v_mfma_f32_32x32x16_bf16 v[80:95], v[12:15], a[128:131], v[80:95]
    ds_read_b64_tr_b16 v[12:13], v5 offset:0
    ds_read_b64_tr_b16 v[14:15], v5 offset:512
    s_waitcnt lgkmcnt(6)
    v_mfma_f32_32x32x16_bf16 v[80:95], v[16:19], a[132:135], v[80:95]
    ds_read_b64_tr_b16 v[16:17], v5 offset:2048
    ds_read_b64_tr_b16 v[18:19], v5 offset:2560
    s_waitcnt lgkmcnt(6)
    v_mfma_f32_32x32x16_bf16 v[80:95], v[20:23], a[136:139], v[80:95]
    ds_read_b64_tr_b16 v[20:21], v5 offset:4096
    ds_read_b64_tr_b16 v[22:23], v5 offset:4608
    s_waitcnt lgkmcnt(6)
    v_mfma_f32_32x32x16_bf16 v[80:95], v[24:27], a[140:143], v[80:95]
    ds_read_b64_tr_b16 v[24:25], v5 offset:6144
    ds_read_b64_tr_b16 v[26:27], v5 offset:6656
    s_waitcnt lgkmcnt(6)
    v_mfma_f32_32x32x16_bf16 v[32:47], v[12:15], a[96:99], v[32:47]
    ds_read_b64_tr_b16 v[12:13], v5 offset:8192
    ds_read_b64_tr_b16 v[14:15], v5 offset:8704
    s_waitcnt lgkmcnt(6)
    v_mfma_f32_32x32x16_bf16 v[32:47], v[16:19], a[100:103], v[32:47]
    ds_read_b64_tr_b16 v[16:17], v5 offset:10240
    ds_read_b64_tr_b16 v[18:19], v5 offset:10752
    s_waitcnt lgkmcnt(6)
    v_mfma_f32_32x32x16_bf16 v[32:47], v[20:23], a[104:107], v[32:47]
    v_mul_f32 v96, v80, v80
    v_mul_f32 v97, v81, v81
    v_mul_f32 v98, v82, v82
    v_mul_f32 v99, v83, v83
    ds_read_b64_tr_b16 v[20:21], v5 offset:12288
    ds_read_b64_tr_b16 v[22:23], v5 offset:12800
    s_waitcnt lgkmcnt(6)
    v_mfma_f32_32x32x16_bf16 v[32:47], v[24:27], a[108:111], v[32:47]
    v_fma_f32 v96, v96, s40, v28
    v_fma_f32 v97, v97, s40, v28
    v_fma_f32 v98, v98, s40, v28
    v_fma_f32 v99, v99, s40, v28
    ds_read_b64_tr_b16 v[24:25], v5 offset:14336
    ds_read_b64_tr_b16 v[26:27], v5 offset:14848
    s_waitcnt lgkmcnt(6)
    v_mfma_f32_32x32x16_bf16 v[32:47], v[12:15], a[112:115], v[32:47]
    v_mul_f32 v96, v96, v80
    v_mul_f32 v97, v97, v81
    v_mul_f32 v98, v98, v82
    v_mul_f32 v99, v99, v83
    ds_read_b64_tr_b16 v[12:13], v5 offset:16384
    ds_read_b64_tr_b16 v[14:15], v5 offset:16896
    s_waitcnt lgkmcnt(6)
    v_mfma_f32_32x32x16_bf16 v[32:47], v[16:19], a[116:119], v[32:47]
    v_exp_f32 v96, v96
    v_exp_f32 v97, v97
    v_exp_f32 v98, v98
    v_exp_f32 v99, v99
    ds_read_b64_tr_b16 v[16:17], v5 offset:18432
    ds_read_b64_tr_b16 v[18:19], v5 offset:18944
    s_waitcnt lgkmcnt(6)
    v_mfma_f32_32x32x16_bf16 v[32:47], v[20:23], a[120:123], v[32:47]
    v_mul_f32 v88, v80, v88
    v_mul_f32 v89, v81, v89
    v_mul_f32 v90, v82, v90
    v_mul_f32 v91, v83, v91
    ds_read_b64_tr_b16 v[20:21], v5 offset:20480
    ds_read_b64_tr_b16 v[22:23], v5 offset:20992
    s_waitcnt lgkmcnt(6)
    v_mfma_f32_32x32x16_bf16 v[32:47], v[24:27], a[124:127], v[32:47]
    v_add_f32 v96, 1.0, v96
    v_add_f32 v97, 1.0, v97
    v_add_f32 v98, 1.0, v98
    v_add_f32 v99, 1.0, v99
    ds_read_b64_tr_b16 v[24:25], v5 offset:22528
    ds_read_b64_tr_b16 v[26:27], v5 offset:23040
    s_waitcnt lgkmcnt(6)
    v_mfma_f32_32x32x16_bf16 v[32:47], v[12:15], a[128:131], v[32:47]
    v_rcp_f32 v96, v96
    v_rcp_f32 v97, v97
    v_rcp_f32 v98, v98
    v_rcp_f32 v99, v99
    ds_read_b64_tr_b16 v[12:13], v6 offset:0
    ds_read_b64_tr_b16 v[14:15], v6 offset:512
    s_waitcnt lgkmcnt(6)
    v_mfma_f32_32x32x16_bf16 v[32:47], v[16:19], a[132:135], v[32:47]
    v_mul_f32 v88, v88, v96
    v_mul_f32 v89, v89, v97
    v_mul_f32 v90, v90, v98
    v_mul_f32 v91, v91, v99
    ds_read_b64_tr_b16 v[16:17], v6 offset:2048
    ds_read_b64_tr_b16 v[18:19], v6 offset:2560
    s_waitcnt lgkmcnt(6)
    v_mfma_f32_32x32x16_bf16 v[32:47], v[20:23], a[136:139], v[32:47]
    v_cvt_pk_bf16_f32 v108, v88, v89
    v_cvt_pk_bf16_f32 v109, v90, v91
    v_mul_f32 v100, v84, v84
    v_mul_f32 v101, v85, v85
    ds_read_b64_tr_b16 v[20:21], v6 offset:4096
    ds_read_b64_tr_b16 v[22:23], v6 offset:4608
    s_waitcnt lgkmcnt(6)
    v_mfma_f32_32x32x16_bf16 v[32:47], v[24:27], a[140:143], v[32:47]
    v_mul_f32 v102, v86, v86
    v_mul_f32 v103, v87, v87
    v_fma_f32 v100, v100, s40, v28
    v_fma_f32 v101, v101, s40, v28
    ds_read_b64_tr_b16 v[24:25], v6 offset:6144
    ds_read_b64_tr_b16 v[26:27], v6 offset:6656
    s_waitcnt lgkmcnt(6)
    v_mfma_f32_32x32x16_bf16 v[48:63], v[12:15], a[96:99], v[48:63]
    v_fma_f32 v102, v102, s40, v28
    v_fma_f32 v103, v103, s40, v28
    v_mul_f32 v100, v100, v84
    v_mul_f32 v101, v101, v85
    ds_read_b64_tr_b16 v[12:13], v6 offset:8192
    ds_read_b64_tr_b16 v[14:15], v6 offset:8704
    s_waitcnt lgkmcnt(6)
    v_mfma_f32_32x32x16_bf16 v[48:63], v[16:19], a[100:103], v[48:63]
    v_mul_f32 v102, v102, v86
    v_mul_f32 v103, v103, v87
    v_exp_f32 v100, v100
    v_exp_f32 v101, v101
    ds_read_b64_tr_b16 v[16:17], v6 offset:10240
    ds_read_b64_tr_b16 v[18:19], v6 offset:10752
    s_waitcnt lgkmcnt(6)
    v_mfma_f32_32x32x16_bf16 v[48:63], v[20:23], a[104:107], v[48:63]
    v_exp_f32 v102, v102
    v_exp_f32 v103, v103
    v_mul_f32 v92, v84, v92
    v_mul_f32 v93, v85, v93
    ds_read_b64_tr_b16 v[20:21], v6 offset:12288
    ds_read_b64_tr_b16 v[22:23], v6 offset:12800
    s_waitcnt lgkmcnt(6)
    v_mfma_f32_32x32x16_bf16 v[48:63], v[24:27], a[108:111], v[48:63]
    v_mul_f32 v94, v86, v94
    v_mul_f32 v95, v87, v95
    v_add_f32 v100, 1.0, v100
    v_add_f32 v101, 1.0, v101
    ds_read_b64_tr_b16 v[24:25], v6 offset:14336
    ds_read_b64_tr_b16 v[26:27], v6 offset:14848
    s_waitcnt lgkmcnt(6)
    v_mfma_f32_32x32x16_bf16 v[48:63], v[12:15], a[112:115], v[48:63]
    v_add_f32 v102, 1.0, v102
    v_add_f32 v103, 1.0, v103
    v_rcp_f32 v100, v100
    v_rcp_f32 v101, v101
    ds_read_b64_tr_b16 v[12:13], v6 offset:16384
    ds_read_b64_tr_b16 v[14:15], v6 offset:16896
    s_waitcnt lgkmcnt(6)
    v_mfma_f32_32x32x16_bf16 v[48:63], v[16:19], a[116:119], v[48:63]
    v_rcp_f32 v102, v102
    v_rcp_f32 v103, v103
    v_mul_f32 v92, v92, v100
    v_mul_f32 v93, v93, v101
    ds_read_b64_tr_b16 v[16:17], v6 offset:18432
    ds_read_b64_tr_b16 v[18:19], v6 offset:18944
    s_waitcnt lgkmcnt(6)
    v_mfma_f32_32x32x16_bf16 v[48:63], v[20:23], a[120:123], v[48:63]
    v_mul_f32 v94, v94, v102
    v_mul_f32 v95, v95, v103
    v_cvt_pk_bf16_f32 v110, v92, v93
    v_cvt_pk_bf16_f32 v111, v94, v95
    ds_read_b64_tr_b16 v[20:21], v6 offset:20480
    ds_read_b64_tr_b16 v[22:23], v6 offset:20992
    s_waitcnt lgkmcnt(6)
    v_mfma_f32_32x32x16_bf16 v[48:63], v[24:27], a[124:127], v[48:63]
    buffer_store_dwordx4 v[108:111], v1, s[16:19], s63 offen offset:0 sc1
    v_mul_f32 v96, v32, v32
    v_mul_f32 v97, v33, v33
    v_mul_f32 v98, v34, v34
    ds_read_b64_tr_b16 v[24:25], v6 offset:22528
    ds_read_b64_tr_b16 v[26:27], v6 offset:23040
    s_waitcnt lgkmcnt(6)
    v_mfma_f32_32x32x16_bf16 v[48:63], v[12:15], a[128:131], v[48:63]
    v_mul_f32 v99, v35, v35
    v_fma_f32 v96, v96, s40, v28
    v_fma_f32 v97, v97, s40, v28
    v_fma_f32 v98, v98, s40, v28
    ds_read_b64_tr_b16 v[12:13], v7 offset:0
    ds_read_b64_tr_b16 v[14:15], v7 offset:512
    s_waitcnt lgkmcnt(6)
    v_mfma_f32_32x32x16_bf16 v[48:63], v[16:19], a[132:135], v[48:63]
    v_fma_f32 v99, v99, s40, v28
    v_mul_f32 v96, v96, v32
    v_mul_f32 v97, v97, v33
    v_mul_f32 v98, v98, v34
    ds_read_b64_tr_b16 v[16:17], v7 offset:2048
    ds_read_b64_tr_b16 v[18:19], v7 offset:2560
    s_waitcnt lgkmcnt(6)
    v_mfma_f32_32x32x16_bf16 v[48:63], v[20:23], a[136:139], v[48:63]
    v_mul_f32 v99, v99, v35
    v_exp_f32 v96, v96
    v_exp_f32 v97, v97
    v_exp_f32 v98, v98
    ds_read_b64_tr_b16 v[20:21], v7 offset:4096
    ds_read_b64_tr_b16 v[22:23], v7 offset:4608
    s_waitcnt lgkmcnt(6)
    v_mfma_f32_32x32x16_bf16 v[48:63], v[24:27], a[140:143], v[48:63]
    v_exp_f32 v99, v99
    v_mul_f32 v40, v32, v40
    v_mul_f32 v41, v33, v41
    v_mul_f32 v42, v34, v42
    ds_read_b64_tr_b16 v[24:25], v7 offset:6144
    ds_read_b64_tr_b16 v[26:27], v7 offset:6656
    s_waitcnt lgkmcnt(6)
    v_mfma_f32_32x32x16_bf16 v[64:79], v[12:15], a[96:99], v[64:79]
    v_mul_f32 v43, v35, v43
    v_add_f32 v96, 1.0, v96
    v_add_f32 v97, 1.0, v97
    v_add_f32 v98, 1.0, v98
    ds_read_b64_tr_b16 v[12:13], v7 offset:8192
    ds_read_b64_tr_b16 v[14:15], v7 offset:8704
    s_waitcnt lgkmcnt(6)
    v_mfma_f32_32x32x16_bf16 v[64:79], v[16:19], a[100:103], v[64:79]
    v_add_f32 v99, 1.0, v99
    v_rcp_f32 v96, v96
    v_rcp_f32 v97, v97
    v_rcp_f32 v98, v98
    ds_read_b64_tr_b16 v[16:17], v7 offset:10240
    ds_read_b64_tr_b16 v[18:19], v7 offset:10752
    s_waitcnt lgkmcnt(6)
    v_mfma_f32_32x32x16_bf16 v[64:79], v[20:23], a[104:107], v[64:79]
    v_rcp_f32 v99, v99
    v_mul_f32 v40, v40, v96
    v_mul_f32 v41, v41, v97
    v_mul_f32 v42, v42, v98
    ds_read_b64_tr_b16 v[20:21], v7 offset:12288
    ds_read_b64_tr_b16 v[22:23], v7 offset:12800
    s_waitcnt lgkmcnt(6)
    v_mfma_f32_32x32x16_bf16 v[64:79], v[24:27], a[108:111], v[64:79]
    v_mul_f32 v43, v43, v99
    v_cvt_pk_bf16_f32 v104, v40, v41
    v_cvt_pk_bf16_f32 v105, v42, v43
    v_mul_f32 v100, v36, v36
    ds_read_b64_tr_b16 v[24:25], v7 offset:14336
    ds_read_b64_tr_b16 v[26:27], v7 offset:14848
    s_waitcnt lgkmcnt(6)
    v_mfma_f32_32x32x16_bf16 v[64:79], v[12:15], a[112:115], v[64:79]
    v_mul_f32 v101, v37, v37
    v_mul_f32 v102, v38, v38
    v_mul_f32 v103, v39, v39
    v_fma_f32 v100, v100, s40, v28
    ds_read_b64_tr_b16 v[12:13], v7 offset:16384
    ds_read_b64_tr_b16 v[14:15], v7 offset:16896
    s_waitcnt lgkmcnt(6)
    v_mfma_f32_32x32x16_bf16 v[64:79], v[16:19], a[116:119], v[64:79]
    v_fma_f32 v101, v101, s40, v28
    v_fma_f32 v102, v102, s40, v28
    v_fma_f32 v103, v103, s40, v28
    v_mul_f32 v100, v100, v36
    ds_read_b64_tr_b16 v[16:17], v7 offset:18432
    ds_read_b64_tr_b16 v[18:19], v7 offset:18944
    s_waitcnt lgkmcnt(6)
    v_mfma_f32_32x32x16_bf16 v[64:79], v[20:23], a[120:123], v[64:79]
    v_mul_f32 v101, v101, v37
    v_mul_f32 v102, v102, v38
    v_mul_f32 v103, v103, v39
    v_exp_f32 v100, v100
    ds_read_b64_tr_b16 v[20:21], v7 offset:20480
    ds_read_b64_tr_b16 v[22:23], v7 offset:20992
    s_waitcnt lgkmcnt(6)
    v_mfma_f32_32x32x16_bf16 v[64:79], v[24:27], a[124:127], v[64:79]
    v_exp_f32 v101, v101
    v_exp_f32 v102, v102
    v_exp_f32 v103, v103
    v_mul_f32 v44, v36, v44
    ds_read_b64_tr_b16 v[24:25], v7 offset:22528
    ds_read_b64_tr_b16 v[26:27], v7 offset:23040
    s_waitcnt lgkmcnt(6)
    v_mfma_f32_32x32x16_bf16 v[64:79], v[12:15], a[128:131], v[64:79]
    v_mul_f32 v45, v37, v45
    v_mul_f32 v46, v38, v46
    v_mul_f32 v47, v39, v47
    v_add_f32 v100, 1.0, v100
    s_waitcnt lgkmcnt(4)
    v_mfma_f32_32x32x16_bf16 v[64:79], v[16:19], a[132:135], v[64:79]
    v_add_f32 v101, 1.0, v101
    v_add_f32 v102, 1.0, v102
    v_add_f32 v103, 1.0, v103
    v_rcp_f32 v100, v100
    s_waitcnt lgkmcnt(2)
    v_mfma_f32_32x32x16_bf16 v[64:79], v[20:23], a[136:139], v[64:79]
    v_rcp_f32 v101, v101
    v_rcp_f32 v102, v102
    v_rcp_f32 v103, v103
    v_mul_f32 v44, v44, v100
    s_waitcnt lgkmcnt(0)
    v_mfma_f32_32x32x16_bf16 v[64:79], v[24:27], a[140:143], v[64:79]
    v_mul_f32 v45, v45, v101
    v_mul_f32 v46, v46, v102
    v_mul_f32 v47, v47, v103
    v_cvt_pk_bf16_f32 v106, v44, v45
    v_cvt_pk_bf16_f32 v107, v46, v47
    buffer_store_dwordx4 v[104:107], v1, s[16:19], s63 offen offset:1024 sc1
    v_mul_f32 v96, v48, v48
    v_mul_f32 v97, v49, v49
    v_mul_f32 v98, v50, v50
    v_mul_f32 v99, v51, v51
    v_fma_f32 v96, v96, s40, v28
    v_fma_f32 v97, v97, s40, v28
    v_fma_f32 v98, v98, s40, v28
    v_fma_f32 v99, v99, s40, v28
    v_mul_f32 v96, v96, v48
    v_mul_f32 v97, v97, v49
    v_mul_f32 v98, v98, v50
    v_mul_f32 v99, v99, v51
    v_exp_f32 v96, v96
    v_exp_f32 v97, v97
    v_exp_f32 v98, v98
    v_exp_f32 v99, v99
    v_mul_f32 v56, v48, v56
    v_mul_f32 v57, v49, v57
    v_mul_f32 v58, v50, v58
    v_mul_f32 v59, v51, v59
    v_add_f32 v96, 1.0, v96
    v_add_f32 v97, 1.0, v97
    v_add_f32 v98, 1.0, v98
    v_add_f32 v99, 1.0, v99
    v_rcp_f32 v96, v96
    v_rcp_f32 v97, v97
    v_rcp_f32 v98, v98
    v_rcp_f32 v99, v99
    v_mul_f32 v56, v56, v96
    v_mul_f32 v57, v57, v97
    v_mul_f32 v58, v58, v98
    v_mul_f32 v59, v59, v99
    v_cvt_pk_bf16_f32 v108, v56, v57
    v_cvt_pk_bf16_f32 v109, v58, v59
    v_mul_f32 v100, v52, v52
    v_mul_f32 v101, v53, v53
    v_mul_f32 v102, v54, v54
    v_mul_f32 v103, v55, v55
    v_fma_f32 v100, v100, s40, v28
    v_fma_f32 v101, v101, s40, v28
    v_fma_f32 v102, v102, s40, v28
    v_fma_f32 v103, v103, s40, v28
    v_mul_f32 v100, v100, v52
    v_mul_f32 v101, v101, v53
    v_mul_f32 v102, v102, v54
    v_mul_f32 v103, v103, v55
    v_exp_f32 v100, v100
    v_exp_f32 v101, v101
    v_exp_f32 v102, v102
    v_exp_f32 v103, v103
    v_mul_f32 v60, v52, v60
    v_mul_f32 v61, v53, v61
    v_mul_f32 v62, v54, v62
    v_mul_f32 v63, v55, v63
    v_add_f32 v100, 1.0, v100
    v_add_f32 v101, 1.0, v101
    v_add_f32 v102, 1.0, v102
    v_add_f32 v103, 1.0, v103
    v_rcp_f32 v100, v100
    v_rcp_f32 v101, v101
    v_rcp_f32 v102, v102
    v_rcp_f32 v103, v103
    v_mul_f32 v60, v60, v100
    v_mul_f32 v61, v61, v101
    v_mul_f32 v62, v62, v102
    v_mul_f32 v63, v63, v103
    v_cvt_pk_bf16_f32 v110, v60, v61
    v_cvt_pk_bf16_f32 v111, v62, v63
    buffer_store_dwordx4 v[108:111], v1, s[16:19], s63 offen offset:2048 sc1
    v_mul_f32 v96, v64, v64
    v_mul_f32 v97, v65, v65
    v_mul_f32 v98, v66, v66
    v_mul_f32 v99, v67, v67
    v_fma_f32 v96, v96, s40, v28
    v_fma_f32 v97, v97, s40, v28
    v_fma_f32 v98, v98, s40, v28
    v_fma_f32 v99, v99, s40, v28
    v_mul_f32 v96, v96, v64
    v_mul_f32 v97, v97, v65
    v_mul_f32 v98, v98, v66
    v_mul_f32 v99, v99, v67
    v_exp_f32 v96, v96
    v_exp_f32 v97, v97
    v_exp_f32 v98, v98
    v_exp_f32 v99, v99
    v_mul_f32 v72, v64, v72
    v_mul_f32 v73, v65, v73
    v_mul_f32 v74, v66, v74
    v_mul_f32 v75, v67, v75
    v_add_f32 v96, 1.0, v96
    v_add_f32 v97, 1.0, v97
    v_add_f32 v98, 1.0, v98
    v_add_f32 v99, 1.0, v99
    v_rcp_f32 v96, v96
    v_rcp_f32 v97, v97
    v_rcp_f32 v98, v98
    v_rcp_f32 v99, v99
    v_mul_f32 v72, v72, v96
    v_mul_f32 v73, v73, v97
    v_mul_f32 v74, v74, v98
    v_mul_f32 v75, v75, v99
    v_cvt_pk_bf16_f32 v104, v72, v73
    v_cvt_pk_bf16_f32 v105, v74, v75
    v_mul_f32 v100, v68, v68
    v_mul_f32 v101, v69, v69
    v_mul_f32 v102, v70, v70
    v_mul_f32 v103, v71, v71
    v_fma_f32 v100, v100, s40, v28
    v_fma_f32 v101, v101, s40, v28
    v_fma_f32 v102, v102, s40, v28
    v_fma_f32 v103, v103, s40, v28
    v_mul_f32 v100, v100, v68
    v_mul_f32 v101, v101, v69
    v_mul_f32 v102, v102, v70
    v_mul_f32 v103, v103, v71
    v_exp_f32 v100, v100
    v_exp_f32 v101, v101
    v_exp_f32 v102, v102
    v_exp_f32 v103, v103
    v_mul_f32 v76, v68, v76
    v_mul_f32 v77, v69, v77
    v_mul_f32 v78, v70, v78
    v_mul_f32 v79, v71, v79
    v_add_f32 v100, 1.0, v100
    v_add_f32 v101, 1.0, v101
    v_add_f32 v102, 1.0, v102
    v_add_f32 v103, 1.0, v103
    v_rcp_f32 v100, v100
    v_rcp_f32 v101, v101
    v_rcp_f32 v102, v102
    v_rcp_f32 v103, v103
    v_mul_f32 v76, v76, v100
    v_mul_f32 v77, v77, v101
    v_mul_f32 v78, v78, v102
    v_mul_f32 v79, v79, v103
    v_cvt_pk_bf16_f32 v106, v76, v77
    v_cvt_pk_bf16_f32 v107, v78, v79
    buffer_store_dwordx4 v[104:107], v1, s[16:19], s63 offen offset:3072 sc1
LB_end:
    s_endpgm
.text
.globl attn_down_kernel
.p2align 8
.type attn_down_kernel,@function
attn_down_kernel:
    s_cmp_ge_u32 s2, 256
    s_cbranch_scc1 LC_end
    s_load_dwordx2 s[8:9], s[0:1], 48
    s_load_dwordx2 s[10:11], s[0:1], 72
    s_load_dwordx2 s[4:5], s[0:1], 0
    s_load_dwordx2 s[6:7], s[0:1], 56
    v_lshrrev_b32 v1, 6, v0
    v_and_b32 v0, 63, v0
    v_readfirstlane_b32 s3, v1
    v_lshlrev_b32 v1, 4, v0
    s_and_b32 s12, s2, 7
    s_lshl_b32 s13, s12, 2
    s_lshr_b32 s14, s2, 3
    s_and_b32 s15, s14, 3
    s_add_u32 s13, s13, s15
    s_waitcnt lgkmcnt(0)
    s_mov_b32 s16, s10
    s_mov_b32 s17, s11
    s_mov_b32 s18, 48848896
    s_mov_b32 s19, 0x20000
    s_cmp_ge_u32 s3, 8
    s_cbranch_scc1 LC_gemm
    s_lshr_b32 s24, s2, 5
    s_lshl_b32 s24, s24, 3
    s_add_u32 s24, s24, s3
    s_lshl_b32 s25, s13, 6
    s_add_u32 s25, s25, s24
    s_lshl_b32 s25, s25, 10
    s_add_u32 s25, s25, 25444352
    buffer_load_dwordx4 v[4:7], v1, s[16:19], s25 offen
    v_lshrrev_b32 v96, 5, v0
    v_and_b32 v97, 31, v0
    v_lshlrev_b32 v97, 1, v97
    v_lshl_add_u32 v3, v96, 12, v97
    s_lshl_b32 s26, s13, 14
    s_add_u32 s26, s26, 33832960
    s_lshl_b32 s27, s24, 6
    s_add_u32 s27, s27, s26
    buffer_load_ushort v8, v3, s[16:19], s27 offen
    v_mov_b32 v104, v3
    v_add_u32 v3, 147456, v3
    v_mov_b32 v9, 0
    v_mov_b32 v10, 0
    v_mov_b32 v11, 0
    v_mov_b32 v18, 0
    v_mov_b32 v19, 0
    v_mov_b32 v17, 0x3f80
    v_mov_b32 v80, 0
    v_mov_b32 v81, 0
    v_mov_b32 v82, 0
    v_mov_b32 v83, 0
    v_mov_b32 v84, 0
    v_mov_b32 v85, 0
    v_mov_b32 v86, 0
    v_mov_b32 v87, 0
    v_mov_b32 v88, 0
    v_mov_b32 v89, 0
    v_mov_b32 v90, 0
    v_mov_b32 v91, 0
    v_mov_b32 v92, 0
    v_mov_b32 v93, 0
    v_mov_b32 v94, 0
    v_mov_b32 v95, 0
    s_mov_b32 s44, 0x00ffffff
    s_mov_b32 s45, 0x00ffffff
    s_setprio 1
    s_barrier
    ds_read_b128 v[12:15], v1 offset:0
    ds_read_u16 v16, v3 offset:0
    s_waitcnt vmcnt(0) lgkmcnt(0)
    v_mfma_f32_32x32x16_bf16 v[32:47], v[12:15], v[4:7], 0
    v_mfma_f32_32x32x8bf16_1k v[32:47], v[16:17], v[8:9], v[32:47]
    s_nop 11
    v_max3_f32 v96, v32, v33, v34
    v_max3_f32 v96, v96, v35, v36
    v_max3_f32 v96, v96, v37, v38
    v_max3_f32 v96, v96, v39, v40
    v_max3_f32 v96, v96, v41, v42
    v_max3_f32 v96, v96, v43, v44
    v_max3_f32 v96, v96, v45, v46
    v_max_f32 v96, v96, v47
    v_mov_b32 v97, v96
    s_nop 1
    v_permlane32_swap_b32 v96, v97
    v_max_f32 v96, v96, v97
    v_sub_f32 v96, 0, v96
    v_cvt_pk_bf16_f32 v96, v96, 0
    s_mov_b32 exec_hi, 0
    v_mov_b32 v9, v96
    s_mov_b32 exec_hi, -1
    v_mfma_f32_32x32x16_bf16 v[32:47], v[12:15], v[4:7], 0
    v_mfma_f32_32x32x8bf16_1k v[32:47], v[16:17], v[8:9], v[32:47]
    ds_read_b128 v[12:15], v1 offset:3072
    ds_read_u16 v16, v3 offset:64
    v_mov_b32 v72, 0
    v_mov_b32 v73, 0
    v_mov_b32 v74, 0
    v_mov_b32 v75, 0
    v_mov_b32 v76, 0
    v_mov_b32 v77, 0
    v_mov_b32 v78, 0
    v_mov_b32 v79, 0
    v_mov_b32 v20, 0
    v_mov_b32 v21, 0
    v_mov_b32 v22, 0
    v_mov_b32 v23, 0
    v_mov_b32 v24, 0
    v_mov_b32 v25, 0
    v_mov_b32 v26, 0
    v_mov_b32 v27, 0
    s_waitcnt lgkmcnt(0)
    s_mov_b32 s28, 4
.p2align 6
LC_aloop:
    s_waitcnt lgkmcnt(2)
    v_mfma_f32_32x32x16_bf16 v[48:63], v[12:15], v[4:7], 0
    v_exp_f32 v32, v32
    v_exp_f32 v33, v33
    v_exp_f32 v34, v34
    v_exp_f32 v35, v35
    v_mfma_f32_32x32x8bf16_1k v[48:63], v[16:17], v[8:9], v[48:63]
    ds_read_b128 v[12:15], v1 offset:6144
    ds_read_u16 v16, v3 offset:128
    v_exp_f32 v36, v36
    v_exp_f32 v37, v37
    v_exp_f32 v38, v38
    v_exp_f32 v39, v39
    v_cvt_pk_bf16_f32 v64, v32, v33
    v_cvt_pk_bf16_f32 v65, v34, v35
    s_waitcnt lgkmcnt(2)
    v_mfma_f32_32x32x16_bf16 v[80:95], v[20:23], v[72:75], v[80:95]
    v_exp_f32 v40, v40
    v_exp_f32 v41, v41
    v_exp_f32 v42, v42
    v_exp_f32 v43, v43
    v_cvt_pk_bf16_f32 v66, v36, v37
    v_cvt_pk_bf16_f32 v67, v38, v39
    v_mfma_f32_32x32x16_bf16 v[80:95], v[24:27], v[76:79], v[80:95]
    s_mov_b64 exec, s[44:45]
    ds_read_b128 v[20:23], v1 offset:1024
    ds_read_b128 v[24:27], v1 offset:2048
    s_mov_b64 exec, -1
    v_exp_f32 v44, v44
    v_exp_f32 v45, v45
    v_exp_f32 v46, v46
    v_exp_f32 v47, v47
    v_cvt_pk_bf16_f32 v68, v40, v41
    v_cvt_pk_bf16_f32 v69, v42, v43
    v_cvt_pk_bf16_f32 v70, v44, v45
    v_cvt_pk_bf16_f32 v71, v46, v47
    s_waitcnt lgkmcnt(2)
    v_mfma_f32_32x32x16_bf16 v[32:47], v[12:15], v[4:7], 0
    v_exp_f32 v48, v48
    v_exp_f32 v49, v49
    v_exp_f32 v50, v50
    v_exp_f32 v51, v51
    v_mfma_f32_32x32x8bf16_1k v[32:47], v[16:17], v[8:9], v[32:47]
    ds_read_b128 v[12:15], v1 offset:9216
    ds_read_u16 v16, v3 offset:192
    v_exp_f32 v52, v52
    v_exp_f32 v53, v53
    v_exp_f32 v54, v54
    v_exp_f32 v55, v55
    v_cvt_pk_bf16_f32 v72, v48, v49
    v_cvt_pk_bf16_f32 v73, v50, v51
    s_waitcnt lgkmcnt(2)
    v_mfma_f32_32x32x16_bf16 v[80:95], v[20:23], v[64:67], v[80:95]
    v_exp_f32 v56, v56
    v_exp_f32 v57, v57
    v_exp_f32 v58, v58
    v_exp_f32 v59, v59
    v_cvt_pk_bf16_f32 v74, v52, v53
    v_cvt_pk_bf16_f32 v75, v54, v55
    v_mfma_f32_32x32x16_bf16 v[80:95], v[24:27], v[68:71], v[80:95]
    s_mov_b64 exec, s[44:45]
    ds_read_b128 v[20:23], v1 offset:4096
    ds_read_b128 v[24:27], v1 offset:5120
    s_mov_b64 exec, -1
    v_exp_f32 v60, v60
    v_exp_f32 v61, v61
    v_exp_f32 v62, v62
    v_exp_f32 v63, v63
    v_cvt_pk_bf16_f32 v76, v56, v57
    v_cvt_pk_bf16_f32 v77, v58, v59
    v_cvt_pk_bf16_f32 v78, v60, v61
    v_cvt_pk_bf16_f32 v79, v62, v63
    s_waitcnt lgkmcnt(2)
    v_mfma_f32_32x32x16_bf16 v[48:63], v[12:15], v[4:7], 0
    v_exp_f32 v32, v32
    v_exp_f32 v33, v33
    v_exp_f32 v34, v34
    v_exp_f32 v35, v35
    v_mfma_f32_32x32x8bf16_1k v[48:63], v[16:17], v[8:9], v[48:63]
    s_waitcnt lgkmcnt(0)
    s_barrier
    ds_read_b128 v[12:15], v1 offset:12288
    ds_read_u16 v16, v3 offset:256
    v_exp_f32 v36, v36
    v_exp_f32 v37, v37
    v_exp_f32 v38, v38
    v_exp_f32 v39, v39
    v_cvt_pk_bf16_f32 v64, v32, v33
    v_cvt_pk_bf16_f32 v65, v34, v35
    s_waitcnt lgkmcnt(2)
    v_mfma_f32_32x32x16_bf16 v[80:95], v[20:23], v[72:75], v[80:95]
    v_exp_f32 v40, v40
    v_exp_f32 v41, v41
    v_exp_f32 v42, v42
    v_exp_f32 v43, v43
    v_cvt_pk_bf16_f32 v66, v36, v37
    v_cvt_pk_bf16_f32 v67, v38, v39
    v_mfma_f32_32x32x16_bf16 v[80:95], v[24:27], v[76:79], v[80:95]
    s_mov_b64 exec, s[44:45]
    ds_read_b128 v[20:23], v1 offset:7168
    ds_read_b128 v[24:27], v1 offset:8192
    s_mov_b64 exec, -1
    v_exp_f32 v44, v44
    v_exp_f32 v45, v45
    v_exp_f32 v46, v46
    v_exp_f32 v47, v47
    v_cvt_pk_bf16_f32 v68, v40, v41
    v_cvt_pk_bf16_f32 v69, v42, v43
    v_cvt_pk_bf16_f32 v70, v44, v45
    v_cvt_pk_bf16_f32 v71, v46, v47
    s_waitcnt lgkmcnt(2)
    v_mfma_f32_32x32x16_bf16 v[32:47], v[12:15], v[4:7], 0
    v_exp_f32 v48, v48
    v_exp_f32 v49, v49
    v_exp_f32 v50, v50
    v_exp_f32 v51, v51
    v_mfma_f32_32x32x8bf16_1k v[32:47], v[16:17], v[8:9], v[32:47]
    ds_read_b128 v[12:15], v1 offset:15360
    ds_read_u16 v16, v3 offset:320
    v_exp_f32 v52, v52
    v_exp_f32 v53, v53
    v_exp_f32 v54, v54
    v_exp_f32 v55, v55
    v_cvt_pk_bf16_f32 v72, v48, v49
    v_cvt_pk_bf16_f32 v73, v50, v51
    s_waitcnt lgkmcnt(2)
    v_mfma_f32_32x32x16_bf16 v[80:95], v[20:23], v[64:67], v[80:95]
    v_exp_f32 v56, v56
    v_exp_f32 v57, v57
    v_exp_f32 v58, v58
    v_exp_f32 v59, v59
    v_cvt_pk_bf16_f32 v74, v52, v53
    v_cvt_pk_bf16_f32 v75, v54, v55
    v_mfma_f32_32x32x16_bf16 v[80:95], v[24:27], v[68:71], v[80:95]
    s_mov_b64 exec, s[44:45]
    ds_read_b128 v[20:23], v1 offset:10240
    ds_read_b128 v[24:27], v1 offset:11264
    s_mov_b64 exec, -1
    v_exp_f32 v60, v60
    v_exp_f32 v61, v61
    v_exp_f32 v62, v62
    v_exp_f32 v63, v63
    v_cvt_pk_bf16_f32 v76, v56, v57
    v_cvt_pk_bf16_f32 v77, v58, v59
    v_cvt_pk_bf16_f32 v78, v60, v61
    v_cvt_pk_bf16_f32 v79, v62, v63
    s_waitcnt lgkmcnt(2)
    v_mfma_f32_32x32x16_bf16 v[48:63], v[12:15], v[4:7], 0
    v_exp_f32 v32, v32
    v_exp_f32 v33, v33
    v_exp_f32 v34, v34
    v_exp_f32 v35, v35
    v_mfma_f32_32x32x8bf16_1k v[48:63], v[16:17], v[8:9], v[48:63]
    ds_read_b128 v[12:15], v1 offset:18432
    ds_read_u16 v16, v3 offset:384
    v_exp_f32 v36, v36
    v_exp_f32 v37, v37
    v_exp_f32 v38, v38
    v_exp_f32 v39, v39
    v_cvt_pk_bf16_f32 v64, v32, v33
    v_cvt_pk_bf16_f32 v65, v34, v35
    s_waitcnt lgkmcnt(2)
    v_mfma_f32_32x32x16_bf16 v[80:95], v[20:23], v[72:75], v[80:95]
    v_exp_f32 v40, v40
    v_exp_f32 v41, v41
    v_exp_f32 v42, v42
    v_exp_f32 v43, v43
    v_cvt_pk_bf16_f32 v66, v36, v37
    v_cvt_pk_bf16_f32 v67, v38, v39
    v_mfma_f32_32x32x16_bf16 v[80:95], v[24:27], v[76:79], v[80:95]
    s_mov_b64 exec, s[44:45]
    ds_read_b128 v[20:23], v1 offset:13312
    ds_read_b128 v[24:27], v1 offset:14336
    s_mov_b64 exec, -1
    v_exp_f32 v44, v44
    v_exp_f32 v45, v45
    v_exp_f32 v46, v46
    v_exp_f32 v47, v47
    v_cvt_pk_bf16_f32 v68, v40, v41
    v_cvt_pk_bf16_f32 v69, v42, v43
    v_cvt_pk_bf16_f32 v70, v44, v45
    v_cvt_pk_bf16_f32 v71, v46, v47
    s_waitcnt lgkmcnt(2)
    v_mfma_f32_32x32x16_bf16 v[32:47], v[12:15], v[4:7], 0
    v_exp_f32 v48, v48
    v_exp_f32 v49, v49
    v_exp_f32 v50, v50
    v_exp_f32 v51, v51
    v_mfma_f32_32x32x8bf16_1k v[32:47], v[16:17], v[8:9], v[32:47]
    ds_read_b128 v[12:15], v1 offset:21504
    ds_read_u16 v16, v3 offset:448
    v_exp_f32 v52, v52
    v_exp_f32 v53, v53
    v_exp_f32 v54, v54
    v_exp_f32 v55, v55
    v_cvt_pk_bf16_f32 v72, v48, v49
    v_cvt_pk_bf16_f32 v73, v50, v51
    s_waitcnt lgkmcnt(2)
    v_mfma_f32_32x32x16_bf16 v[80:95], v[20:23], v[64:67], v[80:95]
    v_exp_f32 v56, v56
    v_exp_f32 v57, v57
    v_exp_f32 v58, v58
    v_exp_f32 v59, v59
    v_cvt_pk_bf16_f32 v74, v52, v53
    v_cvt_pk_bf16_f32 v75, v54, v55
    v_mfma_f32_32x32x16_bf16 v[80:95], v[24:27], v[68:71], v[80:95]
    s_mov_b64 exec, s[44:45]
    ds_read_b128 v[20:23], v1 offset:16384
    ds_read_b128 v[24:27], v1 offset:17408
    s_mov_b64 exec, -1
    v_exp_f32 v60, v60
    v_exp_f32 v61, v61
    v_exp_f32 v62, v62
    v_exp_f32 v63, v63
    v_cvt_pk_bf16_f32 v76, v56, v57
    v_cvt_pk_bf16_f32 v77, v58, v59
    v_cvt_pk_bf16_f32 v78, v60, v61
    v_cvt_pk_bf16_f32 v79, v62, v63
    s_waitcnt lgkmcnt(2)
    v_mfma_f32_32x32x16_bf16 v[48:63], v[12:15], v[4:7], 0
    v_exp_f32 v32, v32
    v_exp_f32 v33, v33
    v_exp_f32 v34, v34
    v_exp_f32 v35, v35
    v_mfma_f32_32x32x8bf16_1k v[48:63], v[16:17], v[8:9], v[48:63]
    s_waitcnt lgkmcnt(0)
    s_barrier
    ds_read_b128 v[12:15], v1 offset:24576
    ds_read_u16 v16, v3 offset:512
    v_exp_f32 v36, v36
    v_exp_f32 v37, v37
    v_exp_f32 v38, v38
    v_exp_f32 v39, v39
    v_cvt_pk_bf16_f32 v64, v32, v33
    v_cvt_pk_bf16_f32 v65, v34, v35
    s_waitcnt lgkmcnt(2)
    v_mfma_f32_32x32x16_bf16 v[80:95], v[20:23], v[72:75], v[80:95]
    v_exp_f32 v40, v40
    v_exp_f32 v41, v41
    v_exp_f32 v42, v42
    v_exp_f32 v43, v43
    v_cvt_pk_bf16_f32 v66, v36, v37
    v_cvt_pk_bf16_f32 v67, v38, v39
    v_mfma_f32_32x32x16_bf16 v[80:95], v[24:27], v[76:79], v[80:95]
    s_mov_b64 exec, s[44:45]
    ds_read_b128 v[20:23], v1 offset:19456
    ds_read_b128 v[24:27], v1 offset:20480
    s_mov_b64 exec, -1
    v_exp_f32 v44, v44
    v_exp_f32 v45, v45
    v_exp_f32 v46, v46
    v_exp_f32 v47, v47
    v_cvt_pk_bf16_f32 v68, v40, v41
    v_cvt_pk_bf16_f32 v69, v42, v43
    v_cvt_pk_bf16_f32 v70, v44, v45
    v_cvt_pk_bf16_f32 v71, v46, v47
    s_waitcnt lgkmcnt(2)
    v_mfma_f32_32x32x16_bf16 v[32:47], v[12:15], v[4:7], 0
    v_exp_f32 v48, v48
    v_exp_f32 v49, v49
    v_exp_f32 v50, v50
    v_exp_f32 v51, v51
    v_mfma_f32_32x32x8bf16_1k v[32:47], v[16:17], v[8:9], v[32:47]
    ds_read_b128 v[12:15], v1 offset:27648
    ds_read_u16 v16, v3 offset:576
    v_exp_f32 v52, v52
    v_exp_f32 v53, v53
    v_exp_f32 v54, v54
    v_exp_f32 v55, v55
    v_cvt_pk_bf16_f32 v72, v48, v49
    v_cvt_pk_bf16_f32 v73, v50, v51
    s_waitcnt lgkmcnt(2)
    v_mfma_f32_32x32x16_bf16 v[80:95], v[20:23], v[64:67], v[80:95]
    v_exp_f32 v56, v56
    v_exp_f32 v57, v57
    v_exp_f32 v58, v58
    v_exp_f32 v59, v59
    v_cvt_pk_bf16_f32 v74, v52, v53
    v_cvt_pk_bf16_f32 v75, v54, v55
    v_mfma_f32_32x32x16_bf16 v[80:95], v[24:27], v[68:71], v[80:95]
    s_mov_b64 exec, s[44:45]
    ds_read_b128 v[20:23], v1 offset:22528
    ds_read_b128 v[24:27], v1 offset:23552
    s_mov_b64 exec, -1
    v_exp_f32 v60, v60
    v_exp_f32 v61, v61
    v_exp_f32 v62, v62
    v_exp_f32 v63, v63
    v_cvt_pk_bf16_f32 v76, v56, v57
    v_cvt_pk_bf16_f32 v77, v58, v59
    v_cvt_pk_bf16_f32 v78, v60, v61
    v_cvt_pk_bf16_f32 v79, v62, v63
    s_waitcnt lgkmcnt(2)
    v_mfma_f32_32x32x16_bf16 v[48:63], v[12:15], v[4:7], 0
    v_exp_f32 v32, v32
    v_exp_f32 v33, v33
    v_exp_f32 v34, v34
    v_exp_f32 v35, v35
    v_mfma_f32_32x32x8bf16_1k v[48:63], v[16:17], v[8:9], v[48:63]
    ds_read_b128 v[12:15], v1 offset:30720
    ds_read_u16 v16, v3 offset:640
    v_exp_f32 v36, v36
    v_exp_f32 v37, v37
    v_exp_f32 v38, v38
    v_exp_f32 v39, v39
    v_cvt_pk_bf16_f32 v64, v32, v33
    v_cvt_pk_bf16_f32 v65, v34, v35
    s_waitcnt lgkmcnt(2)
    v_mfma_f32_32x32x16_bf16 v[80:95], v[20:23], v[72:75], v[80:95]
    v_exp_f32 v40, v40
    v_exp_f32 v41, v41
    v_exp_f32 v42, v42
    v_exp_f32 v43, v43
    v_cvt_pk_bf16_f32 v66, v36, v37
    v_cvt_pk_bf16_f32 v67, v38, v39
    v_mfma_f32_32x32x16_bf16 v[80:95], v[24:27], v[76:79], v[80:95]
    s_mov_b64 exec, s[44:45]
    ds_read_b128 v[20:23], v1 offset:25600
    ds_read_b128 v[24:27], v1 offset:26624
    s_mov_b64 exec, -1
    v_exp_f32 v44, v44
    v_exp_f32 v45, v45
    v_exp_f32 v46, v46
    v_exp_f32 v47, v47
    v_cvt_pk_bf16_f32 v68, v40, v41
    v_cvt_pk_bf16_f32 v69, v42, v43
    v_cvt_pk_bf16_f32 v70, v44, v45
    v_cvt_pk_bf16_f32 v71, v46, v47
    s_waitcnt lgkmcnt(2)
    v_mfma_f32_32x32x16_bf16 v[32:47], v[12:15], v[4:7], 0
    v_exp_f32 v48, v48
    v_exp_f32 v49, v49
    v_exp_f32 v50, v50
    v_exp_f32 v51, v51
    v_mfma_f32_32x32x8bf16_1k v[32:47], v[16:17], v[8:9], v[32:47]
    ds_read_b128 v[12:15], v1 offset:33792
    ds_read_u16 v16, v3 offset:704
    v_exp_f32 v52, v52
    v_exp_f32 v53, v53
    v_exp_f32 v54, v54
    v_exp_f32 v55, v55
    v_cvt_pk_bf16_f32 v72, v48, v49
    v_cvt_pk_bf16_f32 v73, v50, v51
    s_waitcnt lgkmcnt(2)
    v_mfma_f32_32x32x16_bf16 v[80:95], v[20:23], v[64:67], v[80:95]
    v_exp_f32 v56, v56
    v_exp_f32 v57, v57
    v_exp_f32 v58, v58
    v_exp_f32 v59, v59
    v_cvt_pk_bf16_f32 v74, v52, v53
    v_cvt_pk_bf16_f32 v75, v54, v55
    v_mfma_f32_32x32x16_bf16 v[80:95], v[24:27], v[68:71], v[80:95]
    s_mov_b64 exec, s[44:45]
    ds_read_b128 v[20:23], v1 offset:28672
    ds_read_b128 v[24:27], v1 offset:29696
    s_mov_b64 exec, -1
    v_exp_f32 v60, v60
    v_exp_f32 v61, v61
    v_exp_f32 v62, v62
    v_exp_f32 v63, v63
    v_cvt_pk_bf16_f32 v76, v56, v57
    v_cvt_pk_bf16_f32 v77, v58, v59
    v_cvt_pk_bf16_f32 v78, v60, v61
    v_cvt_pk_bf16_f32 v79, v62, v63
    s_waitcnt lgkmcnt(2)
    v_mfma_f32_32x32x16_bf16 v[48:63], v[12:15], v[4:7], 0
    v_exp_f32 v32, v32
    v_exp_f32 v33, v33
    v_exp_f32 v34, v34
    v_exp_f32 v35, v35
    v_mfma_f32_32x32x8bf16_1k v[48:63], v[16:17], v[8:9], v[48:63]
    s_waitcnt lgkmcnt(0)
    s_barrier
    ds_read_b128 v[12:15], v1 offset:36864
    ds_read_u16 v16, v3 offset:768
    v_exp_f32 v36, v36
    v_exp_f32 v37, v37
    v_exp_f32 v38, v38
    v_exp_f32 v39, v39
    v_cvt_pk_bf16_f32 v64, v32, v33
    v_cvt_pk_bf16_f32 v65, v34, v35
    s_waitcnt lgkmcnt(2)
    v_mfma_f32_32x32x16_bf16 v[80:95], v[20:23], v[72:75], v[80:95]
    v_exp_f32 v40, v40
    v_exp_f32 v41, v41
    v_exp_f32 v42, v42
    v_exp_f32 v43, v43
    v_cvt_pk_bf16_f32 v66, v36, v37
    v_cvt_pk_bf16_f32 v67, v38, v39
    v_mfma_f32_32x32x16_bf16 v[80:95], v[24:27], v[76:79], v[80:95]
    s_mov_b64 exec, s[44:45]
    ds_read_b128 v[20:23], v1 offset:31744
    ds_read_b128 v[24:27], v1 offset:32768
    s_mov_b64 exec, -1
    v_exp_f32 v44, v44
    v_exp_f32 v45, v45
    v_exp_f32 v46, v46
    v_exp_f32 v47, v47
    v_cvt_pk_bf16_f32 v68, v40, v41
    v_cvt_pk_bf16_f32 v69, v42, v43
    v_cvt_pk_bf16_f32 v70, v44, v45
    v_cvt_pk_bf16_f32 v71, v46, v47
    s_waitcnt lgkmcnt(2)
    v_mfma_f32_32x32x16_bf16 v[32:47], v[12:15], v[4:7], 0
    v_exp_f32 v48, v48
    v_exp_f32 v49, v49
    v_exp_f32 v50, v50
    v_exp_f32 v51, v51
    v_mfma_f32_32x32x8bf16_1k v[32:47], v[16:17], v[8:9], v[32:47]
    ds_read_b128 v[12:15], v1 offset:39936
    ds_read_u16 v16, v3 offset:832
    v_exp_f32 v52, v52
    v_exp_f32 v53, v53
    v_exp_f32 v54, v54
    v_exp_f32 v55, v55
    v_cvt_pk_bf16_f32 v72, v48, v49
    v_cvt_pk_bf16_f32 v73, v50, v51
    s_waitcnt lgkmcnt(2)
    v_mfma_f32_32x32x16_bf16 v[80:95], v[20:23], v[64:67], v[80:95]
    v_exp_f32 v56, v56
    v_exp_f32 v57, v57
    v_exp_f32 v58, v58
    v_exp_f32 v59, v59
    v_cvt_pk_bf16_f32 v74, v52, v53
    v_cvt_pk_bf16_f32 v75, v54, v55
    v_mfma_f32_32x32x16_bf16 v[80:95], v[24:27], v[68:71], v[80:95]
    s_mov_b64 exec, s[44:45]
    ds_read_b128 v[20:23], v1 offset:34816
    ds_read_b128 v[24:27], v1 offset:35840
    s_mov_b64 exec, -1
    v_exp_f32 v60, v60
    v_exp_f32 v61, v61
    v_exp_f32 v62, v62
    v_exp_f32 v63, v63
    v_cvt_pk_bf16_f32 v76, v56, v57
    v_cvt_pk_bf16_f32 v77, v58, v59
    v_cvt_pk_bf16_f32 v78, v60, v61
    v_cvt_pk_bf16_f32 v79, v62, v63
    s_waitcnt lgkmcnt(2)
    v_mfma_f32_32x32x16_bf16 v[48:63], v[12:15], v[4:7], 0
    v_exp_f32 v32, v32
    v_exp_f32 v33, v33
    v_exp_f32 v34, v34
    v_exp_f32 v35, v35
    v_mfma_f32_32x32x8bf16_1k v[48:63], v[16:17], v[8:9], v[48:63]
    ds_read_b128 v[12:15], v1 offset:43008
    ds_read_u16 v16, v3 offset:896
    v_exp_f32 v36, v36
    v_exp_f32 v37, v37
    v_exp_f32 v38, v38
    v_exp_f32 v39, v39
    v_cvt_pk_bf16_f32 v64, v32, v33
    v_cvt_pk_bf16_f32 v65, v34, v35
    s_waitcnt lgkmcnt(2)
    v_mfma_f32_32x32x16_bf16 v[80:95], v[20:23], v[72:75], v[80:95]
    v_exp_f32 v40, v40
    v_exp_f32 v41, v41
    v_exp_f32 v42, v42
    v_exp_f32 v43, v43
    v_cvt_pk_bf16_f32 v66, v36, v37
    v_cvt_pk_bf16_f32 v67, v38, v39
    v_mfma_f32_32x32x16_bf16 v[80:95], v[24:27], v[76:79], v[80:95]
    s_mov_b64 exec, s[44:45]
    ds_read_b128 v[20:23], v1 offset:37888
    ds_read_b128 v[24:27], v1 offset:38912
    s_mov_b64 exec, -1
    v_exp_f32 v44, v44
    v_exp_f32 v45, v45
    v_exp_f32 v46, v46
    v_exp_f32 v47, v47
    v_cvt_pk_bf16_f32 v68, v40, v41
    v_cvt_pk_bf16_f32 v69, v42, v43
    v_cvt_pk_bf16_f32 v70, v44, v45
    v_cvt_pk_bf16_f32 v71, v46, v47
    s_waitcnt lgkmcnt(2)
    v_mfma_f32_32x32x16_bf16 v[32:47], v[12:15], v[4:7], 0
    v_exp_f32 v48, v48
    v_exp_f32 v49, v49
    v_exp_f32 v50, v50
    v_exp_f32 v51, v51
    v_mfma_f32_32x32x8bf16_1k v[32:47], v[16:17], v[8:9], v[32:47]
    ds_read_b128 v[12:15], v1 offset:46080
    ds_read_u16 v16, v3 offset:960
    v_exp_f32 v52, v52
    v_exp_f32 v53, v53
    v_exp_f32 v54, v54
    v_exp_f32 v55, v55
    v_cvt_pk_bf16_f32 v72, v48, v49
    v_cvt_pk_bf16_f32 v73, v50, v51
    s_waitcnt lgkmcnt(2)
    v_mfma_f32_32x32x16_bf16 v[80:95], v[20:23], v[64:67], v[80:95]
    v_exp_f32 v56, v56
    v_exp_f32 v57, v57
    v_exp_f32 v58, v58
    v_exp_f32 v59, v59
    v_cvt_pk_bf16_f32 v74, v52, v53
    v_cvt_pk_bf16_f32 v75, v54, v55
    v_mfma_f32_32x32x16_bf16 v[80:95], v[24:27], v[68:71], v[80:95]
    s_mov_b64 exec, s[44:45]
    ds_read_b128 v[20:23], v1 offset:40960
    ds_read_b128 v[24:27], v1 offset:41984
    s_mov_b64 exec, -1
    v_exp_f32 v60, v60
    v_exp_f32 v61, v61
    v_exp_f32 v62, v62
    v_exp_f32 v63, v63
    v_cvt_pk_bf16_f32 v76, v56, v57
    v_cvt_pk_bf16_f32 v77, v58, v59
    v_cvt_pk_bf16_f32 v78, v60, v61
    v_cvt_pk_bf16_f32 v79, v62, v63
    s_waitcnt lgkmcnt(2)
    v_mfma_f32_32x32x16_bf16 v[48:63], v[12:15], v[4:7], 0
    v_exp_f32 v32, v32
    v_exp_f32 v33, v33
    v_exp_f32 v34, v34
    v_exp_f32 v35, v35
    v_mfma_f32_32x32x8bf16_1k v[48:63], v[16:17], v[8:9], v[48:63]
    s_waitcnt lgkmcnt(0)
    s_barrier
    v_add_u32 v3, 1024, v3
    ds_read_b128 v[12:15], v1 offset:0
    ds_read_u16 v16, v3 offset:0
    v_exp_f32 v36, v36
    v_exp_f32 v37, v37
    v_exp_f32 v38, v38
    v_exp_f32 v39, v39
    v_cvt_pk_bf16_f32 v64, v32, v33
    v_cvt_pk_bf16_f32 v65, v34, v35
    s_waitcnt lgkmcnt(2)
    v_mfma_f32_32x32x16_bf16 v[80:95], v[20:23], v[72:75], v[80:95]
    v_exp_f32 v40, v40
    v_exp_f32 v41, v41
    v_exp_f32 v42, v42
    v_exp_f32 v43, v43
    v_cvt_pk_bf16_f32 v66, v36, v37
    v_cvt_pk_bf16_f32 v67, v38, v39
    v_mfma_f32_32x32x16_bf16 v[80:95], v[24:27], v[76:79], v[80:95]
    s_mov_b64 exec, s[44:45]
    ds_read_b128 v[20:23], v1 offset:44032
    ds_read_b128 v[24:27], v1 offset:45056
    s_mov_b64 exec, -1
    v_exp_f32 v44, v44
    v_exp_f32 v45, v45
    v_exp_f32 v46, v46
    v_exp_f32 v47, v47
    v_cvt_pk_bf16_f32 v68, v40, v41
    v_cvt_pk_bf16_f32 v69, v42, v43
    v_cvt_pk_bf16_f32 v70, v44, v45
    v_cvt_pk_bf16_f32 v71, v46, v47
    s_waitcnt lgkmcnt(2)
    v_mfma_f32_32x32x16_bf16 v[32:47], v[12:15], v[4:7], 0
    v_exp_f32 v48, v48
    v_exp_f32 v49, v49
    v_exp_f32 v50, v50
    v_exp_f32 v51, v51
    v_mfma_f32_32x32x8bf16_1k v[32:47], v[16:17], v[8:9], v[32:47]
    ds_read_b128 v[12:15], v1 offset:3072
    ds_read_u16 v16, v3 offset:64
    v_exp_f32 v52, v52
    v_exp_f32 v53, v53
    v_exp_f32 v54, v54
    v_exp_f32 v55, v55
    v_cvt_pk_bf16_f32 v72, v48, v49
    v_cvt_pk_bf16_f32 v73, v50, v51
    s_waitcnt lgkmcnt(2)
    v_mfma_f32_32x32x16_bf16 v[80:95], v[20:23], v[64:67], v[80:95]
    v_exp_f32 v56, v56
    v_exp_f32 v57, v57
    v_exp_f32 v58, v58
    v_exp_f32 v59, v59
    v_cvt_pk_bf16_f32 v74, v52, v53
    v_cvt_pk_bf16_f32 v75, v54, v55
    v_mfma_f32_32x32x16_bf16 v[80:95], v[24:27], v[68:71], v[80:95]
    s_mov_b64 exec, s[44:45]
    ds_read_b128 v[20:23], v1 offset:47104
    ds_read_b128 v[24:27], v1 offset:48128
    s_mov_b64 exec, -1
    v_exp_f32 v60, v60
    v_exp_f32 v61, v61
    v_exp_f32 v62, v62
    v_exp_f32 v63, v63
    v_cvt_pk_bf16_f32 v76, v56, v57
    v_cvt_pk_bf16_f32 v77, v58, v59
    v_cvt_pk_bf16_f32 v78, v60, v61
    v_cvt_pk_bf16_f32 v79, v62, v63
    s_sub_u32 s28, s28, 1
    s_cmp_lg_u32 s28, 0
    s_cbranch_scc1 LC_aloop
    s_waitcnt lgkmcnt(0)
    v_mfma_f32_32x32x16_bf16 v[80:95], v[20:23], v[72:75], v[80:95]
    v_mfma_f32_32x32x16_bf16 v[80:95], v[24:27], v[76:79], v[80:95]
    v_mov_b32 v96, 0x207
    s_nop 10
    v_cmp_class_f32 vcc, v80, v96
    s_nop 0
    s_mov_b64 s[30:31], vcc
    v_cmp_class_f32 vcc, v81, v96
    s_nop 0
    s_or_b64 s[30:31], s[30:31], vcc
    v_cmp_class_f32 vcc, v82, v96
    s_nop 0
    s_or_b64 s[30:31], s[30:31], vcc
    v_cmp_class_f32 vcc, v83, v96
    s_nop 0
    s_or_b64 s[30:31], s[30:31], vcc
    v_cmp_class_f32 vcc, v84, v96
    s_nop 0
    s_or_b64 s[30:31], s[30:31], vcc
    v_cmp_class_f32 vcc, v85, v96
    s_nop 0
    s_or_b64 s[30:31], s[30:31], vcc
    v_cmp_class_f32 vcc, v86, v96
    s_nop 0
    s_or_b64 s[30:31], s[30:31], vcc
    v_cmp_class_f32 vcc, v87, v96
    s_nop 0
    s_or_b64 s[30:31], s[30:31], vcc
    v_cmp_class_f32 vcc, v88, v96
    s_mov_b32 vcc_hi, 0
    s_or_b64 s[30:31], s[30:31], vcc
    v_cmp_class_f32 vcc, v89, v96
    s_mov_b32 vcc_hi, 0
    s_or_b64 s[30:31], s[30:31], vcc
    v_cmp_nlt_f32 vcc, 0x2b800000, v90
    s_nop 0
    s_or_b64 s[30:31], s[30:31], vcc
    v_cmp_ngt_f32 vcc, 0x53800000, v90
    s_nop 0
    s_or_b64 s[30:31], s[30:31], vcc
    s_cmp_eq_u64 s[30:31], 0
    s_cbranch_scc1 LC_fin
    v_mov_b32 v9, 0
    s_mul_i32 s32, s13, 196608
    s_add_u32 s32, s32, 27541504
    s_add_u32 s33, s26, 8192
    v_mov_b32 v96, 0xff800000
    s_mov_b32 s28, 0
LC_slow1:
    s_mul_i32 s34, s28, 3072
    s_add_u32 s34, s34, s32
    s_lshl_b32 s35, s28, 6
    s_add_u32 s35, s35, s33
    buffer_load_dwordx4 v[12:15], v1, s[16:19], s34 offen
    buffer_load_ushort v16, v104, s[16:19], s35 offen
    s_waitcnt vmcnt(0)
    v_mfma_f32_32x32x16_bf16 v[32:47], v[12:15], v[4:7], 0
    v_mfma_f32_32x32x8bf16_1k v[32:47], v[16:17], v[8:9], v[32:47]
    s_nop 11
    v_max3_f32 v96, v96, v32, v33
    v_max3_f32 v96, v96, v34, v35
    v_max3_f32 v96, v96, v36, v37
    v_max3_f32 v96, v96, v38, v39
    v_max3_f32 v96, v96, v40, v41
    v_max3_f32 v96, v96, v42, v43
    v_max3_f32 v96, v96, v44, v45
    v_max3_f32 v96, v96, v46, v47
    s_add_u32 s28, s28, 1
    s_cmp_lt_u32 s28, 64
    s_cbranch_scc1 LC_slow1
    v_mov_b32 v97, v96
    s_nop 1
    v_permlane32_swap_b32 v96, v97
    v_max_f32 v96, v96, v97
    v_mov_b32 v80, 0
    v_mov_b32 v81, 0
    v_mov_b32 v82, 0
    v_mov_b32 v83, 0
    v_mov_b32 v84, 0
    v_mov_b32 v85, 0
    v_mov_b32 v86, 0
    v_mov_b32 v87, 0
    v_mov_b32 v88, 0
    v_mov_b32 v89, 0
    v_mov_b32 v90, 0
    v_mov_b32 v91, 0
    v_mov_b32 v92, 0
    v_mov_b32 v93, 0
    v_mov_b32 v94, 0
    v_mov_b32 v95, 0
    s_mov_b32 s28, 0
LC_slow2:
    s_mul_i32 s34, s28, 3072
    s_add_u32 s34, s34, s32
    s_lshl_b32 s35, s28, 6
    s_add_u32 s35, s35, s33
    buffer_load_dwordx4 v[12:15], v1, s[16:19], s34 offen
    buffer_load_ushort v16, v104, s[16:19], s35 offen
    buffer_load_dwordx4 v[20:23], v1, s[16:19], s34 offen offset:1024
    buffer_load_dwordx4 v[24:27], v1, s[16:19], s34 offen offset:2048
    s_waitcnt vmcnt(0)
    v_mfma_f32_32x32x16_bf16 v[32:47], v[12:15], v[4:7], 0
    v_mfma_f32_32x32x8bf16_1k v[32:47], v[16:17], v[8:9], v[32:47]
    s_nop 11
    v_sub_f32 v32, v32, v96
    v_sub_f32 v33, v33, v96
    v_sub_f32 v34, v34, v96
    v_sub_f32 v35, v35, v96
    v_sub_f32 v36, v36, v96
    v_sub_f32 v37, v37, v96
    v_sub_f32 v38, v38, v96
    v_sub_f32 v39, v39, v96
    v_sub_f32 v40, v40, v96
    v_sub_f32 v41, v41, v96
    v_sub_f32 v42, v42, v96
    v_sub_f32 v43, v43, v96
    v_sub_f32 v44, v44, v96
    v_sub_f32 v45, v45, v96
    v_sub_f32 v46, v46, v96
    v_sub_f32 v47, v47, v96
    v_exp_f32 v32, v32
    v_exp_f32 v33, v33
    v_exp_f32 v34, v34
    v_exp_f32 v35, v35
    v_exp_f32 v36, v36
    v_exp_f32 v37, v37
    v_exp_f32 v38, v38
    v_exp_f32 v39, v39
    v_exp_f32 v40, v40
    v_exp_f32 v41, v41
    v_exp_f32 v42, v42
    v_exp_f32 v43, v43
    v_exp_f32 v44, v44
    v_exp_f32 v45, v45
    v_exp_f32 v46, v46
    v_exp_f32 v47, v47
    v_cvt_pk_bf16_f32 v64, v32, v33
    v_cvt_pk_bf16_f32 v65, v34, v35
    v_cvt_pk_bf16_f32 v66, v36, v37
    v_cvt_pk_bf16_f32 v67, v38, v39
    v_cvt_pk_bf16_f32 v68, v40, v41
    v_cvt_pk_bf16_f32 v69, v42, v43
    v_cvt_pk_bf16_f32 v70, v44, v45
    v_cvt_pk_bf16_f32 v71, v46, v47
    v_mfma_f32_32x32x16_bf16 v[80:95], v[20:23], v[64:67], v[80:95]
    s_nop 0
    v_mfma_f32_32x32x16_bf16 v[80:95], v[24:27], v[68:71], v[80:95]
    s_add_u32 s28, s28, 1
    s_cmp_lt_u32 s28, 64
    s_cbranch_scc1 LC_slow2
    s_nop 15
LC_fin:
    v_rcp_f32 v96, v90
    s_nop 0
    v_mul_f32 v80, v80, v96
    v_mul_f32 v81, v81, v96
    v_mul_f32 v82, v82, v96
    v_mul_f32 v83, v83, v96
    v_mul_f32 v84, v84, v96
    v_mul_f32 v85, v85, v96
    v_mul_f32 v86, v86, v96
    v_mul_f32 v87, v87, v96
    v_mul_f32 v88, v88, v96
    v_mul_f32 v89, v89, v96
    v_cvt_pk_bf16_f32 v64, v80, v81
    v_cvt_pk_bf16_f32 v65, v82, v83
    v_cvt_pk_bf16_f32 v66, v84, v85
    v_cvt_pk_bf16_f32 v67, v86, v87
    v_cvt_pk_bf16_f32 v68, v88, v89
    s_mul_i32 s34, s24, 36
    s_add_u32 s35, s34, s13
    s_lshl_b32 s35, s35, 10
    s_add_u32 s35, s35, 34357248
    buffer_store_dwordx4 v[64:67], v1, s[16:19], s35 offen sc1
    s_lshl_b32 s35, s24, 5
    s_add_u32 s35, s35, s13
    s_lshl_b32 s35, s35, 7
    s_add_u32 s35, s35, 36716544
    v_lshlrev_b32 v2, 2, v0
    s_mov_b32 exec_hi, 0
    buffer_store_dword v68, v2, s[16:19], s35 offen sc1
    s_lshl_b32 s36, s24, 7
    s_add_u32 s36, s36, 36978688
    v_mov_b32 v2, 1
    v_mov_b32 v3, 0
    s_mov_b64 exec, 1
    s_waitcnt vmcnt(0)
    buffer_atomic_add v2, v3, s[16:19], s36 offen
    s_mov_b64 exec, -1
    s_branch LC_tail
LC_gemm:
    s_sub_u32 s24, s3, 8
    s_mul_i32 s26, s24, 3072
    s_mul_i32 s25, s13, 196608
    s_add_u32 s25, s25, s26
    s_add_u32 s25, s25, 27541504
    s_lshl_b32 s32, s13, 14
    s_lshl_b32 s33, s24, 11
    s_add_u32 s32, s32, s33
    s_add_u32 s32, s32, 33841152
    s_add_u32 m0, s26, 0
    s_add_u32 s31, s25, 0
    buffer_load_dwordx4 v1, s[16:19], s31 offen lds
    s_add_u32 m0, s26, 1024
    s_add_u32 s31, s25, 1024
    buffer_load_dwordx4 v1, s[16:19], s31 offen lds
    s_add_u32 m0, s26, 2048
    s_add_u32 s31, s25, 2048
    buffer_load_dwordx4 v1, s[16:19], s31 offen lds
    s_add_u32 m0, s33, 147456
    s_add_u32 s31, s32, 0
    buffer_load_dwordx4 v1, s[16:19], s31 offen lds
    s_add_u32 m0, s33, 148480
    s_add_u32 s31, s32, 1024
    buffer_load_dwordx4 v1, s[16:19], s31 offen lds
    s_add_u32 m0, s26, 12288
    s_add_u32 s31, s25, 12288
    buffer_load_dwordx4 v1, s[16:19], s31 offen lds
    s_add_u32 m0, s26, 13312
    s_add_u32 s31, s25, 13312
    buffer_load_dwordx4 v1, s[16:19], s31 offen lds
    s_add_u32 m0, s26, 14336
    s_add_u32 s31, s25, 14336
    buffer_load_dwordx4 v1, s[16:19], s31 offen lds
    s_mov_b32 s20, s8
    s_mov_b32 s21, s9
    s_mov_b32 s22, 5308416
    s_mov_b32 s23, 0x20000
    s_lshl_b32 s32, s12, 1
    s_lshr_b32 s33, s14, 4
    s_add_u32 s32, s32, s33
    s_cmp_eq_u32 s32, 15
    s_cbranch_scc1 LC_idle
    s_mul_i32 s33, s32, 0x56
    s_lshr_b32 s33, s33, 8
    s_mul_i32 s34, s33, 3
    s_sub_u32 s34, s32, s34
    s_and_b32 s35, s14, 15
    s_mul_i32 s36, s33, 60
    s_mul_i32 s37, s33, 56
    s_add_u32 s37, s37, 8
    s_cmp_lt_u32 s33, 2
    s_cselect_b32 s36, s36, s37
    s_cselect_b32 s30, 15, 14
    s_add_u32 s27, s36, s24
    s_mul_i32 s27, s27, 18432
    s_mul_i32 s37, s34, 384
    s_add_u32 s27, s27, s37
    s_mul_i32 s28, s24, 6144
    v_add_u32 v8, 0, v0
    v_mul_u32_u24 v9, 0xaab, v8
    v_lshrrev_b32 v9, 16, v9
    v_mul_u32_u24 v10, 24, v9
    v_sub_u32 v10, v8, v10
    v_and_b32 v11, 2, v9
    v_lshlrev_b32 v11, 1, v11
    v_xor_b32 v10, v10, v11
    v_mul_u32_u24 v9, 1152, v9
    v_lshl_add_u32 v2, v10, 4, v9
    v_add_u32 v8, 64, v0
    v_mul_u32_u24 v9, 0xaab, v8
    v_lshrrev_b32 v9, 16, v9
    v_mul_u32_u24 v10, 24, v9
    v_sub_u32 v10, v8, v10
    v_and_b32 v11, 2, v9
    v_lshlrev_b32 v11, 1, v11
    v_xor_b32 v10, v10, v11
    v_mul_u32_u24 v9, 1152, v9
    v_lshl_add_u32 v3, v10, 4, v9
    v_add_u32 v8, 128, v0
    v_mul_u32_u24 v9, 0xaab, v8
    v_lshrrev_b32 v9, 16, v9
    v_mul_u32_u24 v10, 24, v9
    v_sub_u32 v10, v8, v10
    v_and_b32 v11, 2, v9
    v_lshlrev_b32 v11, 1, v11
    v_xor_b32 v10, v10, v11
    v_mul_u32_u24 v9, 1152, v9
    v_lshl_add_u32 v4, v10, 4, v9
    s_add_u32 m0, s28, 49152
    s_add_u32 s31, s27, 0
    buffer_load_dwordx4 v2, s[20:23], s31 offen lds
    s_add_u32 m0, s28, 50176
    s_add_u32 s31, s27, 0
    buffer_load_dwordx4 v3, s[20:23], s31 offen lds
    s_add_u32 m0, s28, 51200
    s_add_u32 s31, s27, 0
    buffer_load_dwordx4 v4, s[20:23], s31 offen lds
    s_add_u32 m0, s28, 52224
    s_add_u32 s31, s27, 9216
    buffer_load_dwordx4 v2, s[20:23], s31 offen lds
    s_add_u32 m0, s28, 53248
    s_add_u32 s31, s27, 9216
    buffer_load_dwordx4 v3, s[20:23], s31 offen lds
    s_add_u32 m0, s28, 54272
    s_add_u32 s31, s27, 9216
    buffer_load_dwordx4 v4, s[20:23], s31 offen lds
    s_lshl_b32 s38, s35, 2
    s_and_b32 s37, s24, 2
    s_add_u32 s38, s38, s37
    s_mul_i32 s29, s38, 288
    s_add_u32 s29, s29, s36
    s_lshl_b32 s29, s29, 10
    s_add_u32 s29, s29, 6569984
    s_add_u32 s40, s29, 294912
    s_lshr_b32 s39, s38, 1
    s_mul_i32 s39, s39, 6
    s_lshl_b32 s37, s34, 1
    s_add_u32 s39, s39, s37
    s_and_b32 s41, s24, 1
    s_add_u32 s39, s39, s41
    s_mul_i32 s39, s39, 61568
    s_add_u32 s48, s39, 37089280
    s_mul_i32 s37, s33, 12288
    s_add_u32 s39, s39, s37
    s_add_u32 s39, s39, 37027840
    v_lshrrev_b32 v8, 5, v0
    v_bfe_u32 v9, v0, 2, 2
    v_lshl_add_u32 v8, v8, 2, v9
    v_mul_u32_u24 v8, 384, v8
    v_bfe_u32 v10, v0, 4, 1
    v_lshl_add_u32 v8, v10, 5, v8
    v_and_b32 v10, 3, v0
    v_lshl_add_u32 v8, v10, 3, v8
    s_mul_i32 s37, s41, 192
    s_add_u32 s37, s37, 49152
    v_add_u32 v8, s37, v8
    v_lshrrev_b32 v9, 1, v9
    s_cmp_eq_u32 s41, 0
    s_cselect_b32 s37, 64, -64
    v_mul_i32_i24 v9, s37, v9
    v_add_u32 v6, v8, v9
    v_sub_u32 v7, v8, v9
    s_waitcnt vmcnt(9)
    s_barrier
    s_add_u32 m0, s26, 24576
    s_add_u32 s31, s25, 24576
    buffer_load_dwordx4 v1, s[16:19], s31 offen lds
    s_add_u32 m0, s26, 25600
    s_add_u32 s31, s25, 25600
    buffer_load_dwordx4 v1, s[16:19], s31 offen lds
    s_add_u32 m0, s26, 26624
    s_add_u32 s31, s25, 26624
    buffer_load_dwordx4 v1, s[16:19], s31 offen lds
    buffer_load_dwordx4 v[24:27], v1, s[16:19], s29 offen offset:0
    buffer_load_dwordx4 v[28:31], v1, s[16:19], s40 offen offset:0
    buffer_load_dwordx4 v[32:35], v1, s[16:19], s29 offen offset:1024
    buffer_load_dwordx4 v[36:39], v1, s[16:19], s40 offen offset:1024
    s_add_u32 m0, s28, 73728
    s_add_u32 s31, s27, 73728
    buffer_load_dwordx4 v2, s[20:23], s31 offen lds
    s_add_u32 m0, s28, 74752
    s_add_u32 s31, s27, 73728
    buffer_load_dwordx4 v3, s[20:23], s31 offen lds
    s_add_u32 m0, s28, 75776
    s_add_u32 s31, s27, 73728
    buffer_load_dwordx4 v4, s[20:23], s31 offen lds
    s_add_u32 m0, s28, 76800
    s_add_u32 s31, s27, 82944
    buffer_load_dwordx4 v2, s[20:23], s31 offen lds
    s_add_u32 m0, s28, 77824
    s_add_u32 s31, s27, 82944
    buffer_load_dwordx4 v3, s[20:23], s31 offen lds
    s_add_u32 m0, s28, 78848
    s_add_u32 s31, s27, 82944
    buffer_load_dwordx4 v4, s[20:23], s31 offen lds
    buffer_load_dwordx4 v[40:43], v1, s[16:19], s29 offen offset:2048
    buffer_load_dwordx4 v[44:47], v1, s[16:19], s40 offen offset:2048
    buffer_load_dwordx4 v[48:51], v1, s[16:19], s29 offen offset:3072
    buffer_load_dwordx4 v[52:55], v1, s[16:19], s40 offen offset:3072
    s_add_u32 s29, s29, 4096
    s_add_u32 s40, s40, 4096
    buffer_load_dwordx4 v[56:59], v1, s[16:19], s29 offen offset:0
    buffer_load_dwordx4 v[60:63], v1, s[16:19], s40 offen offset:0
    s_add_u32 m0, s28, 98304
    s_add_u32 s31, s27, 147456
    buffer_load_dwordx4 v2, s[20:23], s31 offen lds
    s_add_u32 m0, s28, 99328
    s_add_u32 s31, s27, 147456
    buffer_load_dwordx4 v3, s[20:23], s31 offen lds
    s_add_u32 m0, s28, 100352
    s_add_u32 s31, s27, 147456
    buffer_load_dwordx4 v4, s[20:23], s31 offen lds
    s_add_u32 m0, s28, 101376
    s_add_u32 s31, s27, 156672
    buffer_load_dwordx4 v2, s[20:23], s31 offen lds
    s_add_u32 m0, s28, 102400
    s_add_u32 s31, s27, 156672
    buffer_load_dwordx4 v3, s[20:23], s31 offen lds
    s_add_u32 m0, s28, 103424
    s_add_u32 s31, s27, 156672
    buffer_load_dwordx4 v4, s[20:23], s31 offen lds
    s_waitcnt vmcnt(12)
    s_barrier
    ds_read_b64_tr_b16 v[8:9], v6 offset:0
    ds_read_b64_tr_b16 v[10:11], v6 offset:3072
    ds_read_b64_tr_b16 v[12:13], v7 offset:64
    ds_read_b64_tr_b16 v[14:15], v7 offset:3136
    s_add_u32 m0, s26, 36864
    s_add_u32 s31, s25, 36864
    buffer_load_dwordx4 v1, s[16:19], s31 offen lds
    s_add_u32 m0, s26, 37888
    s_add_u32 s31, s25, 37888
    buffer_load_dwordx4 v1, s[16:19], s31 offen lds
    s_add_u32 m0, s26, 38912
    s_add_u32 s31, s25, 38912
    buffer_load_dwordx4 v1, s[16:19], s31 offen lds
    ds_read_b64_tr_b16 v[16:17], v6 offset:128
    ds_read_b64_tr_b16 v[18:19], v6 offset:3200
    s_waitcnt vmcnt(23) lgkmcnt(4)
    v_mfma_f32_32x32x16_bf16 v[64:79], v[8:11], v[24:27], 0
    s_add_u32 m0, s28, 122880
    s_add_u32 s31, s27, 221184
    buffer_load_dwordx4 v2, s[20:23], s31 offen lds
    v_mfma_f32_32x32x16_bf16 v[112:127], v[8:11], v[28:31], 0
    ds_read_b64_tr_b16 v[20:21], v6 offset:6144
    ds_read_b64_tr_b16 v[22:23], v6 offset:9216
    s_waitcnt lgkmcnt(4)
    v_mfma_f32_32x32x16_bf16 v[80:95], v[12:15], v[24:27], 0
    s_add_u32 m0, s28, 123904
    s_add_u32 s31, s27, 221184
    buffer_load_dwordx4 v3, s[20:23], s31 offen lds
    v_mfma_f32_32x32x16_bf16 v[128:143], v[12:15], v[28:31], 0
    ds_read_b64_tr_b16 v[8:9], v7 offset:6208
    ds_read_b64_tr_b16 v[10:11], v7 offset:9280
    s_waitcnt lgkmcnt(4)
    v_mfma_f32_32x32x16_bf16 v[96:111], v[16:19], v[24:27], 0
    s_add_u32 m0, s28, 124928
    s_add_u32 s31, s27, 221184
    buffer_load_dwordx4 v4, s[20:23], s31 offen lds
    v_mfma_f32_32x32x16_bf16 v[144:159], v[16:19], v[28:31], 0
    buffer_load_dwordx4 v[24:27], v1, s[16:19], s29 offen offset:1024
    buffer_load_dwordx4 v[28:31], v1, s[16:19], s40 offen offset:1024
    ds_read_b64_tr_b16 v[12:13], v6 offset:6272
    ds_read_b64_tr_b16 v[14:15], v6 offset:9344
    s_waitcnt vmcnt(26) lgkmcnt(4)
    v_mfma_f32_32x32x16_bf16 v[64:79], v[20:23], v[32:35], v[64:79]
    s_add_u32 m0, s28, 125952
    s_add_u32 s31, s27, 230400
    buffer_load_dwordx4 v2, s[20:23], s31 offen lds
    v_mfma_f32_32x32x16_bf16 v[112:127], v[20:23], v[36:39], v[112:127]
    ds_read_b64_tr_b16 v[16:17], v6 offset:12288
    ds_read_b64_tr_b16 v[18:19], v6 offset:15360
    s_waitcnt lgkmcnt(4)
    v_mfma_f32_32x32x16_bf16 v[80:95], v[8:11], v[32:35], v[80:95]
    s_add_u32 m0, s28, 126976
    s_add_u32 s31, s27, 230400
    buffer_load_dwordx4 v3, s[20:23], s31 offen lds
    v_mfma_f32_32x32x16_bf16 v[128:143], v[8:11], v[36:39], v[128:143]
    ds_read_b64_tr_b16 v[20:21], v7 offset:12352
    ds_read_b64_tr_b16 v[22:23], v7 offset:15424
    s_waitcnt lgkmcnt(4)
    v_mfma_f32_32x32x16_bf16 v[96:111], v[12:15], v[32:35], v[96:111]
    s_add_u32 m0, s28, 128000
    s_add_u32 s31, s27, 230400
    buffer_load_dwordx4 v4, s[20:23], s31 offen lds
    v_mfma_f32_32x32x16_bf16 v[144:159], v[12:15], v[36:39], v[144:159]
    buffer_load_dwordx4 v[32:35], v1, s[16:19], s29 offen offset:2048
    buffer_load_dwordx4 v[36:39], v1, s[16:19], s40 offen offset:2048
    ds_read_b64_tr_b16 v[8:9], v6 offset:12416
    ds_read_b64_tr_b16 v[10:11], v6 offset:15488
    s_waitcnt vmcnt(23) lgkmcnt(4)
    v_mfma_f32_32x32x16_bf16 v[64:79], v[16:19], v[40:43], v[64:79]
    v_mfma_f32_32x32x16_bf16 v[112:127], v[16:19], v[44:47], v[112:127]
    ds_read_b64_tr_b16 v[12:13], v6 offset:18432
    ds_read_b64_tr_b16 v[14:15], v6 offset:21504
    s_waitcnt lgkmcnt(4)
    v_mfma_f32_32x32x16_bf16 v[80:95], v[20:23], v[40:43], v[80:95]
    v_mfma_f32_32x32x16_bf16 v[128:143], v[20:23], v[44:47], v[128:143]
    ds_read_b64_tr_b16 v[16:17], v7 offset:18496
    ds_read_b64_tr_b16 v[18:19], v7 offset:21568
    s_waitcnt lgkmcnt(4)
    v_mfma_f32_32x32x16_bf16 v[96:111], v[8:11], v[40:43], v[96:111]
    v_mfma_f32_32x32x16_bf16 v[144:159], v[8:11], v[44:47], v[144:159]
    buffer_load_dwordx4 v[40:43], v1, s[16:19], s29 offen offset:3072
    buffer_load_dwordx4 v[44:47], v1, s[16:19], s40 offen offset:3072
    ds_read_b64_tr_b16 v[20:21], v6 offset:18560
    ds_read_b64_tr_b16 v[22:23], v6 offset:21632
    s_waitcnt vmcnt(23) lgkmcnt(4)
    v_mfma_f32_32x32x16_bf16 v[64:79], v[12:15], v[48:51], v[64:79]
    v_mfma_f32_32x32x16_bf16 v[112:127], v[12:15], v[52:55], v[112:127]
    ds_read_b64_tr_b16 v[8:9], v6 offset:24576
    ds_read_b64_tr_b16 v[10:11], v6 offset:27648
    s_waitcnt lgkmcnt(4)
    v_mfma_f32_32x32x16_bf16 v[80:95], v[16:19], v[48:51], v[80:95]
    v_mfma_f32_32x32x16_bf16 v[128:143], v[16:19], v[52:55], v[128:143]
    ds_read_b64_tr_b16 v[12:13], v7 offset:24640
    ds_read_b64_tr_b16 v[14:15], v7 offset:27712
    s_waitcnt lgkmcnt(4)
    v_mfma_f32_32x32x16_bf16 v[96:111], v[20:23], v[48:51], v[96:111]
    v_mfma_f32_32x32x16_bf16 v[144:159], v[20:23], v[52:55], v[144:159]
    s_add_u32 s29, s29, 4096
    s_add_u32 s40, s40, 4096
    buffer_load_dwordx4 v[48:51], v1, s[16:19], s29 offen offset:0
    buffer_load_dwordx4 v[52:55], v1, s[16:19], s40 offen offset:0
    ds_read_b64_tr_b16 v[16:17], v6 offset:24704
    ds_read_b64_tr_b16 v[18:19], v6 offset:27776
    s_waitcnt vmcnt(23) lgkmcnt(4)
    v_mfma_f32_32x32x16_bf16 v[64:79], v[8:11], v[56:59], v[64:79]
    v_mfma_f32_32x32x16_bf16 v[112:127], v[8:11], v[60:63], v[112:127]
    ds_read_b64_tr_b16 v[20:21], v6 offset:30720
    ds_read_b64_tr_b16 v[22:23], v6 offset:33792
    s_waitcnt lgkmcnt(4)
    v_mfma_f32_32x32x16_bf16 v[80:95], v[12:15], v[56:59], v[80:95]
    v_mfma_f32_32x32x16_bf16 v[128:143], v[12:15], v[60:63], v[128:143]
    ds_read_b64_tr_b16 v[8:9], v7 offset:30784
    ds_read_b64_tr_b16 v[10:11], v7 offset:33856
    s_waitcnt lgkmcnt(4)
    v_mfma_f32_32x32x16_bf16 v[96:111], v[16:19], v[56:59], v[96:111]
    v_mfma_f32_32x32x16_bf16 v[144:159], v[16:19], v[60:63], v[144:159]
    buffer_load_dwordx4 v[56:59], v1, s[16:19], s29 offen offset:1024
    buffer_load_dwordx4 v[60:63], v1, s[16:19], s40 offen offset:1024
    ds_read_b64_tr_b16 v[12:13], v6 offset:30848
    ds_read_b64_tr_b16 v[14:15], v6 offset:33920
    s_waitcnt vmcnt(11) lgkmcnt(4)
    v_mfma_f32_32x32x16_bf16 v[64:79], v[20:23], v[24:27], v[64:79]
    v_mfma_f32_32x32x16_bf16 v[112:127], v[20:23], v[28:31], v[112:127]
    ds_read_b64_tr_b16 v[16:17], v6 offset:36864
    ds_read_b64_tr_b16 v[18:19], v6 offset:39936
    s_waitcnt lgkmcnt(4)
    v_mfma_f32_32x32x16_bf16 v[80:95], v[8:11], v[24:27], v[80:95]
    v_mfma_f32_32x32x16_bf16 v[128:143], v[8:11], v[28:31], v[128:143]
    ds_read_b64_tr_b16 v[20:21], v7 offset:36928
    ds_read_b64_tr_b16 v[22:23], v7 offset:40000
    s_waitcnt lgkmcnt(4)
    v_mfma_f32_32x32x16_bf16 v[96:111], v[12:15], v[24:27], v[96:111]
    v_mfma_f32_32x32x16_bf16 v[144:159], v[12:15], v[28:31], v[144:159]
    buffer_load_dwordx4 v[24:27], v1, s[16:19], s29 offen offset:2048
    buffer_load_dwordx4 v[28:31], v1, s[16:19], s40 offen offset:2048
    ds_read_b64_tr_b16 v[8:9], v6 offset:36992
    ds_read_b64_tr_b16 v[10:11], v6 offset:40064
    s_waitcnt vmcnt(8) lgkmcnt(4)
    v_mfma_f32_32x32x16_bf16 v[64:79], v[16:19], v[32:35], v[64:79]
    v_mfma_f32_32x32x16_bf16 v[112:127], v[16:19], v[36:39], v[112:127]
    ds_read_b64_tr_b16 v[12:13], v6 offset:43008
    ds_read_b64_tr_b16 v[14:15], v6 offset:46080
    s_waitcnt lgkmcnt(4)
    v_mfma_f32_32x32x16_bf16 v[80:95], v[20:23], v[32:35], v[80:95]
    v_mfma_f32_32x32x16_bf16 v[128:143], v[20:23], v[36:39], v[128:143]
    ds_read_b64_tr_b16 v[16:17], v7 offset:43072
    ds_read_b64_tr_b16 v[18:19], v7 offset:46144
    s_waitcnt lgkmcnt(4)
    v_mfma_f32_32x32x16_bf16 v[96:111], v[8:11], v[32:35], v[96:111]
    v_mfma_f32_32x32x16_bf16 v[144:159], v[8:11], v[36:39], v[144:159]
    buffer_load_dwordx4 v[32:35], v1, s[16:19], s29 offen offset:3072
    buffer_load_dwordx4 v[36:39], v1, s[16:19], s40 offen offset:3072
    ds_read_b64_tr_b16 v[20:21], v6 offset:43136
    ds_read_b64_tr_b16 v[22:23], v6 offset:46208
    s_waitcnt vmcnt(8) lgkmcnt(4)
    v_mfma_f32_32x32x16_bf16 v[64:79], v[12:15], v[40:43], v[64:79]
    v_mfma_f32_32x32x16_bf16 v[112:127], v[12:15], v[44:47], v[112:127]
    s_waitcnt lgkmcnt(2)
    v_mfma_f32_32x32x16_bf16 v[80:95], v[16:19], v[40:43], v[80:95]
    v_mfma_f32_32x32x16_bf16 v[128:143], v[16:19], v[44:47], v[128:143]
    s_waitcnt lgkmcnt(0)
    v_mfma_f32_32x32x16_bf16 v[96:111], v[20:23], v[40:43], v[96:111]
    v_mfma_f32_32x32x16_bf16 v[144:159], v[20:23], v[44:47], v[144:159]
    s_add_u32 s29, s29, 4096
    s_add_u32 s40, s40, 4096
    buffer_load_dwordx4 v[40:43], v1, s[16:19], s29 offen offset:0
    buffer_load_dwordx4 v[44:47], v1, s[16:19], s40 offen offset:0
    s_waitcnt vmcnt(25)
    s_barrier
    v_add_u32 v6, 49152, v6
    v_add_u32 v7, 49152, v7
    ds_read_b64_tr_b16 v[8:9], v6 offset:0
    ds_read_b64_tr_b16 v[10:11], v6 offset:3072
    ds_read_b64_tr_b16 v[12:13], v7 offset:64
    ds_read_b64_tr_b16 v[14:15], v7 offset:3136
    s_add_u32 m0, s26, 0
    s_add_u32 s31, s25, 49152
    buffer_load_dwordx4 v1, s[16:19], s31 offen lds
    s_add_u32 m0, s26, 1024
    s_add_u32 s31, s25, 50176
    buffer_load_dwordx4 v1, s[16:19], s31 offen lds
    s_add_u32 m0, s26, 2048
    s_add_u32 s31, s25, 51200
    buffer_load_dwordx4 v1, s[16:19], s31 offen lds
    ds_read_b64_tr_b16 v[16:17], v6 offset:128
    ds_read_b64_tr_b16 v[18:19], v6 offset:3200
    s_waitcnt vmcnt(11) lgkmcnt(4)
    v_mfma_f32_32x32x16_bf16 v[64:79], v[8:11], v[48:51], v[64:79]
    s_add_u32 m0, s28, 49152
    s_add_u32 s31, s27, 294912
    buffer_load_dwordx4 v2, s[20:23], s31 offen lds
    v_mfma_f32_32x32x16_bf16 v[112:127], v[8:11], v[52:55], v[112:127]
    s_add_u32 m0, s28, 50176
    s_add_u32 s31, s27, 294912
    buffer_load_dwordx4 v3, s[20:23], s31 offen lds
    ds_read_b64_tr_b16 v[20:21], v6 offset:6144
    ds_read_b64_tr_b16 v[22:23], v6 offset:9216
    s_waitcnt lgkmcnt(4)
    v_mfma_f32_32x32x16_bf16 v[80:95], v[12:15], v[48:51], v[80:95]
    s_add_u32 m0, s28, 51200
    s_add_u32 s31, s27, 294912
    buffer_load_dwordx4 v4, s[20:23], s31 offen lds
    v_mfma_f32_32x32x16_bf16 v[128:143], v[12:15], v[52:55], v[128:143]
    s_add_u32 m0, s28, 52224
    s_add_u32 s31, s27, 304128
    buffer_load_dwordx4 v2, s[20:23], s31 offen lds
    ds_read_b64_tr_b16 v[8:9], v7 offset:6208
    ds_read_b64_tr_b16 v[10:11], v7 offset:9280
    s_waitcnt lgkmcnt(4)
    v_mfma_f32_32x32x16_bf16 v[96:111], v[16:19], v[48:51], v[96:111]
    s_add_u32 m0, s28, 53248
    s_add_u32 s31, s27, 304128
    buffer_load_dwordx4 v3, s[20:23], s31 offen lds
    v_mfma_f32_32x32x16_bf16 v[144:159], v[16:19], v[52:55], v[144:159]
    s_add_u32 m0, s28, 54272
    s_add_u32 s31, s27, 304128
    buffer_load_dwordx4 v4, s[20:23], s31 offen lds
    buffer_load_dwordx4 v[48:51], v1, s[16:19], s29 offen offset:1024
    buffer_load_dwordx4 v[52:55], v1, s[16:19], s40 offen offset:1024
    ds_read_b64_tr_b16 v[12:13], v6 offset:6272
    ds_read_b64_tr_b16 v[14:15], v6 offset:9344
    s_waitcnt vmcnt(17) lgkmcnt(4)
    v_mfma_f32_32x32x16_bf16 v[64:79], v[20:23], v[56:59], v[64:79]
    s_add_u32 m0, s28, 73728
    s_add_u32 s31, s27, 368640
    buffer_load_dwordx4 v2, s[20:23], s31 offen lds
    v_mfma_f32_32x32x16_bf16 v[112:127], v[20:23], v[60:63], v[112:127]
    s_add_u32 m0, s28, 74752
    s_add_u32 s31, s27, 368640
    buffer_load_dwordx4 v3, s[20:23], s31 offen lds
    ds_read_b64_tr_b16 v[16:17], v6 offset:12288
    ds_read_b64_tr_b16 v[18:19], v6 offset:15360
    s_waitcnt lgkmcnt(4)
    v_mfma_f32_32x32x16_bf16 v[80:95], v[8:11], v[56:59], v[80:95]
    s_add_u32 m0, s28, 75776
    s_add_u32 s31, s27, 368640
    buffer_load_dwordx4 v4, s[20:23], s31 offen lds
    v_mfma_f32_32x32x16_bf16 v[128:143], v[8:11], v[60:63], v[128:143]
    s_add_u32 m0, s28, 76800
    s_add_u32 s31, s27, 377856
    buffer_load_dwordx4 v2, s[20:23], s31 offen lds
    ds_read_b64_tr_b16 v[20:21], v7 offset:12352
    ds_read_b64_tr_b16 v[22:23], v7 offset:15424
    s_waitcnt lgkmcnt(4)
    v_mfma_f32_32x32x16_bf16 v[96:111], v[12:15], v[56:59], v[96:111]
    s_add_u32 m0, s28, 77824
    s_add_u32 s31, s27, 377856
    buffer_load_dwordx4 v3, s[20:23], s31 offen lds
    v_mfma_f32_32x32x16_bf16 v[144:159], v[12:15], v[60:63], v[144:159]
    s_add_u32 m0, s28, 78848
    s_add_u32 s31, s27, 377856
    buffer_load_dwordx4 v4, s[20:23], s31 offen lds
    buffer_load_dwordx4 v[56:59], v1, s[16:19], s29 offen offset:2048
    buffer_load_dwordx4 v[60:63], v1, s[16:19], s40 offen offset:2048
    ds_read_b64_tr_b16 v[8:9], v6 offset:12416
    ds_read_b64_tr_b16 v[10:11], v6 offset:15488
    s_waitcnt vmcnt(23) lgkmcnt(4)
    v_mfma_f32_32x32x16_bf16 v[64:79], v[16:19], v[24:27], v[64:79]
    v_mfma_f32_32x32x16_bf16 v[112:127], v[16:19], v[28:31], v[112:127]
    ds_read_b64_tr_b16 v[12:13], v6 offset:18432
    ds_read_b64_tr_b16 v[14:15], v6 offset:21504
    s_waitcnt lgkmcnt(4)
    v_mfma_f32_32x32x16_bf16 v[80:95], v[20:23], v[24:27], v[80:95]
    v_mfma_f32_32x32x16_bf16 v[128:143], v[20:23], v[28:31], v[128:143]
    ds_read_b64_tr_b16 v[16:17], v7 offset:18496
    ds_read_b64_tr_b16 v[18:19], v7 offset:21568
    s_waitcnt lgkmcnt(4)
    v_mfma_f32_32x32x16_bf16 v[96:111], v[8:11], v[24:27], v[96:111]
    v_mfma_f32_32x32x16_bf16 v[144:159], v[8:11], v[28:31], v[144:159]
    buffer_load_dwordx4 v[24:27], v1, s[16:19], s29 offen offset:3072
    buffer_load_dwordx4 v[28:31], v1, s[16:19], s40 offen offset:3072
    ds_read_b64_tr_b16 v[20:21], v6 offset:18560
    ds_read_b64_tr_b16 v[22:23], v6 offset:21632
    s_waitcnt vmcnt(23) lgkmcnt(4)
    v_mfma_f32_32x32x16_bf16 v[64:79], v[12:15], v[32:35], v[64:79]
    v_mfma_f32_32x32x16_bf16 v[112:127], v[12:15], v[36:39], v[112:127]
    s_waitcnt lgkmcnt(2)
    v_mfma_f32_32x32x16_bf16 v[80:95], v[16:19], v[32:35], v[80:95]
    v_mfma_f32_32x32x16_bf16 v[128:143], v[16:19], v[36:39], v[128:143]
    s_waitcnt lgkmcnt(0)
    v_mfma_f32_32x32x16_bf16 v[96:111], v[20:23], v[32:35], v[96:111]
    v_mfma_f32_32x32x16_bf16 v[144:159], v[20:23], v[36:39], v[144:159]
    s_add_u32 s29, s29, 4096
    s_add_u32 s40, s40, 4096
    buffer_load_dwordx4 v[32:35], v1, s[16:19], s29 offen offset:0
    buffer_load_dwordx4 v[36:39], v1, s[16:19], s40 offen offset:0
    s_waitcnt vmcnt(37)
    s_barrier
    ds_read_b64_tr_b16 v[8:9], v6 offset:24576
    ds_read_b64_tr_b16 v[10:11], v6 offset:27648
    ds_read_b64_tr_b16 v[12:13], v7 offset:24640
    ds_read_b64_tr_b16 v[14:15], v7 offset:27712
    s_add_u32 m0, s26, 12288
    s_add_u32 s31, s25, 61440
    buffer_load_dwordx4 v1, s[16:19], s31 offen lds
    s_add_u32 m0, s26, 13312
    s_add_u32 s31, s25, 62464
    buffer_load_dwordx4 v1, s[16:19], s31 offen lds
    s_add_u32 m0, s26, 14336
    s_add_u32 s31, s25, 63488
    buffer_load_dwordx4 v1, s[16:19], s31 offen lds
    ds_read_b64_tr_b16 v[16:17], v6 offset:24704
    ds_read_b64_tr_b16 v[18:19], v6 offset:27776
    s_waitcnt vmcnt(26) lgkmcnt(4)
    v_mfma_f32_32x32x16_bf16 v[64:79], v[8:11], v[40:43], v[64:79]
    s_add_u32 m0, s28, 98304
    s_add_u32 s31, s27, 442368
    buffer_load_dwordx4 v2, s[20:23], s31 offen lds
    v_mfma_f32_32x32x16_bf16 v[112:127], v[8:11], v[44:47], v[112:127]
    ds_read_b64_tr_b16 v[20:21], v6 offset:30720
    ds_read_b64_tr_b16 v[22:23], v6 offset:33792
    s_waitcnt lgkmcnt(4)
    v_mfma_f32_32x32x16_bf16 v[80:95], v[12:15], v[40:43], v[80:95]
    s_add_u32 m0, s28, 99328
    s_add_u32 s31, s27, 442368
    buffer_load_dwordx4 v3, s[20:23], s31 offen lds
    v_mfma_f32_32x32x16_bf16 v[128:143], v[12:15], v[44:47], v[128:143]
    ds_read_b64_tr_b16 v[8:9], v7 offset:30784
    ds_read_b64_tr_b16 v[10:11], v7 offset:33856
    s_waitcnt lgkmcnt(4)
    v_mfma_f32_32x32x16_bf16 v[96:111], v[16:19], v[40:43], v[96:111]
    s_add_u32 m0, s28, 100352
    s_add_u32 s31, s27, 442368
    buffer_load_dwordx4 v4, s[20:23], s31 offen lds
    v_mfma_f32_32x32x16_bf16 v[144:159], v[16:19], v[44:47], v[144:159]
    buffer_load_dwordx4 v[40:43], v1, s[16:19], s29 offen offset:1024
    buffer_load_dwordx4 v[44:47], v1, s[16:19], s40 offen offset:1024
    ds_read_b64_tr_b16 v[12:13], v6 offset:30848
    ds_read_b64_tr_b16 v[14:15], v6 offset:33920
    s_waitcnt vmcnt(20) lgkmcnt(4)
    v_mfma_f32_32x32x16_bf16 v[64:79], v[20:23], v[48:51], v[64:79]
    s_add_u32 m0, s28, 101376
    s_add_u32 s31, s27, 451584
    buffer_load_dwordx4 v2, s[20:23], s31 offen lds
    v_mfma_f32_32x32x16_bf16 v[112:127], v[20:23], v[52:55], v[112:127]
    ds_read_b64_tr_b16 v[16:17], v6 offset:36864
    ds_read_b64_tr_b16 v[18:19], v6 offset:39936
    s_waitcnt lgkmcnt(4)
    v_mfma_f32_32x32x16_bf16 v[80:95], v[8:11], v[48:51], v[80:95]
    s_add_u32 m0, s28, 102400
    s_add_u32 s31, s27, 451584
    buffer_load_dwordx4 v3, s[20:23], s31 offen lds
    v_mfma_f32_32x32x16_bf16 v[128:143], v[8:11], v[52:55], v[128:143]
    ds_read_b64_tr_b16 v[20:21], v7 offset:36928
    ds_read_b64_tr_b16 v[22:23], v7 offset:40000
    s_waitcnt lgkmcnt(4)
    v_mfma_f32_32x32x16_bf16 v[96:111], v[12:15], v[48:51], v[96:111]
    s_add_u32 m0, s28, 103424
    s_add_u32 s31, s27, 451584
    buffer_load_dwordx4 v4, s[20:23], s31 offen lds
    v_mfma_f32_32x32x16_bf16 v[144:159], v[12:15], v[52:55], v[144:159]
    buffer_load_dwordx4 v[48:51], v1, s[16:19], s29 offen offset:2048
    buffer_load_dwordx4 v[52:55], v1, s[16:19], s40 offen offset:2048
    ds_read_b64_tr_b16 v[8:9], v6 offset:36992
    ds_read_b64_tr_b16 v[10:11], v6 offset:40064
    s_waitcnt vmcnt(17) lgkmcnt(4)
    v_mfma_f32_32x32x16_bf16 v[64:79], v[16:19], v[56:59], v[64:79]
    v_mfma_f32_32x32x16_bf16 v[112:127], v[16:19], v[60:63], v[112:127]
    ds_read_b64_tr_b16 v[12:13], v6 offset:43008
    ds_read_b64_tr_b16 v[14:15], v6 offset:46080
    s_waitcnt lgkmcnt(4)
    v_mfma_f32_32x32x16_bf16 v[80:95], v[20:23], v[56:59], v[80:95]
    v_mfma_f32_32x32x16_bf16 v[128:143], v[20:23], v[60:63], v[128:143]
    ds_read_b64_tr_b16 v[16:17], v7 offset:43072
    ds_read_b64_tr_b16 v[18:19], v7 offset:46144
    s_waitcnt lgkmcnt(4)
    v_mfma_f32_32x32x16_bf16 v[96:111], v[8:11], v[56:59], v[96:111]
    v_mfma_f32_32x32x16_bf16 v[144:159], v[8:11], v[60:63], v[144:159]
    buffer_load_dwordx4 v[56:59], v1, s[16:19], s29 offen offset:3072
    buffer_load_dwordx4 v[60:63], v1, s[16:19], s40 offen offset:3072
    ds_read_b64_tr_b16 v[20:21], v6 offset:43136
    ds_read_b64_tr_b16 v[22:23], v6 offset:46208
    s_waitcnt vmcnt(17) lgkmcnt(4)
    v_mfma_f32_32x32x16_bf16 v[64:79], v[12:15], v[24:27], v[64:79]
    v_mfma_f32_32x32x16_bf16 v[112:127], v[12:15], v[28:31], v[112:127]
    s_waitcnt lgkmcnt(2)
    v_mfma_f32_32x32x16_bf16 v[80:95], v[16:19], v[24:27], v[80:95]
    v_mfma_f32_32x32x16_bf16 v[128:143], v[16:19], v[28:31], v[128:143]
    s_waitcnt lgkmcnt(0)
    v_mfma_f32_32x32x16_bf16 v[96:111], v[20:23], v[24:27], v[96:111]
    v_mfma_f32_32x32x16_bf16 v[144:159], v[20:23], v[28:31], v[144:159]
    s_add_u32 s29, s29, 4096
    s_add_u32 s40, s40, 4096
    buffer_load_dwordx4 v[24:27], v1, s[16:19], s29 offen offset:0
    buffer_load_dwordx4 v[28:31], v1, s[16:19], s40 offen offset:0
    s_waitcnt vmcnt(31)
    s_barrier
    v_add_u32 v6, 4294918144, v6
    v_add_u32 v7, 4294918144, v7
    ds_read_b64_tr_b16 v[8:9], v6 offset:0
    ds_read_b64_tr_b16 v[10:11], v6 offset:3072
    ds_read_b64_tr_b16 v[12:13], v7 offset:64
    ds_read_b64_tr_b16 v[14:15], v7 offset:3136
    s_add_u32 m0, s26, 24576
    s_add_u32 s31, s25, 73728
    buffer_load_dwordx4 v1, s[16:19], s31 offen lds
    s_add_u32 m0, s26, 25600
    s_add_u32 s31, s25, 74752
    buffer_load_dwordx4 v1, s[16:19], s31 offen lds
    s_add_u32 m0, s26, 26624
    s_add_u32 s31, s25, 75776
    buffer_load_dwordx4 v1, s[16:19], s31 offen lds
    ds_read_b64_tr_b16 v[16:17], v6 offset:128
    ds_read_b64_tr_b16 v[18:19], v6 offset:3200
    s_waitcnt vmcnt(20) lgkmcnt(4)
    v_mfma_f32_32x32x16_bf16 v[64:79], v[8:11], v[32:35], v[64:79]
    s_add_u32 m0, s28, 122880
    s_add_u32 s31, s27, 516096
    buffer_load_dwordx4 v2, s[20:23], s31 offen lds
    v_mfma_f32_32x32x16_bf16 v[112:127], v[8:11], v[36:39], v[112:127]
    ds_read_b64_tr_b16 v[20:21], v6 offset:6144
    ds_read_b64_tr_b16 v[22:23], v6 offset:9216
    s_waitcnt lgkmcnt(4)
    v_mfma_f32_32x32x16_bf16 v[80:95], v[12:15], v[32:35], v[80:95]
    s_add_u32 m0, s28, 123904
    s_add_u32 s31, s27, 516096
    buffer_load_dwordx4 v3, s[20:23], s31 offen lds
    v_mfma_f32_32x32x16_bf16 v[128:143], v[12:15], v[36:39], v[128:143]
    ds_read_b64_tr_b16 v[8:9], v7 offset:6208
    ds_read_b64_tr_b16 v[10:11], v7 offset:9280
    s_waitcnt lgkmcnt(4)
    v_mfma_f32_32x32x16_bf16 v[96:111], v[16:19], v[32:35], v[96:111]
    s_add_u32 m0, s28, 124928
    s_add_u32 s31, s27, 516096
    buffer_load_dwordx4 v4, s[20:23], s31 offen lds
    v_mfma_f32_32x32x16_bf16 v[144:159], v[16:19], v[36:39], v[144:159]
    buffer_load_dwordx4 v[32:35], v1, s[16:19], s29 offen offset:1024
    buffer_load_dwordx4 v[36:39], v1, s[16:19], s40 offen offset:1024
    ds_read_b64_tr_b16 v[12:13], v6 offset:6272
    ds_read_b64_tr_b16 v[14:15], v6 offset:9344
    s_waitcnt vmcnt(17) lgkmcnt(4)
    v_mfma_f32_32x32x16_bf16 v[64:79], v[20:23], v[40:43], v[64:79]
    s_add_u32 m0, s28, 125952
    s_add_u32 s31, s27, 525312
    buffer_load_dwordx4 v2, s[20:23], s31 offen lds
    v_mfma_f32_32x32x16_bf16 v[112:127], v[20:23], v[44:47], v[112:127]
    ds_read_b64_tr_b16 v[16:17], v6 offset:12288
    ds_read_b64_tr_b16 v[18:19], v6 offset:15360
    s_waitcnt lgkmcnt(4)
    v_mfma_f32_32x32x16_bf16 v[80:95], v[8:11], v[40:43], v[80:95]
    s_add_u32 m0, s28, 126976
    s_add_u32 s31, s27, 525312
    buffer_load_dwordx4 v3, s[20:23], s31 offen lds
    v_mfma_f32_32x32x16_bf16 v[128:143], v[8:11], v[44:47], v[128:143]
    ds_read_b64_tr_b16 v[20:21], v7 offset:12352
    ds_read_b64_tr_b16 v[22:23], v7 offset:15424
    s_waitcnt lgkmcnt(4)
    v_mfma_f32_32x32x16_bf16 v[96:111], v[12:15], v[40:43], v[96:111]
    s_add_u32 m0, s28, 128000
    s_add_u32 s31, s27, 525312
    buffer_load_dwordx4 v4, s[20:23], s31 offen lds
    v_mfma_f32_32x32x16_bf16 v[144:159], v[12:15], v[44:47], v[144:159]
    buffer_load_dwordx4 v[40:43], v1, s[16:19], s29 offen offset:2048
    buffer_load_dwordx4 v[44:47], v1, s[16:19], s40 offen offset:2048
    ds_read_b64_tr_b16 v[8:9], v6 offset:12416
    ds_read_b64_tr_b16 v[10:11], v6 offset:15488
    s_waitcnt vmcnt(17) lgkmcnt(4)
    v_mfma_f32_32x32x16_bf16 v[64:79], v[16:19], v[48:51], v[64:79]
    v_mfma_f32_32x32x16_bf16 v[112:127], v[16:19], v[52:55], v[112:127]
    ds_read_b64_tr_b16 v[12:13], v6 offset:18432
    ds_read_b64_tr_b16 v[14:15], v6 offset:21504
    s_waitcnt lgkmcnt(4)
    v_mfma_f32_32x32x16_bf16 v[80:95], v[20:23], v[48:51], v[80:95]
    v_mfma_f32_32x32x16_bf16 v[128:143], v[20:23], v[52:55], v[128:143]
    ds_read_b64_tr_b16 v[16:17], v7 offset:18496
    ds_read_b64_tr_b16 v[18:19], v7 offset:21568
    s_waitcnt lgkmcnt(4)
    v_mfma_f32_32x32x16_bf16 v[96:111], v[8:11], v[48:51], v[96:111]
    v_mfma_f32_32x32x16_bf16 v[144:159], v[8:11], v[52:55], v[144:159]
    buffer_load_dwordx4 v[48:51], v1, s[16:19], s29 offen offset:3072
    buffer_load_dwordx4 v[52:55], v1, s[16:19], s40 offen offset:3072
    ds_read_b64_tr_b16 v[20:21], v6 offset:18560
    ds_read_b64_tr_b16 v[22:23], v6 offset:21632
    s_waitcnt vmcnt(17) lgkmcnt(4)
    v_mfma_f32_32x32x16_bf16 v[64:79], v[12:15], v[56:59], v[64:79]
    v_mfma_f32_32x32x16_bf16 v[112:127], v[12:15], v[60:63], v[112:127]
    s_waitcnt lgkmcnt(2)
    v_mfma_f32_32x32x16_bf16 v[80:95], v[16:19], v[56:59], v[80:95]
    v_mfma_f32_32x32x16_bf16 v[128:143], v[16:19], v[60:63], v[128:143]
    s_waitcnt lgkmcnt(0)
    v_mfma_f32_32x32x16_bf16 v[96:111], v[20:23], v[56:59], v[96:111]
    v_mfma_f32_32x32x16_bf16 v[144:159], v[20:23], v[60:63], v[144:159]
    s_add_u32 s29, s29, 4096
    s_add_u32 s40, s40, 4096
    buffer_load_dwordx4 v[56:59], v1, s[16:19], s29 offen offset:0
    buffer_load_dwordx4 v[60:63], v1, s[16:19], s40 offen offset:0
    s_waitcnt vmcnt(31)
    s_barrier
    ds_read_b64_tr_b16 v[8:9], v6 offset:24576
    ds_read_b64_tr_b16 v[10:11], v6 offset:27648
    ds_read_b64_tr_b16 v[12:13], v7 offset:24640
    ds_read_b64_tr_b16 v[14:15], v7 offset:27712
    s_add_u32 m0, s26, 36864
    s_add_u32 s31, s25, 86016
    buffer_load_dwordx4 v1, s[16:19], s31 offen lds
    s_add_u32 m0, s26, 37888
    s_add_u32 s31, s25, 87040
    buffer_load_dwordx4 v1, s[16:19], s31 offen lds
    s_add_u32 m0, s26, 38912
    s_add_u32 s31, s25, 88064
    buffer_load_dwordx4 v1, s[16:19], s31 offen lds
    ds_read_b64_tr_b16 v[16:17], v6 offset:24704
    ds_read_b64_tr_b16 v[18:19], v6 offset:27776
    s_waitcnt vmcnt(20) lgkmcnt(4)
    v_mfma_f32_32x32x16_bf16 v[64:79], v[8:11], v[24:27], v[64:79]
    s_add_u32 m0, s28, 49152
    s_add_u32 s31, s27, 589824
    buffer_load_dwordx4 v2, s[20:23], s31 offen lds
    v_mfma_f32_32x32x16_bf16 v[112:127], v[8:11], v[28:31], v[112:127]
    ds_read_b64_tr_b16 v[20:21], v6 offset:30720
    ds_read_b64_tr_b16 v[22:23], v6 offset:33792
    s_waitcnt lgkmcnt(4)
    v_mfma_f32_32x32x16_bf16 v[80:95], v[12:15], v[24:27], v[80:95]
    s_add_u32 m0, s28, 50176
    s_add_u32 s31, s27, 589824
    buffer_load_dwordx4 v3, s[20:23], s31 offen lds
    v_mfma_f32_32x32x16_bf16 v[128:143], v[12:15], v[28:31], v[128:143]
    ds_read_b64_tr_b16 v[8:9], v7 offset:30784
    ds_read_b64_tr_b16 v[10:11], v7 offset:33856
    s_waitcnt lgkmcnt(4)
    v_mfma_f32_32x32x16_bf16 v[96:111], v[16:19], v[24:27], v[96:111]
    s_add_u32 m0, s28, 51200
    s_add_u32 s31, s27, 589824
    buffer_load_dwordx4 v4, s[20:23], s31 offen lds
    v_mfma_f32_32x32x16_bf16 v[144:159], v[16:19], v[28:31], v[144:159]
    buffer_load_dwordx4 v[24:27], v1, s[16:19], s29 offen offset:1024
    buffer_load_dwordx4 v[28:31], v1, s[16:19], s40 offen offset:1024
    ds_read_b64_tr_b16 v[12:13], v6 offset:30848
    ds_read_b64_tr_b16 v[14:15], v6 offset:33920
    s_waitcnt vmcnt(17) lgkmcnt(4)
    v_mfma_f32_32x32x16_bf16 v[64:79], v[20:23], v[32:35], v[64:79]
    s_add_u32 m0, s28, 52224
    s_add_u32 s31, s27, 599040
    buffer_load_dwordx4 v2, s[20:23], s31 offen lds
    v_mfma_f32_32x32x16_bf16 v[112:127], v[20:23], v[36:39], v[112:127]
    ds_read_b64_tr_b16 v[16:17], v6 offset:36864
    ds_read_b64_tr_b16 v[18:19], v6 offset:39936
    s_waitcnt lgkmcnt(4)
    v_mfma_f32_32x32x16_bf16 v[80:95], v[8:11], v[32:35], v[80:95]
    s_add_u32 m0, s28, 53248
    s_add_u32 s31, s27, 599040
    buffer_load_dwordx4 v3, s[20:23], s31 offen lds
    v_mfma_f32_32x32x16_bf16 v[128:143], v[8:11], v[36:39], v[128:143]
    ds_read_b64_tr_b16 v[20:21], v7 offset:36928
    ds_read_b64_tr_b16 v[22:23], v7 offset:40000
    s_waitcnt lgkmcnt(4)
    v_mfma_f32_32x32x16_bf16 v[96:111], v[12:15], v[32:35], v[96:111]
    s_add_u32 m0, s28, 54272
    s_add_u32 s31, s27, 599040
    buffer_load_dwordx4 v4, s[20:23], s31 offen lds
    v_mfma_f32_32x32x16_bf16 v[144:159], v[12:15], v[36:39], v[144:159]
    buffer_load_dwordx4 v[32:35], v1, s[16:19], s29 offen offset:2048
    buffer_load_dwordx4 v[36:39], v1, s[16:19], s40 offen offset:2048
    ds_read_b64_tr_b16 v[8:9], v6 offset:36992
    ds_read_b64_tr_b16 v[10:11], v6 offset:40064
    s_waitcnt vmcnt(17) lgkmcnt(4)
    v_mfma_f32_32x32x16_bf16 v[64:79], v[16:19], v[40:43], v[64:79]
    v_mfma_f32_32x32x16_bf16 v[112:127], v[16:19], v[44:47], v[112:127]
    ds_read_b64_tr_b16 v[12:13], v6 offset:43008
    ds_read_b64_tr_b16 v[14:15], v6 offset:46080
    s_waitcnt lgkmcnt(4)
    v_mfma_f32_32x32x16_bf16 v[80:95], v[20:23], v[40:43], v[80:95]
    v_mfma_f32_32x32x16_bf16 v[128:143], v[20:23], v[44:47], v[128:143]
    ds_read_b64_tr_b16 v[16:17], v7 offset:43072
    ds_read_b64_tr_b16 v[18:19], v7 offset:46144
    s_waitcnt lgkmcnt(4)
    v_mfma_f32_32x32x16_bf16 v[96:111], v[8:11], v[40:43], v[96:111]
    v_mfma_f32_32x32x16_bf16 v[144:159], v[8:11], v[44:47], v[144:159]
    buffer_load_dwordx4 v[40:43], v1, s[16:19], s29 offen offset:3072
    buffer_load_dwordx4 v[44:47], v1, s[16:19], s40 offen offset:3072
    ds_read_b64_tr_b16 v[20:21], v6 offset:43136
    ds_read_b64_tr_b16 v[22:23], v6 offset:46208
    s_waitcnt vmcnt(17) lgkmcnt(4)
    v_mfma_f32_32x32x16_bf16 v[64:79], v[12:15], v[48:51], v[64:79]
    v_mfma_f32_32x32x16_bf16 v[112:127], v[12:15], v[52:55], v[112:127]
    s_waitcnt lgkmcnt(2)
    v_mfma_f32_32x32x16_bf16 v[80:95], v[16:19], v[48:51], v[80:95]
    v_mfma_f32_32x32x16_bf16 v[128:143], v[16:19], v[52:55], v[128:143]
    s_waitcnt lgkmcnt(0)
    v_mfma_f32_32x32x16_bf16 v[96:111], v[20:23], v[48:51], v[96:111]
    v_mfma_f32_32x32x16_bf16 v[144:159], v[20:23], v[52:55], v[144:159]
    s_add_u32 s29, s29, 4096
    s_add_u32 s40, s40, 4096
    buffer_load_dwordx4 v[48:51], v1, s[16:19], s29 offen offset:0
    buffer_load_dwordx4 v[52:55], v1, s[16:19], s40 offen offset:0
    s_waitcnt vmcnt(31)
    s_barrier
    v_add_u32 v6, 49152, v6
    v_add_u32 v7, 49152, v7
    ds_read_b64_tr_b16 v[8:9], v6 offset:0
    ds_read_b64_tr_b16 v[10:11], v6 offset:3072
    ds_read_b64_tr_b16 v[12:13], v7 offset:64
    ds_read_b64_tr_b16 v[14:15], v7 offset:3136
    s_add_u32 m0, s26, 0
    s_add_u32 s31, s25, 98304
    buffer_load_dwordx4 v1, s[16:19], s31 offen lds
    s_add_u32 m0, s26, 1024
    s_add_u32 s31, s25, 99328
    buffer_load_dwordx4 v1, s[16:19], s31 offen lds
    s_add_u32 m0, s26, 2048
    s_add_u32 s31, s25, 100352
    buffer_load_dwordx4 v1, s[16:19], s31 offen lds
    ds_read_b64_tr_b16 v[16:17], v6 offset:128
    ds_read_b64_tr_b16 v[18:19], v6 offset:3200
    s_waitcnt vmcnt(20) lgkmcnt(4)
    v_mfma_f32_32x32x16_bf16 v[64:79], v[8:11], v[56:59], v[64:79]
    s_add_u32 m0, s28, 73728
    s_add_u32 s31, s27, 663552
    buffer_load_dwordx4 v2, s[20:23], s31 offen lds
    v_mfma_f32_32x32x16_bf16 v[112:127], v[8:11], v[60:63], v[112:127]
    ds_read_b64_tr_b16 v[20:21], v6 offset:6144
    ds_read_b64_tr_b16 v[22:23], v6 offset:9216
    s_waitcnt lgkmcnt(4)
    v_mfma_f32_32x32x16_bf16 v[80:95], v[12:15], v[56:59], v[80:95]
    s_add_u32 m0, s28, 74752
    s_add_u32 s31, s27, 663552
    buffer_load_dwordx4 v3, s[20:23], s31 offen lds
    v_mfma_f32_32x32x16_bf16 v[128:143], v[12:15], v[60:63], v[128:143]
    ds_read_b64_tr_b16 v[8:9], v7 offset:6208
    ds_read_b64_tr_b16 v[10:11], v7 offset:9280
    s_waitcnt lgkmcnt(4)
    v_mfma_f32_32x32x16_bf16 v[96:111], v[16:19], v[56:59], v[96:111]
    s_add_u32 m0, s28, 75776
    s_add_u32 s31, s27, 663552
    buffer_load_dwordx4 v4, s[20:23], s31 offen lds
    v_mfma_f32_32x32x16_bf16 v[144:159], v[16:19], v[60:63], v[144:159]
    buffer_load_dwordx4 v[56:59], v1, s[16:19], s29 offen offset:1024
    buffer_load_dwordx4 v[60:63], v1, s[16:19], s40 offen offset:1024
    ds_read_b64_tr_b16 v[12:13], v6 offset:6272
    ds_read_b64_tr_b16 v[14:15], v6 offset:9344
    s_waitcnt vmcnt(17) lgkmcnt(4)
    v_mfma_f32_32x32x16_bf16 v[64:79], v[20:23], v[24:27], v[64:79]
    s_add_u32 m0, s28, 76800
    s_add_u32 s31, s27, 672768
    buffer_load_dwordx4 v2, s[20:23], s31 offen lds
    v_mfma_f32_32x32x16_bf16 v[112:127], v[20:23], v[28:31], v[112:127]
    ds_read_b64_tr_b16 v[16:17], v6 offset:12288
    ds_read_b64_tr_b16 v[18:19], v6 offset:15360
    s_waitcnt lgkmcnt(4)
    v_mfma_f32_32x32x16_bf16 v[80:95], v[8:11], v[24:27], v[80:95]
    s_add_u32 m0, s28, 77824
    s_add_u32 s31, s27, 672768
    buffer_load_dwordx4 v3, s[20:23], s31 offen lds
    v_mfma_f32_32x32x16_bf16 v[128:143], v[8:11], v[28:31], v[128:143]
    ds_read_b64_tr_b16 v[20:21], v7 offset:12352
    ds_read_b64_tr_b16 v[22:23], v7 offset:15424
    s_waitcnt lgkmcnt(4)
    v_mfma_f32_32x32x16_bf16 v[96:111], v[12:15], v[24:27], v[96:111]
    s_add_u32 m0, s28, 78848
    s_add_u32 s31, s27, 672768
    buffer_load_dwordx4 v4, s[20:23], s31 offen lds
    v_mfma_f32_32x32x16_bf16 v[144:159], v[12:15], v[28:31], v[144:159]
    buffer_load_dwordx4 v[24:27], v1, s[16:19], s29 offen offset:2048
    buffer_load_dwordx4 v[28:31], v1, s[16:19], s40 offen offset:2048
    ds_read_b64_tr_b16 v[8:9], v6 offset:12416
    ds_read_b64_tr_b16 v[10:11], v6 offset:15488
    s_waitcnt vmcnt(17) lgkmcnt(4)
    v_mfma_f32_32x32x16_bf16 v[64:79], v[16:19], v[32:35], v[64:79]
    v_mfma_f32_32x32x16_bf16 v[112:127], v[16:19], v[36:39], v[112:127]
    ds_read_b64_tr_b16 v[12:13], v6 offset:18432
    ds_read_b64_tr_b16 v[14:15], v6 offset:21504
    s_waitcnt lgkmcnt(4)
    v_mfma_f32_32x32x16_bf16 v[80:95], v[20:23], v[32:35], v[80:95]
    v_mfma_f32_32x32x16_bf16 v[128:143], v[20:23], v[36:39], v[128:143]
    ds_read_b64_tr_b16 v[16:17], v7 offset:18496
    ds_read_b64_tr_b16 v[18:19], v7 offset:21568
    s_waitcnt lgkmcnt(4)
    v_mfma_f32_32x32x16_bf16 v[96:111], v[8:11], v[32:35], v[96:111]
    v_mfma_f32_32x32x16_bf16 v[144:159], v[8:11], v[36:39], v[144:159]
    buffer_load_dwordx4 v[32:35], v1, s[16:19], s29 offen offset:3072
    buffer_load_dwordx4 v[36:39], v1, s[16:19], s40 offen offset:3072
    ds_read_b64_tr_b16 v[20:21], v6 offset:18560
    ds_read_b64_tr_b16 v[22:23], v6 offset:21632
    s_waitcnt vmcnt(17) lgkmcnt(4)
    v_mfma_f32_32x32x16_bf16 v[64:79], v[12:15], v[40:43], v[64:79]
    v_mfma_f32_32x32x16_bf16 v[112:127], v[12:15], v[44:47], v[112:127]
    s_waitcnt lgkmcnt(2)
    v_mfma_f32_32x32x16_bf16 v[80:95], v[16:19], v[40:43], v[80:95]
    v_mfma_f32_32x32x16_bf16 v[128:143], v[16:19], v[44:47], v[128:143]
    s_waitcnt lgkmcnt(0)
    v_mfma_f32_32x32x16_bf16 v[96:111], v[20:23], v[40:43], v[96:111]
    v_mfma_f32_32x32x16_bf16 v[144:159], v[20:23], v[44:47], v[144:159]
    s_add_u32 s29, s29, 4096
    s_add_u32 s40, s40, 4096
    buffer_load_dwordx4 v[40:43], v1, s[16:19], s29 offen offset:0
    buffer_load_dwordx4 v[44:47], v1, s[16:19], s40 offen offset:0
    s_waitcnt vmcnt(31)
    s_barrier
    ds_read_b64_tr_b16 v[8:9], v6 offset:24576
    ds_read_b64_tr_b16 v[10:11], v6 offset:27648
    ds_read_b64_tr_b16 v[12:13], v7 offset:24640
    ds_read_b64_tr_b16 v[14:15], v7 offset:27712
    s_add_u32 m0, s26, 12288
    s_add_u32 s31, s25, 110592
    buffer_load_dwordx4 v1, s[16:19], s31 offen lds
    s_add_u32 m0, s26, 13312
    s_add_u32 s31, s25, 111616
    buffer_load_dwordx4 v1, s[16:19], s31 offen lds
    s_add_u32 m0, s26, 14336
    s_add_u32 s31, s25, 112640
    buffer_load_dwordx4 v1, s[16:19], s31 offen lds
    ds_read_b64_tr_b16 v[16:17], v6 offset:24704
    ds_read_b64_tr_b16 v[18:19], v6 offset:27776
    s_waitcnt vmcnt(20) lgkmcnt(4)
    v_mfma_f32_32x32x16_bf16 v[64:79], v[8:11], v[48:51], v[64:79]
    s_add_u32 m0, s28, 98304
    s_add_u32 s31, s27, 737280
    buffer_load_dwordx4 v2, s[20:23], s31 offen lds
    v_mfma_f32_32x32x16_bf16 v[112:127], v[8:11], v[52:55], v[112:127]
    ds_read_b64_tr_b16 v[20:21], v6 offset:30720
    ds_read_b64_tr_b16 v[22:23], v6 offset:33792
    s_waitcnt lgkmcnt(4)
    v_mfma_f32_32x32x16_bf16 v[80:95], v[12:15], v[48:51], v[80:95]
    s_add_u32 m0, s28, 99328
    s_add_u32 s31, s27, 737280
    buffer_load_dwordx4 v3, s[20:23], s31 offen lds
    v_mfma_f32_32x32x16_bf16 v[128:143], v[12:15], v[52:55], v[128:143]
    ds_read_b64_tr_b16 v[8:9], v7 offset:30784
    ds_read_b64_tr_b16 v[10:11], v7 offset:33856
    s_waitcnt lgkmcnt(4)
    v_mfma_f32_32x32x16_bf16 v[96:111], v[16:19], v[48:51], v[96:111]
    s_add_u32 m0, s28, 100352
    s_add_u32 s31, s27, 737280
    buffer_load_dwordx4 v4, s[20:23], s31 offen lds
    v_mfma_f32_32x32x16_bf16 v[144:159], v[16:19], v[52:55], v[144:159]
    buffer_load_dwordx4 v[48:51], v1, s[16:19], s29 offen offset:1024
    buffer_load_dwordx4 v[52:55], v1, s[16:19], s40 offen offset:1024
    ds_read_b64_tr_b16 v[12:13], v6 offset:30848
    ds_read_b64_tr_b16 v[14:15], v6 offset:33920
    s_waitcnt vmcnt(17) lgkmcnt(4)
    v_mfma_f32_32x32x16_bf16 v[64:79], v[20:23], v[56:59], v[64:79]
    s_add_u32 m0, s28, 101376
    s_add_u32 s31, s27, 746496
    buffer_load_dwordx4 v2, s[20:23], s31 offen lds
    v_mfma_f32_32x32x16_bf16 v[112:127], v[20:23], v[60:63], v[112:127]
    ds_read_b64_tr_b16 v[16:17], v6 offset:36864
    ds_read_b64_tr_b16 v[18:19], v6 offset:39936
    s_waitcnt lgkmcnt(4)
    v_mfma_f32_32x32x16_bf16 v[80:95], v[8:11], v[56:59], v[80:95]
    s_add_u32 m0, s28, 102400
    s_add_u32 s31, s27, 746496
    buffer_load_dwordx4 v3, s[20:23], s31 offen lds
    v_mfma_f32_32x32x16_bf16 v[128:143], v[8:11], v[60:63], v[128:143]
    ds_read_b64_tr_b16 v[20:21], v7 offset:36928
    ds_read_b64_tr_b16 v[22:23], v7 offset:40000
    s_waitcnt lgkmcnt(4)
    v_mfma_f32_32x32x16_bf16 v[96:111], v[12:15], v[56:59], v[96:111]
    s_add_u32 m0, s28, 103424
    s_add_u32 s31, s27, 746496
    buffer_load_dwordx4 v4, s[20:23], s31 offen lds
    v_mfma_f32_32x32x16_bf16 v[144:159], v[12:15], v[60:63], v[144:159]
    buffer_load_dwordx4 v[56:59], v1, s[16:19], s29 offen offset:2048
    buffer_load_dwordx4 v[60:63], v1, s[16:19], s40 offen offset:2048
    ds_read_b64_tr_b16 v[8:9], v6 offset:36992
    ds_read_b64_tr_b16 v[10:11], v6 offset:40064
    s_waitcnt vmcnt(17) lgkmcnt(4)
    v_mfma_f32_32x32x16_bf16 v[64:79], v[16:19], v[24:27], v[64:79]
    v_mfma_f32_32x32x16_bf16 v[112:127], v[16:19], v[28:31], v[112:127]
    ds_read_b64_tr_b16 v[12:13], v6 offset:43008
    ds_read_b64_tr_b16 v[14:15], v6 offset:46080
    s_waitcnt lgkmcnt(4)
    v_mfma_f32_32x32x16_bf16 v[80:95], v[20:23], v[24:27], v[80:95]
    v_mfma_f32_32x32x16_bf16 v[128:143], v[20:23], v[28:31], v[128:143]
    ds_read_b64_tr_b16 v[16:17], v7 offset:43072
    ds_read_b64_tr_b16 v[18:19], v7 offset:46144
    s_waitcnt lgkmcnt(4)
    v_mfma_f32_32x32x16_bf16 v[96:111], v[8:11], v[24:27], v[96:111]
    v_mfma_f32_32x32x16_bf16 v[144:159], v[8:11], v[28:31], v[144:159]
    buffer_load_dwordx4 v[24:27], v1, s[16:19], s29 offen offset:3072
    buffer_load_dwordx4 v[28:31], v1, s[16:19], s40 offen offset:3072
    ds_read_b64_tr_b16 v[20:21], v6 offset:43136
    ds_read_b64_tr_b16 v[22:23], v6 offset:46208
    s_waitcnt vmcnt(17) lgkmcnt(4)
    v_mfma_f32_32x32x16_bf16 v[64:79], v[12:15], v[32:35], v[64:79]
    v_mfma_f32_32x32x16_bf16 v[112:127], v[12:15], v[36:39], v[112:127]
    s_waitcnt lgkmcnt(2)
    v_mfma_f32_32x32x16_bf16 v[80:95], v[16:19], v[32:35], v[80:95]
    v_mfma_f32_32x32x16_bf16 v[128:143], v[16:19], v[36:39], v[128:143]
    s_waitcnt lgkmcnt(0)
    v_mfma_f32_32x32x16_bf16 v[96:111], v[20:23], v[32:35], v[96:111]
    v_mfma_f32_32x32x16_bf16 v[144:159], v[20:23], v[36:39], v[144:159]
    s_add_u32 s29, s29, 4096
    s_add_u32 s40, s40, 4096
    buffer_load_dwordx4 v[32:35], v1, s[16:19], s29 offen offset:0
    buffer_load_dwordx4 v[36:39], v1, s[16:19], s40 offen offset:0
    s_waitcnt vmcnt(31)
    s_barrier
    v_add_u32 v6, 4294918144, v6
    v_add_u32 v7, 4294918144, v7
    ds_read_b64_tr_b16 v[8:9], v6 offset:0
    ds_read_b64_tr_b16 v[10:11], v6 offset:3072
    ds_read_b64_tr_b16 v[12:13], v7 offset:64
    ds_read_b64_tr_b16 v[14:15], v7 offset:3136
    s_add_u32 m0, s26, 24576
    s_add_u32 s31, s25, 122880
    buffer_load_dwordx4 v1, s[16:19], s31 offen lds
    s_add_u32 m0, s26, 25600
    s_add_u32 s31, s25, 123904
    buffer_load_dwordx4 v1, s[16:19], s31 offen lds
    s_add_u32 m0, s26, 26624
    s_add_u32 s31, s25, 124928
    buffer_load_dwordx4 v1, s[16:19], s31 offen lds
    ds_read_b64_tr_b16 v[16:17], v6 offset:128
    ds_read_b64_tr_b16 v[18:19], v6 offset:3200
    s_waitcnt vmcnt(20) lgkmcnt(4)
    v_mfma_f32_32x32x16_bf16 v[64:79], v[8:11], v[40:43], v[64:79]
    s_add_u32 m0, s28, 122880
    s_add_u32 s31, s27, 811008
    buffer_load_dwordx4 v2, s[20:23], s31 offen lds
    v_mfma_f32_32x32x16_bf16 v[112:127], v[8:11], v[44:47], v[112:127]
    ds_read_b64_tr_b16 v[20:21], v6 offset:6144
    ds_read_b64_tr_b16 v[22:23], v6 offset:9216
    s_waitcnt lgkmcnt(4)
    v_mfma_f32_32x32x16_bf16 v[80:95], v[12:15], v[40:43], v[80:95]
    s_add_u32 m0, s28, 123904
    s_add_u32 s31, s27, 811008
    buffer_load_dwordx4 v3, s[20:23], s31 offen lds
    v_mfma_f32_32x32x16_bf16 v[128:143], v[12:15], v[44:47], v[128:143]
    ds_read_b64_tr_b16 v[8:9], v7 offset:6208
    ds_read_b64_tr_b16 v[10:11], v7 offset:9280
    s_waitcnt lgkmcnt(4)
    v_mfma_f32_32x32x16_bf16 v[96:111], v[16:19], v[40:43], v[96:111]
    s_add_u32 m0, s28, 124928
    s_add_u32 s31, s27, 811008
    buffer_load_dwordx4 v4, s[20:23], s31 offen lds
    v_mfma_f32_32x32x16_bf16 v[144:159], v[16:19], v[44:47], v[144:159]
    buffer_load_dwordx4 v[40:43], v1, s[16:19], s29 offen offset:1024
    buffer_load_dwordx4 v[44:47], v1, s[16:19], s40 offen offset:1024
    ds_read_b64_tr_b16 v[12:13], v6 offset:6272
    ds_read_b64_tr_b16 v[14:15], v6 offset:9344
    s_waitcnt vmcnt(17) lgkmcnt(4)
    v_mfma_f32_32x32x16_bf16 v[64:79], v[20:23], v[48:51], v[64:79]
    s_add_u32 m0, s28, 125952
    s_add_u32 s31, s27, 820224
    buffer_load_dwordx4 v2, s[20:23], s31 offen lds
    v_mfma_f32_32x32x16_bf16 v[112:127], v[20:23], v[52:55], v[112:127]
    ds_read_b64_tr_b16 v[16:17], v6 offset:12288
    ds_read_b64_tr_b16 v[18:19], v6 offset:15360
    s_waitcnt lgkmcnt(4)
    v_mfma_f32_32x32x16_bf16 v[80:95], v[8:11], v[48:51], v[80:95]
    s_add_u32 m0, s28, 126976
    s_add_u32 s31, s27, 820224
    buffer_load_dwordx4 v3, s[20:23], s31 offen lds
    v_mfma_f32_32x32x16_bf16 v[128:143], v[8:11], v[52:55], v[128:143]
    ds_read_b64_tr_b16 v[20:21], v7 offset:12352
    ds_read_b64_tr_b16 v[22:23], v7 offset:15424
    s_waitcnt lgkmcnt(4)
    v_mfma_f32_32x32x16_bf16 v[96:111], v[12:15], v[48:51], v[96:111]
    s_add_u32 m0, s28, 128000
    s_add_u32 s31, s27, 820224
    buffer_load_dwordx4 v4, s[20:23], s31 offen lds
    v_mfma_f32_32x32x16_bf16 v[144:159], v[12:15], v[52:55], v[144:159]
    buffer_load_dwordx4 v[48:51], v1, s[16:19], s29 offen offset:2048
    buffer_load_dwordx4 v[52:55], v1, s[16:19], s40 offen offset:2048
    ds_read_b64_tr_b16 v[8:9], v6 offset:12416
    ds_read_b64_tr_b16 v[10:11], v6 offset:15488
    s_waitcnt vmcnt(17) lgkmcnt(4)
    v_mfma_f32_32x32x16_bf16 v[64:79], v[16:19], v[56:59], v[64:79]
    v_mfma_f32_32x32x16_bf16 v[112:127], v[16:19], v[60:63], v[112:127]
    ds_read_b64_tr_b16 v[12:13], v6 offset:18432
    ds_read_b64_tr_b16 v[14:15], v6 offset:21504
    s_waitcnt lgkmcnt(4)
    v_mfma_f32_32x32x16_bf16 v[80:95], v[20:23], v[56:59], v[80:95]
    v_mfma_f32_32x32x16_bf16 v[128:143], v[20:23], v[60:63], v[128:143]
    ds_read_b64_tr_b16 v[16:17], v7 offset:18496
    ds_read_b64_tr_b16 v[18:19], v7 offset:21568
    s_waitcnt lgkmcnt(4)
    v_mfma_f32_32x32x16_bf16 v[96:111], v[8:11], v[56:59], v[96:111]
    v_mfma_f32_32x32x16_bf16 v[144:159], v[8:11], v[60:63], v[144:159]
    buffer_load_dwordx4 v[56:59], v1, s[16:19], s29 offen offset:3072
    buffer_load_dwordx4 v[60:63], v1, s[16:19], s40 offen offset:3072
    ds_read_b64_tr_b16 v[20:21], v6 offset:18560
    ds_read_b64_tr_b16 v[22:23], v6 offset:21632
    s_waitcnt vmcnt(17) lgkmcnt(4)
    v_mfma_f32_32x32x16_bf16 v[64:79], v[12:15], v[24:27], v[64:79]
    v_mfma_f32_32x32x16_bf16 v[112:127], v[12:15], v[28:31], v[112:127]
    s_waitcnt lgkmcnt(2)
    v_mfma_f32_32x32x16_bf16 v[80:95], v[16:19], v[24:27], v[80:95]
    v_mfma_f32_32x32x16_bf16 v[128:143], v[16:19], v[28:31], v[128:143]
    s_waitcnt lgkmcnt(0)
    v_mfma_f32_32x32x16_bf16 v[96:111], v[20:23], v[24:27], v[96:111]
    v_mfma_f32_32x32x16_bf16 v[144:159], v[20:23], v[28:31], v[144:159]
    s_add_u32 s29, s29, 4096
    s_add_u32 s40, s40, 4096
    buffer_load_dwordx4 v[24:27], v1, s[16:19], s29 offen offset:0
    buffer_load_dwordx4 v[28:31], v1, s[16:19], s40 offen offset:0
    s_waitcnt vmcnt(31)
    s_barrier
    ds_read_b64_tr_b16 v[8:9], v6 offset:24576
    ds_read_b64_tr_b16 v[10:11], v6 offset:27648
    ds_read_b64_tr_b16 v[12:13], v7 offset:24640
    ds_read_b64_tr_b16 v[14:15], v7 offset:27712
    s_add_u32 m0, s26, 36864
    s_add_u32 s31, s25, 135168
    buffer_load_dwordx4 v1, s[16:19], s31 offen lds
    s_add_u32 m0, s26, 37888
    s_add_u32 s31, s25, 136192
    buffer_load_dwordx4 v1, s[16:19], s31 offen lds
    s_add_u32 m0, s26, 38912
    s_add_u32 s31, s25, 137216
    buffer_load_dwordx4 v1, s[16:19], s31 offen lds
    ds_read_b64_tr_b16 v[16:17], v6 offset:24704
    ds_read_b64_tr_b16 v[18:19], v6 offset:27776
    s_waitcnt vmcnt(20) lgkmcnt(4)
    v_mfma_f32_32x32x16_bf16 v[64:79], v[8:11], v[32:35], v[64:79]
    s_add_u32 m0, s28, 49152
    s_add_u32 s31, s27, 884736
    buffer_load_dwordx4 v2, s[20:23], s31 offen lds
    v_mfma_f32_32x32x16_bf16 v[112:127], v[8:11], v[36:39], v[112:127]
    ds_read_b64_tr_b16 v[20:21], v6 offset:30720
    ds_read_b64_tr_b16 v[22:23], v6 offset:33792
    s_waitcnt lgkmcnt(4)
    v_mfma_f32_32x32x16_bf16 v[80:95], v[12:15], v[32:35], v[80:95]
    s_add_u32 m0, s28, 50176
    s_add_u32 s31, s27, 884736
    buffer_load_dwordx4 v3, s[20:23], s31 offen lds
    v_mfma_f32_32x32x16_bf16 v[128:143], v[12:15], v[36:39], v[128:143]
    ds_read_b64_tr_b16 v[8:9], v7 offset:30784
    ds_read_b64_tr_b16 v[10:11], v7 offset:33856
    s_waitcnt lgkmcnt(4)
    v_mfma_f32_32x32x16_bf16 v[96:111], v[16:19], v[32:35], v[96:111]
    s_add_u32 m0, s28, 51200
    s_add_u32 s31, s27, 884736
    buffer_load_dwordx4 v4, s[20:23], s31 offen lds
    v_mfma_f32_32x32x16_bf16 v[144:159], v[16:19], v[36:39], v[144:159]
    buffer_load_dwordx4 v[32:35], v1, s[16:19], s29 offen offset:1024
    buffer_load_dwordx4 v[36:39], v1, s[16:19], s40 offen offset:1024
    ds_read_b64_tr_b16 v[12:13], v6 offset:30848
    ds_read_b64_tr_b16 v[14:15], v6 offset:33920
    s_waitcnt vmcnt(17) lgkmcnt(4)
    v_mfma_f32_32x32x16_bf16 v[64:79], v[20:23], v[40:43], v[64:79]
    s_add_u32 m0, s28, 52224
    s_add_u32 s31, s27, 893952
    buffer_load_dwordx4 v2, s[20:23], s31 offen lds
    v_mfma_f32_32x32x16_bf16 v[112:127], v[20:23], v[44:47], v[112:127]
    ds_read_b64_tr_b16 v[16:17], v6 offset:36864
    ds_read_b64_tr_b16 v[18:19], v6 offset:39936
    s_waitcnt lgkmcnt(4)
    v_mfma_f32_32x32x16_bf16 v[80:95], v[8:11], v[40:43], v[80:95]
    s_add_u32 m0, s28, 53248
    s_add_u32 s31, s27, 893952
    buffer_load_dwordx4 v3, s[20:23], s31 offen lds
    v_mfma_f32_32x32x16_bf16 v[128:143], v[8:11], v[44:47], v[128:143]
    ds_read_b64_tr_b16 v[20:21], v7 offset:36928
    ds_read_b64_tr_b16 v[22:23], v7 offset:40000
    s_waitcnt lgkmcnt(4)
    v_mfma_f32_32x32x16_bf16 v[96:111], v[12:15], v[40:43], v[96:111]
    s_add_u32 m0, s28, 54272
    s_add_u32 s31, s27, 893952
    buffer_load_dwordx4 v4, s[20:23], s31 offen lds
    v_mfma_f32_32x32x16_bf16 v[144:159], v[12:15], v[44:47], v[144:159]
    buffer_load_dwordx4 v[40:43], v1, s[16:19], s29 offen offset:2048
    buffer_load_dwordx4 v[44:47], v1, s[16:19], s40 offen offset:2048
    ds_read_b64_tr_b16 v[8:9], v6 offset:36992
    ds_read_b64_tr_b16 v[10:11], v6 offset:40064
    s_waitcnt vmcnt(17) lgkmcnt(4)
    v_mfma_f32_32x32x16_bf16 v[64:79], v[16:19], v[48:51], v[64:79]
    v_mfma_f32_32x32x16_bf16 v[112:127], v[16:19], v[52:55], v[112:127]
    ds_read_b64_tr_b16 v[12:13], v6 offset:43008
    ds_read_b64_tr_b16 v[14:15], v6 offset:46080
    s_waitcnt lgkmcnt(4)
    v_mfma_f32_32x32x16_bf16 v[80:95], v[20:23], v[48:51], v[80:95]
    v_mfma_f32_32x32x16_bf16 v[128:143], v[20:23], v[52:55], v[128:143]
    ds_read_b64_tr_b16 v[16:17], v7 offset:43072
    ds_read_b64_tr_b16 v[18:19], v7 offset:46144
    s_waitcnt lgkmcnt(4)
    v_mfma_f32_32x32x16_bf16 v[96:111], v[8:11], v[48:51], v[96:111]
    v_mfma_f32_32x32x16_bf16 v[144:159], v[8:11], v[52:55], v[144:159]
    buffer_load_dwordx4 v[48:51], v1, s[16:19], s29 offen offset:3072
    buffer_load_dwordx4 v[52:55], v1, s[16:19], s40 offen offset:3072
    ds_read_b64_tr_b16 v[20:21], v6 offset:43136
    ds_read_b64_tr_b16 v[22:23], v6 offset:46208
    s_waitcnt vmcnt(17) lgkmcnt(4)
    v_mfma_f32_32x32x16_bf16 v[64:79], v[12:15], v[56:59], v[64:79]
    v_mfma_f32_32x32x16_bf16 v[112:127], v[12:15], v[60:63], v[112:127]
    s_waitcnt lgkmcnt(2)
    v_mfma_f32_32x32x16_bf16 v[80:95], v[16:19], v[56:59], v[80:95]
    v_mfma_f32_32x32x16_bf16 v[128:143], v[16:19], v[60:63], v[128:143]
    s_waitcnt lgkmcnt(0)
    v_mfma_f32_32x32x16_bf16 v[96:111], v[20:23], v[56:59], v[96:111]
    v_mfma_f32_32x32x16_bf16 v[144:159], v[20:23], v[60:63], v[144:159]
    s_add_u32 s29, s29, 4096
    s_add_u32 s40, s40, 4096
    buffer_load_dwordx4 v[56:59], v1, s[16:19], s29 offen offset:0
    buffer_load_dwordx4 v[60:63], v1, s[16:19], s40 offen offset:0
    s_waitcnt vmcnt(31)
    s_barrier
    v_add_u32 v6, 49152, v6
    v_add_u32 v7, 49152, v7
    ds_read_b64_tr_b16 v[8:9], v6 offset:0
    ds_read_b64_tr_b16 v[10:11], v6 offset:3072
    ds_read_b64_tr_b16 v[12:13], v7 offset:64
    ds_read_b64_tr_b16 v[14:15], v7 offset:3136
    s_add_u32 m0, s26, 0
    s_add_u32 s31, s25, 147456
    buffer_load_dwordx4 v1, s[16:19], s31 offen lds
    s_add_u32 m0, s26, 1024
    s_add_u32 s31, s25, 148480
    buffer_load_dwordx4 v1, s[16:19], s31 offen lds
    s_add_u32 m0, s26, 2048
    s_add_u32 s31, s25, 149504
    buffer_load_dwordx4 v1, s[16:19], s31 offen lds
    s_mul_i32 s42, s14, 43
    s_lshr_b32 s42, s42, 8
    s_mul_i32 s42, s42, 6
    s_sub_u32 s42, s14, s42
    s_mul_i32 s42, s42, 108
    s_mul_i32 s43, s24, 3
    s_add_u32 s43, s43, 0
    s_lshr_b32 s46, s43, 2
    s_mul_i32 s46, s46, 36
    s_add_u32 s46, s46, s42
    s_and_b32 s43, s43, 3
    s_add_u32 s47, s46, s43
    s_lshl_b32 s47, s47, 10
    s_add_u32 s81, s47, 5939200
    s_lshl_b32 s43, s43, 3
    s_add_u32 s43, s43, s46
    s_lshl_b32 s43, s43, 10
    s_add_u32 s78, s43, 5906432
    s_mul_i32 s43, s24, 3
    s_add_u32 s43, s43, 1
    s_lshr_b32 s46, s43, 2
    s_mul_i32 s46, s46, 36
    s_add_u32 s46, s46, s42
    s_and_b32 s43, s43, 3
    s_add_u32 s47, s46, s43
    s_lshl_b32 s47, s47, 10
    s_add_u32 s82, s47, 5939200
    s_lshl_b32 s43, s43, 3
    s_add_u32 s43, s43, s46
    s_lshl_b32 s43, s43, 10
    s_add_u32 s79, s43, 5906432
    s_mul_i32 s43, s24, 3
    s_add_u32 s43, s43, 2
    s_lshr_b32 s46, s43, 2
    s_mul_i32 s46, s46, 36
    s_add_u32 s46, s46, s42
    s_and_b32 s43, s43, 3
    s_add_u32 s47, s46, s43
    s_lshl_b32 s47, s47, 10
    s_add_u32 s83, s47, 5939200
    s_lshl_b32 s43, s43, 3
    s_add_u32 s43, s43, s46
    s_lshl_b32 s43, s43, 10
    s_add_u32 s80, s43, 5906432
    s_mul_i32 s84, s24, 3072
    s_mov_b32 s50, 36986880
    v_mov_b32 v5, 0
    buffer_load_dword v5, v5, s[16:19], s50 offen sc1
    ds_read_b64_tr_b16 v[16:17], v6 offset:128
    ds_read_b64_tr_b16 v[18:19], v6 offset:3200
    s_waitcnt vmcnt(21) lgkmcnt(4)
    v_mfma_f32_32x32x16_bf16 v[64:79], v[8:11], v[24:27], v[64:79]
    s_add_u32 m0, s28, 73728
    s_add_u32 s31, s27, 958464
    buffer_load_dwordx4 v2, s[20:23], s31 offen lds
    v_mfma_f32_32x32x16_bf16 v[112:127], v[8:11], v[28:31], v[112:127]
    ds_read_b64_tr_b16 v[20:21], v6 offset:6144
    ds_read_b64_tr_b16 v[22:23], v6 offset:9216
    s_waitcnt lgkmcnt(4)
    v_mfma_f32_32x32x16_bf16 v[80:95], v[12:15], v[24:27], v[80:95]
    s_add_u32 m0, s28, 74752
    s_add_u32 s31, s27, 958464
    buffer_load_dwordx4 v3, s[20:23], s31 offen lds
    v_mfma_f32_32x32x16_bf16 v[128:143], v[12:15], v[28:31], v[128:143]
    ds_read_b64_tr_b16 v[8:9], v7 offset:6208
    ds_read_b64_tr_b16 v[10:11], v7 offset:9280
    s_waitcnt lgkmcnt(4)
    v_mfma_f32_32x32x16_bf16 v[96:111], v[16:19], v[24:27], v[96:111]
    s_add_u32 m0, s28, 75776
    s_add_u32 s31, s27, 958464
    buffer_load_dwordx4 v4, s[20:23], s31 offen lds
    v_mfma_f32_32x32x16_bf16 v[144:159], v[16:19], v[28:31], v[144:159]
    buffer_load_dwordx4 v[24:27], v1, s[16:19], s29 offen offset:1024
    buffer_load_dwordx4 v[28:31], v1, s[16:19], s40 offen offset:1024
    ds_read_b64_tr_b16 v[12:13], v6 offset:6272
    ds_read_b64_tr_b16 v[14:15], v6 offset:9344
    s_waitcnt vmcnt(18) lgkmcnt(4)
    v_mfma_f32_32x32x16_bf16 v[64:79], v[20:23], v[32:35], v[64:79]
    s_add_u32 m0, s28, 76800
    s_add_u32 s31, s27, 967680
    buffer_load_dwordx4 v2, s[20:23], s31 offen lds
    v_mfma_f32_32x32x16_bf16 v[112:127], v[20:23], v[36:39], v[112:127]
    ds_read_b64_tr_b16 v[16:17], v6 offset:12288
    ds_read_b64_tr_b16 v[18:19], v6 offset:15360
    s_waitcnt lgkmcnt(4)
    v_mfma_f32_32x32x16_bf16 v[80:95], v[8:11], v[32:35], v[80:95]
    s_add_u32 m0, s28, 77824
    s_add_u32 s31, s27, 967680
    buffer_load_dwordx4 v3, s[20:23], s31 offen lds
    v_mfma_f32_32x32x16_bf16 v[128:143], v[8:11], v[36:39], v[128:143]
    ds_read_b64_tr_b16 v[20:21], v7 offset:12352
    ds_read_b64_tr_b16 v[22:23], v7 offset:15424
    s_waitcnt lgkmcnt(4)
    v_mfma_f32_32x32x16_bf16 v[96:111], v[12:15], v[32:35], v[96:111]
    s_add_u32 m0, s28, 78848
    s_add_u32 s31, s27, 967680
    buffer_load_dwordx4 v4, s[20:23], s31 offen lds
    v_mfma_f32_32x32x16_bf16 v[144:159], v[12:15], v[36:39], v[144:159]
    buffer_load_dwordx4 v[32:35], v1, s[16:19], s29 offen offset:2048
    buffer_load_dwordx4 v[36:39], v1, s[16:19], s40 offen offset:2048
    ds_read_b64_tr_b16 v[8:9], v6 offset:12416
    ds_read_b64_tr_b16 v[10:11], v6 offset:15488
    s_waitcnt vmcnt(18) lgkmcnt(4)
    v_mfma_f32_32x32x16_bf16 v[64:79], v[16:19], v[40:43], v[64:79]
    v_mfma_f32_32x32x16_bf16 v[112:127], v[16:19], v[44:47], v[112:127]
    ds_read_b64_tr_b16 v[12:13], v6 offset:18432
    ds_read_b64_tr_b16 v[14:15], v6 offset:21504
    s_waitcnt lgkmcnt(4)
    v_mfma_f32_32x32x16_bf16 v[80:95], v[20:23], v[40:43], v[80:95]
    v_mfma_f32_32x32x16_bf16 v[128:143], v[20:23], v[44:47], v[128:143]
    ds_read_b64_tr_b16 v[16:17], v7 offset:18496
    ds_read_b64_tr_b16 v[18:19], v7 offset:21568
    s_waitcnt lgkmcnt(4)
    v_mfma_f32_32x32x16_bf16 v[96:111], v[8:11], v[40:43], v[96:111]
    v_mfma_f32_32x32x16_bf16 v[144:159], v[8:11], v[44:47], v[144:159]
    buffer_load_dwordx4 v[40:43], v1, s[16:19], s29 offen offset:3072
    buffer_load_dwordx4 v[44:47], v1, s[16:19], s40 offen offset:3072
    ds_read_b64_tr_b16 v[20:21], v6 offset:18560
    ds_read_b64_tr_b16 v[22:23], v6 offset:21632
    s_waitcnt vmcnt(18) lgkmcnt(4)
    v_mfma_f32_32x32x16_bf16 v[64:79], v[12:15], v[48:51], v[64:79]
    v_mfma_f32_32x32x16_bf16 v[112:127], v[12:15], v[52:55], v[112:127]
    s_waitcnt lgkmcnt(2)
    v_mfma_f32_32x32x16_bf16 v[80:95], v[16:19], v[48:51], v[80:95]
    v_mfma_f32_32x32x16_bf16 v[128:143], v[16:19], v[52:55], v[128:143]
    s_waitcnt lgkmcnt(0)
    v_mfma_f32_32x32x16_bf16 v[96:111], v[20:23], v[48:51], v[96:111]
    v_mfma_f32_32x32x16_bf16 v[144:159], v[20:23], v[52:55], v[144:159]
    s_add_u32 s29, s29, 4096
    s_add_u32 s40, s40, 4096
    buffer_load_dwordx4 v[48:51], v1, s[16:19], s29 offen offset:0
    buffer_load_dwordx4 v[52:55], v1, s[16:19], s40 offen offset:0
    s_waitcnt vmcnt(32)
    s_barrier
    ds_read_b64_tr_b16 v[8:9], v6 offset:24576
    ds_read_b64_tr_b16 v[10:11], v6 offset:27648
    ds_read_b64_tr_b16 v[12:13], v7 offset:24640
    ds_read_b64_tr_b16 v[14:15], v7 offset:27712
    s_add_u32 m0, s26, 12288
    s_add_u32 s31, s25, 159744
    buffer_load_dwordx4 v1, s[16:19], s31 offen lds
    s_add_u32 m0, s26, 13312
    s_add_u32 s31, s25, 160768
    buffer_load_dwordx4 v1, s[16:19], s31 offen lds
    s_add_u32 m0, s26, 14336
    s_add_u32 s31, s25, 161792
    buffer_load_dwordx4 v1, s[16:19], s31 offen lds
    ds_read_b64_tr_b16 v[16:17], v6 offset:24704
    ds_read_b64_tr_b16 v[18:19], v6 offset:27776
    s_waitcnt vmcnt(21) lgkmcnt(4)
    v_mfma_f32_32x32x16_bf16 v[64:79], v[8:11], v[56:59], v[64:79]
    s_add_u32 m0, s28, 98304
    s_add_u32 s31, s27, 1032192
    buffer_load_dwordx4 v2, s[20:23], s31 offen lds
    v_mfma_f32_32x32x16_bf16 v[112:127], v[8:11], v[60:63], v[112:127]
    ds_read_b64_tr_b16 v[20:21], v6 offset:30720
    ds_read_b64_tr_b16 v[22:23], v6 offset:33792
    s_waitcnt lgkmcnt(4)
    v_mfma_f32_32x32x16_bf16 v[80:95], v[12:15], v[56:59], v[80:95]
    s_add_u32 m0, s28, 99328
    s_add_u32 s31, s27, 1032192
    buffer_load_dwordx4 v3, s[20:23], s31 offen lds
    v_mfma_f32_32x32x16_bf16 v[128:143], v[12:15], v[60:63], v[128:143]
    ds_read_b64_tr_b16 v[8:9], v7 offset:30784
    ds_read_b64_tr_b16 v[10:11], v7 offset:33856
    s_waitcnt lgkmcnt(4)
    v_mfma_f32_32x32x16_bf16 v[96:111], v[16:19], v[56:59], v[96:111]
    s_add_u32 m0, s28, 100352
    s_add_u32 s31, s27, 1032192
    buffer_load_dwordx4 v4, s[20:23], s31 offen lds
    v_mfma_f32_32x32x16_bf16 v[144:159], v[16:19], v[60:63], v[144:159]
    buffer_load_dwordx4 v[56:59], v1, s[16:19], s29 offen offset:1024
    buffer_load_dwordx4 v[60:63], v1, s[16:19], s40 offen offset:1024
    ds_read_b64_tr_b16 v[12:13], v6 offset:30848
    ds_read_b64_tr_b16 v[14:15], v6 offset:33920
    s_waitcnt vmcnt(17) lgkmcnt(4)
    v_mfma_f32_32x32x16_bf16 v[64:79], v[20:23], v[24:27], v[64:79]
    s_add_u32 m0, s28, 101376
    s_add_u32 s31, s27, 1041408
    buffer_load_dwordx4 v2, s[20:23], s31 offen lds
    v_mfma_f32_32x32x16_bf16 v[112:127], v[20:23], v[28:31], v[112:127]
    ds_read_b64_tr_b16 v[16:17], v6 offset:36864
    ds_read_b64_tr_b16 v[18:19], v6 offset:39936
    s_waitcnt lgkmcnt(4)
    v_mfma_f32_32x32x16_bf16 v[80:95], v[8:11], v[24:27], v[80:95]
    s_add_u32 m0, s28, 102400
    s_add_u32 s31, s27, 1041408
    buffer_load_dwordx4 v3, s[20:23], s31 offen lds
    v_mfma_f32_32x32x16_bf16 v[128:143], v[8:11], v[28:31], v[128:143]
    ds_read_b64_tr_b16 v[20:21], v7 offset:36928
    ds_read_b64_tr_b16 v[22:23], v7 offset:40000
    s_waitcnt lgkmcnt(4)
    v_mfma_f32_32x32x16_bf16 v[96:111], v[12:15], v[24:27], v[96:111]
    s_add_u32 m0, s28, 103424
    s_add_u32 s31, s27, 1041408
    buffer_load_dwordx4 v4, s[20:23], s31 offen lds
    v_mfma_f32_32x32x16_bf16 v[144:159], v[12:15], v[28:31], v[144:159]
    buffer_load_dwordx4 v[24:27], v1, s[16:19], s29 offen offset:2048
    buffer_load_dwordx4 v[28:31], v1, s[16:19], s40 offen offset:2048
    ds_read_b64_tr_b16 v[8:9], v6 offset:36992
    ds_read_b64_tr_b16 v[10:11], v6 offset:40064
    s_waitcnt vmcnt(17) lgkmcnt(4)
    v_mfma_f32_32x32x16_bf16 v[64:79], v[16:19], v[32:35], v[64:79]
    v_mfma_f32_32x32x16_bf16 v[112:127], v[16:19], v[36:39], v[112:127]
    ds_read_b64_tr_b16 v[12:13], v6 offset:43008
    ds_read_b64_tr_b16 v[14:15], v6 offset:46080
    s_waitcnt lgkmcnt(4)
    v_mfma_f32_32x32x16_bf16 v[80:95], v[20:23], v[32:35], v[80:95]
    v_mfma_f32_32x32x16_bf16 v[128:143], v[20:23], v[36:39], v[128:143]
    ds_read_b64_tr_b16 v[16:17], v7 offset:43072
    ds_read_b64_tr_b16 v[18:19], v7 offset:46144
    s_waitcnt lgkmcnt(4)
    v_mfma_f32_32x32x16_bf16 v[96:111], v[8:11], v[32:35], v[96:111]
    v_mfma_f32_32x32x16_bf16 v[144:159], v[8:11], v[36:39], v[144:159]
    buffer_load_dwordx4 v[32:35], v1, s[16:19], s29 offen offset:3072
    buffer_load_dwordx4 v[36:39], v1, s[16:19], s40 offen offset:3072
    ds_read_b64_tr_b16 v[20:21], v6 offset:43136
    ds_read_b64_tr_b16 v[22:23], v6 offset:46208
    s_waitcnt vmcnt(17) lgkmcnt(4)
    v_mfma_f32_32x32x16_bf16 v[64:79], v[12:15], v[40:43], v[64:79]
    v_mfma_f32_32x32x16_bf16 v[112:127], v[12:15], v[44:47], v[112:127]
    s_waitcnt lgkmcnt(2)
    v_mfma_f32_32x32x16_bf16 v[80:95], v[16:19], v[40:43], v[80:95]
    v_mfma_f32_32x32x16_bf16 v[128:143], v[16:19], v[44:47], v[128:143]
    s_waitcnt lgkmcnt(0)
    v_mfma_f32_32x32x16_bf16 v[96:111], v[20:23], v[40:43], v[96:111]
    v_mfma_f32_32x32x16_bf16 v[144:159], v[20:23], v[44:47], v[144:159]
    s_add_u32 s29, s29, 4096
    s_add_u32 s40, s40, 4096
    buffer_load_dwordx4 v[40:43], v1, s[16:19], s29 offen offset:0
    buffer_load_dwordx4 v[44:47], v1, s[16:19], s40 offen offset:0
    s_waitcnt vmcnt(32)
    s_barrier
    v_add_u32 v6, 4294918144, v6
    v_add_u32 v7, 4294918144, v7
    s_waitcnt vmcnt(31)
    v_readfirstlane_b32 s52, v5
    s_nop 0
    s_cmp_ge_u32 s52, 64
    s_cbranch_scc1 LC_pdW
    s_mov_b32 s50, 36986880
    v_mov_b32 v3, 0
    s_mov_b32 s51, 0x40000
LC_pollW:
    buffer_load_dword v2, v3, s[16:19], s50 offen sc1
    s_waitcnt vmcnt(0)
    v_readfirstlane_b32 s52, v2
    s_nop 0
    s_cmp_ge_u32 s52, 64
    s_cbranch_scc1 LC_pdW
    s_sub_u32 s51, s51, 1
    s_cmp_lg_u32 s51, 0
    s_cbranch_scc1 LC_pollW
LC_pdW:
    ds_read_b64_tr_b16 v[8:9], v6 offset:0
    ds_read_b64_tr_b16 v[10:11], v6 offset:3072
    ds_read_b64_tr_b16 v[12:13], v7 offset:64
    ds_read_b64_tr_b16 v[14:15], v7 offset:3136
    s_add_u32 m0, s26, 24576
    s_add_u32 s31, s25, 172032
    buffer_load_dwordx4 v1, s[16:19], s31 offen lds
    s_add_u32 m0, s26, 25600
    s_add_u32 s31, s25, 173056
    buffer_load_dwordx4 v1, s[16:19], s31 offen lds
    s_add_u32 m0, s26, 26624
    s_add_u32 s31, s25, 174080
    buffer_load_dwordx4 v1, s[16:19], s31 offen lds
    ds_read_b64_tr_b16 v[16:17], v6 offset:128
    ds_read_b64_tr_b16 v[18:19], v6 offset:3200
    s_waitcnt vmcnt(20) lgkmcnt(4)
    v_mfma_f32_32x32x16_bf16 v[64:79], v[8:11], v[48:51], v[64:79]
    s_add_u32 m0, s84, 122880
    s_add_u32 s31, s78, 0
    buffer_load_dwordx4 v1, s[16:19], s31 offen sc1 lds
    v_mfma_f32_32x32x16_bf16 v[112:127], v[8:11], v[52:55], v[112:127]
    ds_read_b64_tr_b16 v[20:21], v6 offset:6144
    ds_read_b64_tr_b16 v[22:23], v6 offset:9216
    s_waitcnt lgkmcnt(4)
    v_mfma_f32_32x32x16_bf16 v[80:95], v[12:15], v[48:51], v[80:95]
    s_add_u32 m0, s84, 123904
    s_add_u32 s31, s79, 0
    buffer_load_dwordx4 v1, s[16:19], s31 offen sc1 lds
    v_mfma_f32_32x32x16_bf16 v[128:143], v[12:15], v[52:55], v[128:143]
    ds_read_b64_tr_b16 v[8:9], v7 offset:6208
    ds_read_b64_tr_b16 v[10:11], v7 offset:9280
    s_waitcnt lgkmcnt(4)
    v_mfma_f32_32x32x16_bf16 v[96:111], v[16:19], v[48:51], v[96:111]
    s_add_u32 m0, s84, 124928
    s_add_u32 s31, s80, 0
    buffer_load_dwordx4 v1, s[16:19], s31 offen sc1 lds
    v_mfma_f32_32x32x16_bf16 v[144:159], v[16:19], v[52:55], v[144:159]
    buffer_load_dwordx4 v[48:51], v1, s[16:19], s29 offen offset:1024
    buffer_load_dwordx4 v[52:55], v1, s[16:19], s40 offen offset:1024
    ds_read_b64_tr_b16 v[12:13], v6 offset:6272
    ds_read_b64_tr_b16 v[14:15], v6 offset:9344
    s_waitcnt vmcnt(17) lgkmcnt(4)
    v_mfma_f32_32x32x16_bf16 v[64:79], v[20:23], v[56:59], v[64:79]
    s_add_u32 m0, s84, 135168
    s_add_u32 s31, s78, 1024
    buffer_load_dwordx4 v1, s[16:19], s31 offen sc1 lds
    v_mfma_f32_32x32x16_bf16 v[112:127], v[20:23], v[60:63], v[112:127]
    ds_read_b64_tr_b16 v[16:17], v6 offset:12288
    ds_read_b64_tr_b16 v[18:19], v6 offset:15360
    s_waitcnt lgkmcnt(4)
    v_mfma_f32_32x32x16_bf16 v[80:95], v[8:11], v[56:59], v[80:95]
    s_add_u32 m0, s84, 136192
    s_add_u32 s31, s79, 1024
    buffer_load_dwordx4 v1, s[16:19], s31 offen sc1 lds
    v_mfma_f32_32x32x16_bf16 v[128:143], v[8:11], v[60:63], v[128:143]
    ds_read_b64_tr_b16 v[20:21], v7 offset:12352
    ds_read_b64_tr_b16 v[22:23], v7 offset:15424
    s_waitcnt lgkmcnt(4)
    v_mfma_f32_32x32x16_bf16 v[96:111], v[12:15], v[56:59], v[96:111]
    s_add_u32 m0, s84, 137216
    s_add_u32 s31, s80, 1024
    buffer_load_dwordx4 v1, s[16:19], s31 offen sc1 lds
    v_mfma_f32_32x32x16_bf16 v[144:159], v[12:15], v[60:63], v[144:159]
    buffer_load_dwordx4 v[56:59], v1, s[16:19], s29 offen offset:2048
    buffer_load_dwordx4 v[60:63], v1, s[16:19], s40 offen offset:2048
    ds_read_b64_tr_b16 v[8:9], v6 offset:12416
    ds_read_b64_tr_b16 v[10:11], v6 offset:15488
    s_waitcnt vmcnt(17) lgkmcnt(4)
    v_mfma_f32_32x32x16_bf16 v[64:79], v[16:19], v[24:27], v[64:79]
    v_mfma_f32_32x32x16_bf16 v[112:127], v[16:19], v[28:31], v[112:127]
    ds_read_b64_tr_b16 v[12:13], v6 offset:18432
    ds_read_b64_tr_b16 v[14:15], v6 offset:21504
    s_waitcnt lgkmcnt(4)
    v_mfma_f32_32x32x16_bf16 v[80:95], v[20:23], v[24:27], v[80:95]
    v_mfma_f32_32x32x16_bf16 v[128:143], v[20:23], v[28:31], v[128:143]
    ds_read_b64_tr_b16 v[16:17], v7 offset:18496
    ds_read_b64_tr_b16 v[18:19], v7 offset:21568
    s_waitcnt lgkmcnt(4)
    v_mfma_f32_32x32x16_bf16 v[96:111], v[8:11], v[24:27], v[96:111]
    v_mfma_f32_32x32x16_bf16 v[144:159], v[8:11], v[28:31], v[144:159]
    buffer_load_dwordx4 v[24:27], v1, s[16:19], s29 offen offset:3072
    buffer_load_dwordx4 v[28:31], v1, s[16:19], s40 offen offset:3072
    ds_read_b64_tr_b16 v[20:21], v6 offset:18560
    ds_read_b64_tr_b16 v[22:23], v6 offset:21632
    s_waitcnt vmcnt(17) lgkmcnt(4)
    v_mfma_f32_32x32x16_bf16 v[64:79], v[12:15], v[32:35], v[64:79]
    v_mfma_f32_32x32x16_bf16 v[112:127], v[12:15], v[36:39], v[112:127]
    s_waitcnt lgkmcnt(2)
    v_mfma_f32_32x32x16_bf16 v[80:95], v[16:19], v[32:35], v[80:95]
    v_mfma_f32_32x32x16_bf16 v[128:143], v[16:19], v[36:39], v[128:143]
    s_waitcnt lgkmcnt(0)
    v_mfma_f32_32x32x16_bf16 v[96:111], v[20:23], v[32:35], v[96:111]
    v_mfma_f32_32x32x16_bf16 v[144:159], v[20:23], v[36:39], v[144:159]
    s_add_u32 s29, s29, 4096
    s_add_u32 s40, s40, 4096
    buffer_load_dwordx4 v[32:35], v1, s[16:19], s29 offen offset:0
    buffer_load_dwordx4 v[36:39], v1, s[16:19], s40 offen offset:0
    s_waitcnt vmcnt(31)
    s_barrier
    ds_read_b64_tr_b16 v[8:9], v6 offset:24576
    ds_read_b64_tr_b16 v[10:11], v6 offset:27648
    ds_read_b64_tr_b16 v[12:13], v7 offset:24640
    ds_read_b64_tr_b16 v[14:15], v7 offset:27712
    s_add_u32 m0, s26, 36864
    s_add_u32 s31, s25, 184320
    buffer_load_dwordx4 v1, s[16:19], s31 offen lds
    s_add_u32 m0, s26, 37888
    s_add_u32 s31, s25, 185344
    buffer_load_dwordx4 v1, s[16:19], s31 offen lds
    s_add_u32 m0, s26, 38912
    s_add_u32 s31, s25, 186368
    buffer_load_dwordx4 v1, s[16:19], s31 offen lds
    ds_read_b64_tr_b16 v[16:17], v6 offset:24704
    ds_read_b64_tr_b16 v[18:19], v6 offset:27776
    s_waitcnt vmcnt(20) lgkmcnt(4)
    v_mfma_f32_32x32x16_bf16 v[64:79], v[8:11], v[40:43], v[64:79]
    s_add_u32 m0, s84, 49152
    s_add_u32 s31, s78, 2048
    buffer_load_dwordx4 v1, s[16:19], s31 offen sc1 lds
    v_mfma_f32_32x32x16_bf16 v[112:127], v[8:11], v[44:47], v[112:127]
    ds_read_b64_tr_b16 v[20:21], v6 offset:30720
    ds_read_b64_tr_b16 v[22:23], v6 offset:33792
    s_waitcnt lgkmcnt(4)
    v_mfma_f32_32x32x16_bf16 v[80:95], v[12:15], v[40:43], v[80:95]
    s_add_u32 m0, s84, 50176
    s_add_u32 s31, s79, 2048
    buffer_load_dwordx4 v1, s[16:19], s31 offen sc1 lds
    v_mfma_f32_32x32x16_bf16 v[128:143], v[12:15], v[44:47], v[128:143]
    ds_read_b64_tr_b16 v[8:9], v7 offset:30784
    ds_read_b64_tr_b16 v[10:11], v7 offset:33856
    s_waitcnt lgkmcnt(4)
    v_mfma_f32_32x32x16_bf16 v[96:111], v[16:19], v[40:43], v[96:111]
    s_add_u32 m0, s84, 51200
    s_add_u32 s31, s80, 2048
    buffer_load_dwordx4 v1, s[16:19], s31 offen sc1 lds
    v_mfma_f32_32x32x16_bf16 v[144:159], v[16:19], v[44:47], v[144:159]
    buffer_load_dwordx4 v[40:43], v1, s[16:19], s29 offen offset:1024
    buffer_load_dwordx4 v[44:47], v1, s[16:19], s40 offen offset:1024
    ds_read_b64_tr_b16 v[12:13], v6 offset:30848
    ds_read_b64_tr_b16 v[14:15], v6 offset:33920
    s_waitcnt vmcnt(17) lgkmcnt(4)
    v_mfma_f32_32x32x16_bf16 v[64:79], v[20:23], v[48:51], v[64:79]
    s_add_u32 m0, s84, 61440
    s_add_u32 s31, s78, 3072
    buffer_load_dwordx4 v1, s[16:19], s31 offen sc1 lds
    v_mfma_f32_32x32x16_bf16 v[112:127], v[20:23], v[52:55], v[112:127]
    ds_read_b64_tr_b16 v[16:17], v6 offset:36864
    ds_read_b64_tr_b16 v[18:19], v6 offset:39936
    s_waitcnt lgkmcnt(4)
    v_mfma_f32_32x32x16_bf16 v[80:95], v[8:11], v[48:51], v[80:95]
    s_add_u32 m0, s84, 62464
    s_add_u32 s31, s79, 3072
    buffer_load_dwordx4 v1, s[16:19], s31 offen sc1 lds
    v_mfma_f32_32x32x16_bf16 v[128:143], v[8:11], v[52:55], v[128:143]
    ds_read_b64_tr_b16 v[20:21], v7 offset:36928
    ds_read_b64_tr_b16 v[22:23], v7 offset:40000
    s_waitcnt lgkmcnt(4)
    v_mfma_f32_32x32x16_bf16 v[96:111], v[12:15], v[48:51], v[96:111]
    s_add_u32 m0, s84, 63488
    s_add_u32 s31, s80, 3072
    buffer_load_dwordx4 v1, s[16:19], s31 offen sc1 lds
    v_mfma_f32_32x32x16_bf16 v[144:159], v[12:15], v[52:55], v[144:159]
    buffer_load_dwordx4 v[48:51], v1, s[16:19], s29 offen offset:2048
    buffer_load_dwordx4 v[52:55], v1, s[16:19], s40 offen offset:2048
    ds_read_b64_tr_b16 v[8:9], v6 offset:36992
    ds_read_b64_tr_b16 v[10:11], v6 offset:40064
    s_waitcnt vmcnt(17) lgkmcnt(4)
    v_mfma_f32_32x32x16_bf16 v[64:79], v[16:19], v[56:59], v[64:79]
    v_mfma_f32_32x32x16_bf16 v[112:127], v[16:19], v[60:63], v[112:127]
    ds_read_b64_tr_b16 v[12:13], v6 offset:43008
    ds_read_b64_tr_b16 v[14:15], v6 offset:46080
    s_waitcnt lgkmcnt(4)
    v_mfma_f32_32x32x16_bf16 v[80:95], v[20:23], v[56:59], v[80:95]
    v_mfma_f32_32x32x16_bf16 v[128:143], v[20:23], v[60:63], v[128:143]
    ds_read_b64_tr_b16 v[16:17], v7 offset:43072
    ds_read_b64_tr_b16 v[18:19], v7 offset:46144
    s_waitcnt lgkmcnt(4)
    v_mfma_f32_32x32x16_bf16 v[96:111], v[8:11], v[56:59], v[96:111]
    v_mfma_f32_32x32x16_bf16 v[144:159], v[8:11], v[60:63], v[144:159]
    buffer_load_dwordx4 v[56:59], v1, s[16:19], s29 offen offset:3072
    buffer_load_dwordx4 v[60:63], v1, s[16:19], s40 offen offset:3072
    ds_read_b64_tr_b16 v[20:21], v6 offset:43136
    ds_read_b64_tr_b16 v[22:23], v6 offset:46208
    s_waitcnt vmcnt(17) lgkmcnt(4)
    v_mfma_f32_32x32x16_bf16 v[64:79], v[12:15], v[24:27], v[64:79]
    v_mfma_f32_32x32x16_bf16 v[112:127], v[12:15], v[28:31], v[112:127]
    s_waitcnt lgkmcnt(2)
    v_mfma_f32_32x32x16_bf16 v[80:95], v[16:19], v[24:27], v[80:95]
    v_mfma_f32_32x32x16_bf16 v[128:143], v[16:19], v[28:31], v[128:143]
    s_waitcnt lgkmcnt(0)
    v_mfma_f32_32x32x16_bf16 v[96:111], v[20:23], v[24:27], v[96:111]
    v_mfma_f32_32x32x16_bf16 v[144:159], v[20:23], v[28:31], v[144:159]
    s_waitcnt vmcnt(12)
    s_barrier
    v_add_u32 v6, 49152, v6
    v_add_u32 v7, 49152, v7
    s_add_u32 m0, s84, 73728
    s_add_u32 s31, s78, 4096
    buffer_load_dwordx4 v1, s[16:19], s31 offen sc1 lds
    s_add_u32 m0, s84, 74752
    s_add_u32 s31, s79, 4096
    buffer_load_dwordx4 v1, s[16:19], s31 offen sc1 lds
    s_add_u32 m0, s84, 75776
    s_add_u32 s31, s80, 4096
    buffer_load_dwordx4 v1, s[16:19], s31 offen sc1 lds
    s_add_u32 m0, s84, 86016
    s_add_u32 s31, s78, 5120
    buffer_load_dwordx4 v1, s[16:19], s31 offen sc1 lds
    s_add_u32 m0, s84, 87040
    s_add_u32 s31, s79, 5120
    buffer_load_dwordx4 v1, s[16:19], s31 offen sc1 lds
    s_add_u32 m0, s84, 88064
    s_add_u32 s31, s80, 5120
    buffer_load_dwordx4 v1, s[16:19], s31 offen sc1 lds
    s_cmp_eq_u32 s30, 14
    s_cbranch_scc1 LC_skip14
    ds_read_b64_tr_b16 v[8:9], v6 offset:0
    ds_read_b64_tr_b16 v[10:11], v6 offset:3072
    ds_read_b64_tr_b16 v[12:13], v7 offset:64
    ds_read_b64_tr_b16 v[14:15], v7 offset:3136
    ds_read_b64_tr_b16 v[16:17], v6 offset:128
    ds_read_b64_tr_b16 v[18:19], v6 offset:3200
    s_waitcnt vmcnt(21) lgkmcnt(4)
    v_mfma_f32_32x32x16_bf16 v[64:79], v[8:11], v[32:35], v[64:79]
    v_mfma_f32_32x32x16_bf16 v[112:127], v[8:11], v[36:39], v[112:127]
    ds_read_b64_tr_b16 v[20:21], v6 offset:6144
    ds_read_b64_tr_b16 v[22:23], v6 offset:9216
    s_waitcnt lgkmcnt(4)
    v_mfma_f32_32x32x16_bf16 v[80:95], v[12:15], v[32:35], v[80:95]
    v_mfma_f32_32x32x16_bf16 v[128:143], v[12:15], v[36:39], v[128:143]
    ds_read_b64_tr_b16 v[8:9], v7 offset:6208
    ds_read_b64_tr_b16 v[10:11], v7 offset:9280
    s_waitcnt lgkmcnt(4)
    v_mfma_f32_32x32x16_bf16 v[96:111], v[16:19], v[32:35], v[96:111]
    v_mfma_f32_32x32x16_bf16 v[144:159], v[16:19], v[36:39], v[144:159]
    ds_read_b64_tr_b16 v[12:13], v6 offset:6272
    ds_read_b64_tr_b16 v[14:15], v6 offset:9344
    s_waitcnt vmcnt(13) lgkmcnt(4)
    v_mfma_f32_32x32x16_bf16 v[64:79], v[20:23], v[40:43], v[64:79]
    v_mfma_f32_32x32x16_bf16 v[112:127], v[20:23], v[44:47], v[112:127]
    ds_read_b64_tr_b16 v[16:17], v6 offset:12288
    ds_read_b64_tr_b16 v[18:19], v6 offset:15360
    s_waitcnt lgkmcnt(4)
    v_mfma_f32_32x32x16_bf16 v[80:95], v[8:11], v[40:43], v[80:95]
    v_mfma_f32_32x32x16_bf16 v[128:143], v[8:11], v[44:47], v[128:143]
    ds_read_b64_tr_b16 v[20:21], v7 offset:12352
    ds_read_b64_tr_b16 v[22:23], v7 offset:15424
    s_waitcnt lgkmcnt(4)
    v_mfma_f32_32x32x16_bf16 v[96:111], v[12:15], v[40:43], v[96:111]
    v_mfma_f32_32x32x16_bf16 v[144:159], v[12:15], v[44:47], v[144:159]
    ds_read_b64_tr_b16 v[8:9], v6 offset:12416
    ds_read_b64_tr_b16 v[10:11], v6 offset:15488
    s_waitcnt vmcnt(8) lgkmcnt(4)
    v_mfma_f32_32x32x16_bf16 v[64:79], v[16:19], v[48:51], v[64:79]
    v_mfma_f32_32x32x16_bf16 v[112:127], v[16:19], v[52:55], v[112:127]
    ds_read_b64_tr_b16 v[12:13], v6 offset:18432
    ds_read_b64_tr_b16 v[14:15], v6 offset:21504
    s_waitcnt lgkmcnt(4)
    v_mfma_f32_32x32x16_bf16 v[80:95], v[20:23], v[48:51], v[80:95]
    v_mfma_f32_32x32x16_bf16 v[128:143], v[20:23], v[52:55], v[128:143]
    ds_read_b64_tr_b16 v[16:17], v7 offset:18496
    ds_read_b64_tr_b16 v[18:19], v7 offset:21568
    s_waitcnt lgkmcnt(4)
    v_mfma_f32_32x32x16_bf16 v[96:111], v[8:11], v[48:51], v[96:111]
    v_mfma_f32_32x32x16_bf16 v[144:159], v[8:11], v[52:55], v[144:159]
    ds_read_b64_tr_b16 v[20:21], v6 offset:18560
    ds_read_b64_tr_b16 v[22:23], v6 offset:21632
    s_waitcnt vmcnt(6) lgkmcnt(4)
    v_mfma_f32_32x32x16_bf16 v[64:79], v[12:15], v[56:59], v[64:79]
    v_mfma_f32_32x32x16_bf16 v[112:127], v[12:15], v[60:63], v[112:127]
    s_waitcnt lgkmcnt(2)
    v_mfma_f32_32x32x16_bf16 v[80:95], v[16:19], v[56:59], v[80:95]
    v_mfma_f32_32x32x16_bf16 v[128:143], v[16:19], v[60:63], v[128:143]
    s_waitcnt lgkmcnt(0)
    v_mfma_f32_32x32x16_bf16 v[96:111], v[20:23], v[56:59], v[96:111]
    v_mfma_f32_32x32x16_bf16 v[144:159], v[20:23], v[60:63], v[144:159]
LC_skip14:
    s_nop 7
    v_cvt_pk_bf16_f32 v8, v64, v65
    v_cvt_pk_bf16_f32 v9, v66, v67
    v_cvt_pk_bf16_f32 v10, v112, v113
    v_cvt_pk_bf16_f32 v11, v114, v115
    buffer_store_dwordx4 v[8:11], v1, s[16:19], s39 offen offset:0 sc1
    v_cvt_pk_bf16_f32 v12, v68, v69
    v_cvt_pk_bf16_f32 v13, v70, v71
    v_cvt_pk_bf16_f32 v14, v116, v117
    v_cvt_pk_bf16_f32 v15, v118, v119
    buffer_store_dwordx4 v[12:15], v1, s[16:19], s39 offen offset:1024 sc1
    v_cvt_pk_bf16_f32 v16, v72, v73
    v_cvt_pk_bf16_f32 v17, v74, v75
    v_cvt_pk_bf16_f32 v18, v120, v121
    v_cvt_pk_bf16_f32 v19, v122, v123
    buffer_store_dwordx4 v[16:19], v1, s[16:19], s39 offen offset:2048 sc1
    v_cvt_pk_bf16_f32 v20, v76, v77
    v_cvt_pk_bf16_f32 v21, v78, v79
    v_cvt_pk_bf16_f32 v22, v124, v125
    v_cvt_pk_bf16_f32 v23, v126, v127
    buffer_store_dwordx4 v[20:23], v1, s[16:19], s39 offen offset:3072 sc1
    s_add_u32 s39, s39, 4096
    v_cvt_pk_bf16_f32 v8, v80, v81
    v_cvt_pk_bf16_f32 v9, v82, v83
    v_cvt_pk_bf16_f32 v10, v128, v129
    v_cvt_pk_bf16_f32 v11, v130, v131
    buffer_store_dwordx4 v[8:11], v1, s[16:19], s39 offen offset:0 sc1
    v_cvt_pk_bf16_f32 v12, v84, v85
    v_cvt_pk_bf16_f32 v13, v86, v87
    v_cvt_pk_bf16_f32 v14, v132, v133
    v_cvt_pk_bf16_f32 v15, v134, v135
    buffer_store_dwordx4 v[12:15], v1, s[16:19], s39 offen offset:1024 sc1
    v_cvt_pk_bf16_f32 v16, v88, v89
    v_cvt_pk_bf16_f32 v17, v90, v91
    v_cvt_pk_bf16_f32 v18, v136, v137
    v_cvt_pk_bf16_f32 v19, v138, v139
    buffer_store_dwordx4 v[16:19], v1, s[16:19], s39 offen offset:2048 sc1
    v_cvt_pk_bf16_f32 v20, v92, v93
    v_cvt_pk_bf16_f32 v21, v94, v95
    v_cvt_pk_bf16_f32 v22, v140, v141
    v_cvt_pk_bf16_f32 v23, v142, v143
    buffer_store_dwordx4 v[20:23], v1, s[16:19], s39 offen offset:3072 sc1
    s_add_u32 s39, s39, 4096
    v_cvt_pk_bf16_f32 v8, v96, v97
    v_cvt_pk_bf16_f32 v9, v98, v99
    v_cvt_pk_bf16_f32 v10, v144, v145
    v_cvt_pk_bf16_f32 v11, v146, v147
    buffer_store_dwordx4 v[8:11], v1, s[16:19], s39 offen offset:0 sc1
    v_cvt_pk_bf16_f32 v12, v100, v101
    v_cvt_pk_bf16_f32 v13, v102, v103
    v_cvt_pk_bf16_f32 v14, v148, v149
    v_cvt_pk_bf16_f32 v15, v150, v151
    buffer_store_dwordx4 v[12:15], v1, s[16:19], s39 offen offset:1024 sc1
    v_cvt_pk_bf16_f32 v16, v104, v105
    v_cvt_pk_bf16_f32 v17, v106, v107
    v_cvt_pk_bf16_f32 v18, v152, v153
    v_cvt_pk_bf16_f32 v19, v154, v155
    buffer_store_dwordx4 v[16:19], v1, s[16:19], s39 offen offset:2048 sc1
    v_cvt_pk_bf16_f32 v20, v108, v109
    v_cvt_pk_bf16_f32 v21, v110, v111
    v_cvt_pk_bf16_f32 v22, v156, v157
    v_cvt_pk_bf16_f32 v23, v158, v159
    buffer_store_dwordx4 v[20:23], v1, s[16:19], s39 offen offset:3072 sc1
    s_barrier
    s_add_u32 m0, s84, 98304
    s_add_u32 s31, s78, 6144
    buffer_load_dwordx4 v1, s[16:19], s31 offen sc1 lds
    s_add_u32 m0, s84, 99328
    s_add_u32 s31, s79, 6144
    buffer_load_dwordx4 v1, s[16:19], s31 offen sc1 lds
    s_add_u32 m0, s84, 100352
    s_add_u32 s31, s80, 6144
    buffer_load_dwordx4 v1, s[16:19], s31 offen sc1 lds
    s_add_u32 m0, s84, 110592
    s_add_u32 s31, s78, 7168
    buffer_load_dwordx4 v1, s[16:19], s31 offen sc1 lds
    s_add_u32 m0, s84, 111616
    s_add_u32 s31, s79, 7168
    buffer_load_dwordx4 v1, s[16:19], s31 offen sc1 lds
    s_add_u32 m0, s84, 112640
    s_add_u32 s31, s80, 7168
    buffer_load_dwordx4 v1, s[16:19], s31 offen sc1 lds
    s_add_u32 m0, s84, 0
    s_nop 0
    buffer_load_dwordx4 v1, s[16:19], s81 offen sc1 lds
    s_add_u32 m0, s84, 1024
    s_nop 0
    buffer_load_dwordx4 v1, s[16:19], s82 offen sc1 lds
    s_add_u32 m0, s84, 2048
    s_nop 0
    buffer_load_dwordx4 v1, s[16:19], s83 offen sc1 lds
    s_waitcnt vmcnt(9)
    v_mov_b32 v2, 1
    v_mov_b32 v3, 0
    s_mov_b64 exec, 1
    buffer_atomic_add v2, v3, s[16:19], s48 offen
    s_mov_b64 exec, -1
    s_barrier
    s_branch LC_tail
LC_idle:
    s_load_dwordx2 s[8:9], s[0:1], 16
    s_and_b32 s35, s14, 15
    s_lshl_b32 s35, s35, 2
    s_add_u32 s35, s35, s24
    v_and_b32 v2, 31, v0
    v_lshrrev_b32 v3, 5, v0
    v_lshlrev_b32 v2, 1, v2
    v_mul_u32_u24 v6, 4608, v3
    v_add_u32 v6, v2, v6
    v_mul_u32_u24 v7, 82944, v3
    v_add_u32 v7, v2, v7
    s_waitcnt lgkmcnt(0)
    s_mov_b32 s20, s8
    s_mov_b32 s21, s9
    s_mov_b32 s22, 663552
    s_mov_b32 s23, 0x20000
    s_waitcnt vmcnt(3)
    s_barrier
    s_add_u32 m0, s26, 24576
    s_add_u32 s31, s25, 24576
    buffer_load_dwordx4 v1, s[16:19], s31 offen lds
    s_add_u32 m0, s26, 25600
    s_add_u32 s31, s25, 25600
    buffer_load_dwordx4 v1, s[16:19], s31 offen lds
    s_add_u32 m0, s26, 26624
    s_add_u32 s31, s25, 26624
    buffer_load_dwordx4 v1, s[16:19], s31 offen lds
    s_add_u32 s36, s35, 0
    s_min_u32 s36, s36, 215
    s_mul_i32 s37, s36, 0x1556
    s_lshr_b32 s37, s37, 16
    s_mul_i32 s38, s37, 12
    s_sub_u32 s38, s36, s38
    s_mul_i32 s38, s38, 3
    s_lshl_b32 s37, s37, 6
    s_add_u32 s39, s38, 0
    s_cmp_ge_u32 s39, 32
    s_cbranch_scc1 LC_wo_rest00
    s_mul_i32 s40, s39, 20736
    s_add_u32 s40, s40, s37
    s_add_u32 s41, s40, 0
    buffer_load_ushort v12, v6, s[20:23], s41 offen
    s_add_u32 s41, s40, 1152
    buffer_load_ushort v13, v6, s[20:23], s41 offen
    s_add_u32 s41, s40, 2304
    buffer_load_ushort v14, v6, s[20:23], s41 offen
    s_add_u32 s41, s40, 3456
    buffer_load_ushort v15, v6, s[20:23], s41 offen
    s_add_u32 s41, s40, 9216
    buffer_load_ushort v16, v6, s[20:23], s41 offen
    s_add_u32 s41, s40, 10368
    buffer_load_ushort v17, v6, s[20:23], s41 offen
    s_add_u32 s41, s40, 11520
    buffer_load_ushort v18, v6, s[20:23], s41 offen
    s_add_u32 s41, s40, 12672
    buffer_load_ushort v19, v6, s[20:23], s41 offen
    s_branch LC_wo_done00
LC_wo_rest00:
    s_sub_u32 s39, s39, 32
    s_mul_i32 s40, s39, 165888
    s_add_u32 s40, s40, s37
    s_add_u32 s41, s40, 18432
    buffer_load_ushort v12, v7, s[20:23], s41 offen
    s_add_u32 s41, s40, 19584
    buffer_load_ushort v13, v7, s[20:23], s41 offen
    s_add_u32 s41, s40, 39168
    buffer_load_ushort v14, v7, s[20:23], s41 offen
    s_add_u32 s41, s40, 40320
    buffer_load_ushort v15, v7, s[20:23], s41 offen
    s_add_u32 s41, s40, 59904
    buffer_load_ushort v16, v7, s[20:23], s41 offen
    s_add_u32 s41, s40, 61056
    buffer_load_ushort v17, v7, s[20:23], s41 offen
    s_add_u32 s41, s40, 80640
    buffer_load_ushort v18, v7, s[20:23], s41 offen
    s_add_u32 s41, s40, 81792
    buffer_load_ushort v19, v7, s[20:23], s41 offen
LC_wo_done00:
    s_add_u32 s39, s38, 1
    s_cmp_ge_u32 s39, 32
    s_cbranch_scc1 LC_wo_rest01
    s_mul_i32 s40, s39, 20736
    s_add_u32 s40, s40, s37
    s_add_u32 s41, s40, 0
    buffer_load_ushort v20, v6, s[20:23], s41 offen
    s_add_u32 s41, s40, 1152
    buffer_load_ushort v21, v6, s[20:23], s41 offen
    s_add_u32 s41, s40, 2304
    buffer_load_ushort v22, v6, s[20:23], s41 offen
    s_add_u32 s41, s40, 3456
    buffer_load_ushort v23, v6, s[20:23], s41 offen
    s_add_u32 s41, s40, 9216
    buffer_load_ushort v24, v6, s[20:23], s41 offen
    s_add_u32 s41, s40, 10368
    buffer_load_ushort v25, v6, s[20:23], s41 offen
    s_add_u32 s41, s40, 11520
    buffer_load_ushort v26, v6, s[20:23], s41 offen
    s_add_u32 s41, s40, 12672
    buffer_load_ushort v27, v6, s[20:23], s41 offen
    s_branch LC_wo_done01
LC_wo_rest01:
    s_sub_u32 s39, s39, 32
    s_mul_i32 s40, s39, 165888
    s_add_u32 s40, s40, s37
    s_add_u32 s41, s40, 18432
    buffer_load_ushort v20, v7, s[20:23], s41 offen
    s_add_u32 s41, s40, 19584
    buffer_load_ushort v21, v7, s[20:23], s41 offen
    s_add_u32 s41, s40, 39168
    buffer_load_ushort v22, v7, s[20:23], s41 offen
    s_add_u32 s41, s40, 40320
    buffer_load_ushort v23, v7, s[20:23], s41 offen
    s_add_u32 s41, s40, 59904
    buffer_load_ushort v24, v7, s[20:23], s41 offen
    s_add_u32 s41, s40, 61056
    buffer_load_ushort v25, v7, s[20:23], s41 offen
    s_add_u32 s41, s40, 80640
    buffer_load_ushort v26, v7, s[20:23], s41 offen
    s_add_u32 s41, s40, 81792
    buffer_load_ushort v27, v7, s[20:23], s41 offen
LC_wo_done01:
    s_add_u32 s39, s38, 2
    s_cmp_ge_u32 s39, 32
    s_cbranch_scc1 LC_wo_rest02
    s_mul_i32 s40, s39, 20736
    s_add_u32 s40, s40, s37
    s_add_u32 s41, s40, 0
    buffer_load_ushort v28, v6, s[20:23], s41 offen
    s_add_u32 s41, s40, 1152
    buffer_load_ushort v29, v6, s[20:23], s41 offen
    s_add_u32 s41, s40, 2304
    buffer_load_ushort v30, v6, s[20:23], s41 offen
    s_add_u32 s41, s40, 3456
    buffer_load_ushort v31, v6, s[20:23], s41 offen
    s_add_u32 s41, s40, 9216
    buffer_load_ushort v32, v6, s[20:23], s41 offen
    s_add_u32 s41, s40, 10368
    buffer_load_ushort v33, v6, s[20:23], s41 offen
    s_add_u32 s41, s40, 11520
    buffer_load_ushort v34, v6, s[20:23], s41 offen
    s_add_u32 s41, s40, 12672
    buffer_load_ushort v35, v6, s[20:23], s41 offen
    s_branch LC_wo_done02
LC_wo_rest02:
    s_sub_u32 s39, s39, 32
    s_mul_i32 s40, s39, 165888
    s_add_u32 s40, s40, s37
    s_add_u32 s41, s40, 18432
    buffer_load_ushort v28, v7, s[20:23], s41 offen
    s_add_u32 s41, s40, 19584
    buffer_load_ushort v29, v7, s[20:23], s41 offen
    s_add_u32 s41, s40, 39168
    buffer_load_ushort v30, v7, s[20:23], s41 offen
    s_add_u32 s41, s40, 40320
    buffer_load_ushort v31, v7, s[20:23], s41 offen
    s_add_u32 s41, s40, 59904
    buffer_load_ushort v32, v7, s[20:23], s41 offen
    s_add_u32 s41, s40, 61056
    buffer_load_ushort v33, v7, s[20:23], s41 offen
    s_add_u32 s41, s40, 80640
    buffer_load_ushort v34, v7, s[20:23], s41 offen
    s_add_u32 s41, s40, 81792
    buffer_load_ushort v35, v7, s[20:23], s41 offen
LC_wo_done02:
    s_mul_i32 s36, s36, 3072
    s_add_u32 s36, s36, 5906432
    s_waitcnt vmcnt(27)
    s_barrier
    s_add_u32 m0, s26, 36864
    s_add_u32 s31, s25, 36864
    buffer_load_dwordx4 v1, s[16:19], s31 offen lds
    s_add_u32 m0, s26, 37888
    s_add_u32 s31, s25, 37888
    buffer_load_dwordx4 v1, s[16:19], s31 offen lds
    s_add_u32 m0, s26, 38912
    s_add_u32 s31, s25, 38912
    buffer_load_dwordx4 v1, s[16:19], s31 offen lds
    s_waitcnt vmcnt(27)
    s_barrier
    s_add_u32 m0, s26, 0
    s_add_u32 s31, s25, 49152
    buffer_load_dwordx4 v1, s[16:19], s31 offen lds
    s_add_u32 m0, s26, 1024
    s_add_u32 s31, s25, 50176
    buffer_load_dwordx4 v1, s[16:19], s31 offen lds
    s_add_u32 m0, s26, 2048
    s_add_u32 s31, s25, 51200
    buffer_load_dwordx4 v1, s[16:19], s31 offen lds
    s_waitcnt vmcnt(6)
    v_lshl_or_b32 v12, v13, 16, v12
    v_lshl_or_b32 v13, v15, 16, v14
    v_lshl_or_b32 v14, v17, 16, v16
    v_lshl_or_b32 v15, v19, 16, v18
    buffer_store_dwordx4 v[12:15], v1, s[16:19], s36 offen offset:0 sc1
    v_lshl_or_b32 v20, v21, 16, v20
    v_lshl_or_b32 v21, v23, 16, v22
    v_lshl_or_b32 v22, v25, 16, v24
    v_lshl_or_b32 v23, v27, 16, v26
    buffer_store_dwordx4 v[20:23], v1, s[16:19], s36 offen offset:1024 sc1
    v_lshl_or_b32 v28, v29, 16, v28
    v_lshl_or_b32 v29, v31, 16, v30
    v_lshl_or_b32 v30, v33, 16, v32
    v_lshl_or_b32 v31, v35, 16, v34
    buffer_store_dwordx4 v[28:31], v1, s[16:19], s36 offen offset:2048 sc1
    s_waitcnt vmcnt(6)
    s_barrier
    s_add_u32 m0, s26, 12288
    s_add_u32 s31, s25, 61440
    buffer_load_dwordx4 v1, s[16:19], s31 offen lds
    s_add_u32 m0, s26, 13312
    s_add_u32 s31, s25, 62464
    buffer_load_dwordx4 v1, s[16:19], s31 offen lds
    s_add_u32 m0, s26, 14336
    s_add_u32 s31, s25, 63488
    buffer_load_dwordx4 v1, s[16:19], s31 offen lds
    s_add_u32 s36, s35, 64
    s_min_u32 s36, s36, 215
    s_mul_i32 s37, s36, 0x1556
    s_lshr_b32 s37, s37, 16
    s_mul_i32 s38, s37, 12
    s_sub_u32 s38, s36, s38
    s_mul_i32 s38, s38, 3
    s_lshl_b32 s37, s37, 6
    s_add_u32 s39, s38, 0
    s_cmp_ge_u32 s39, 32
    s_cbranch_scc1 LC_wo_rest10
    s_mul_i32 s40, s39, 20736
    s_add_u32 s40, s40, s37
    s_add_u32 s41, s40, 0
    buffer_load_ushort v12, v6, s[20:23], s41 offen
    s_add_u32 s41, s40, 1152
    buffer_load_ushort v13, v6, s[20:23], s41 offen
    s_add_u32 s41, s40, 2304
    buffer_load_ushort v14, v6, s[20:23], s41 offen
    s_add_u32 s41, s40, 3456
    buffer_load_ushort v15, v6, s[20:23], s41 offen
    s_add_u32 s41, s40, 9216
    buffer_load_ushort v16, v6, s[20:23], s41 offen
    s_add_u32 s41, s40, 10368
    buffer_load_ushort v17, v6, s[20:23], s41 offen
    s_add_u32 s41, s40, 11520
    buffer_load_ushort v18, v6, s[20:23], s41 offen
    s_add_u32 s41, s40, 12672
    buffer_load_ushort v19, v6, s[20:23], s41 offen
    s_branch LC_wo_done10
LC_wo_rest10:
    s_sub_u32 s39, s39, 32
    s_mul_i32 s40, s39, 165888
    s_add_u32 s40, s40, s37
    s_add_u32 s41, s40, 18432
    buffer_load_ushort v12, v7, s[20:23], s41 offen
    s_add_u32 s41, s40, 19584
    buffer_load_ushort v13, v7, s[20:23], s41 offen
    s_add_u32 s41, s40, 39168
    buffer_load_ushort v14, v7, s[20:23], s41 offen
    s_add_u32 s41, s40, 40320
    buffer_load_ushort v15, v7, s[20:23], s41 offen
    s_add_u32 s41, s40, 59904
    buffer_load_ushort v16, v7, s[20:23], s41 offen
    s_add_u32 s41, s40, 61056
    buffer_load_ushort v17, v7, s[20:23], s41 offen
    s_add_u32 s41, s40, 80640
    buffer_load_ushort v18, v7, s[20:23], s41 offen
    s_add_u32 s41, s40, 81792
    buffer_load_ushort v19, v7, s[20:23], s41 offen
LC_wo_done10:
    s_add_u32 s39, s38, 1
    s_cmp_ge_u32 s39, 32
    s_cbranch_scc1 LC_wo_rest11
    s_mul_i32 s40, s39, 20736
    s_add_u32 s40, s40, s37
    s_add_u32 s41, s40, 0
    buffer_load_ushort v20, v6, s[20:23], s41 offen
    s_add_u32 s41, s40, 1152
    buffer_load_ushort v21, v6, s[20:23], s41 offen
    s_add_u32 s41, s40, 2304
    buffer_load_ushort v22, v6, s[20:23], s41 offen
    s_add_u32 s41, s40, 3456
    buffer_load_ushort v23, v6, s[20:23], s41 offen
    s_add_u32 s41, s40, 9216
    buffer_load_ushort v24, v6, s[20:23], s41 offen
    s_add_u32 s41, s40, 10368
    buffer_load_ushort v25, v6, s[20:23], s41 offen
    s_add_u32 s41, s40, 11520
    buffer_load_ushort v26, v6, s[20:23], s41 offen
    s_add_u32 s41, s40, 12672
    buffer_load_ushort v27, v6, s[20:23], s41 offen
    s_branch LC_wo_done11
LC_wo_rest11:
    s_sub_u32 s39, s39, 32
    s_mul_i32 s40, s39, 165888
    s_add_u32 s40, s40, s37
    s_add_u32 s41, s40, 18432
    buffer_load_ushort v20, v7, s[20:23], s41 offen
    s_add_u32 s41, s40, 19584
    buffer_load_ushort v21, v7, s[20:23], s41 offen
    s_add_u32 s41, s40, 39168
    buffer_load_ushort v22, v7, s[20:23], s41 offen
    s_add_u32 s41, s40, 40320
    buffer_load_ushort v23, v7, s[20:23], s41 offen
    s_add_u32 s41, s40, 59904
    buffer_load_ushort v24, v7, s[20:23], s41 offen
    s_add_u32 s41, s40, 61056
    buffer_load_ushort v25, v7, s[20:23], s41 offen
    s_add_u32 s41, s40, 80640
    buffer_load_ushort v26, v7, s[20:23], s41 offen
    s_add_u32 s41, s40, 81792
    buffer_load_ushort v27, v7, s[20:23], s41 offen
LC_wo_done11:
    s_add_u32 s39, s38, 2
    s_cmp_ge_u32 s39, 32
    s_cbranch_scc1 LC_wo_rest12
    s_mul_i32 s40, s39, 20736
    s_add_u32 s40, s40, s37
    s_add_u32 s41, s40, 0
    buffer_load_ushort v28, v6, s[20:23], s41 offen
    s_add_u32 s41, s40, 1152
    buffer_load_ushort v29, v6, s[20:23], s41 offen
    s_add_u32 s41, s40, 2304
    buffer_load_ushort v30, v6, s[20:23], s41 offen
    s_add_u32 s41, s40, 3456
    buffer_load_ushort v31, v6, s[20:23], s41 offen
    s_add_u32 s41, s40, 9216
    buffer_load_ushort v32, v6, s[20:23], s41 offen
    s_add_u32 s41, s40, 10368
    buffer_load_ushort v33, v6, s[20:23], s41 offen
    s_add_u32 s41, s40, 11520
    buffer_load_ushort v34, v6, s[20:23], s41 offen
    s_add_u32 s41, s40, 12672
    buffer_load_ushort v35, v6, s[20:23], s41 offen
    s_branch LC_wo_done12
LC_wo_rest12:
    s_sub_u32 s39, s39, 32
    s_mul_i32 s40, s39, 165888
    s_add_u32 s40, s40, s37
    s_add_u32 s41, s40, 18432
    buffer_load_ushort v28, v7, s[20:23], s41 offen
    s_add_u32 s41, s40, 19584
    buffer_load_ushort v29, v7, s[20:23], s41 offen
    s_add_u32 s41, s40, 39168
    buffer_load_ushort v30, v7, s[20:23], s41 offen
    s_add_u32 s41, s40, 40320
    buffer_load_ushort v31, v7, s[20:23], s41 offen
    s_add_u32 s41, s40, 59904
    buffer_load_ushort v32, v7, s[20:23], s41 offen
    s_add_u32 s41, s40, 61056
    buffer_load_ushort v33, v7, s[20:23], s41 offen
    s_add_u32 s41, s40, 80640
    buffer_load_ushort v34, v7, s[20:23], s41 offen
    s_add_u32 s41, s40, 81792
    buffer_load_ushort v35, v7, s[20:23], s41 offen
LC_wo_done12:
    s_mul_i32 s36, s36, 3072
    s_add_u32 s36, s36, 5906432
    s_waitcnt vmcnt(30)
    s_barrier
    s_add_u32 m0, s26, 24576
    s_add_u32 s31, s25, 73728
    buffer_load_dwordx4 v1, s[16:19], s31 offen lds
    s_add_u32 m0, s26, 25600
    s_add_u32 s31, s25, 74752
    buffer_load_dwordx4 v1, s[16:19], s31 offen lds
    s_add_u32 m0, s26, 26624
    s_add_u32 s31, s25, 75776
    buffer_load_dwordx4 v1, s[16:19], s31 offen lds
    s_waitcnt vmcnt(27)
    s_barrier
    s_add_u32 m0, s26, 36864
    s_add_u32 s31, s25, 86016
    buffer_load_dwordx4 v1, s[16:19], s31 offen lds
    s_add_u32 m0, s26, 37888
    s_add_u32 s31, s25, 87040
    buffer_load_dwordx4 v1, s[16:19], s31 offen lds
    s_add_u32 m0, s26, 38912
    s_add_u32 s31, s25, 88064
    buffer_load_dwordx4 v1, s[16:19], s31 offen lds
    s_waitcnt vmcnt(6)
    v_lshl_or_b32 v12, v13, 16, v12
    v_lshl_or_b32 v13, v15, 16, v14
    v_lshl_or_b32 v14, v17, 16, v16
    v_lshl_or_b32 v15, v19, 16, v18
    buffer_store_dwordx4 v[12:15], v1, s[16:19], s36 offen offset:0 sc1
    v_lshl_or_b32 v20, v21, 16, v20
    v_lshl_or_b32 v21, v23, 16, v22
    v_lshl_or_b32 v22, v25, 16, v24
    v_lshl_or_b32 v23, v27, 16, v26
    buffer_store_dwordx4 v[20:23], v1, s[16:19], s36 offen offset:1024 sc1
    v_lshl_or_b32 v28, v29, 16, v28
    v_lshl_or_b32 v29, v31, 16, v30
    v_lshl_or_b32 v30, v33, 16, v32
    v_lshl_or_b32 v31, v35, 16, v34
    buffer_store_dwordx4 v[28:31], v1, s[16:19], s36 offen offset:2048 sc1
    s_waitcnt vmcnt(6)
    s_barrier
    s_add_u32 m0, s26, 0
    s_add_u32 s31, s25, 98304
    buffer_load_dwordx4 v1, s[16:19], s31 offen lds
    s_add_u32 m0, s26, 1024
    s_add_u32 s31, s25, 99328
    buffer_load_dwordx4 v1, s[16:19], s31 offen lds
    s_add_u32 m0, s26, 2048
    s_add_u32 s31, s25, 100352
    buffer_load_dwordx4 v1, s[16:19], s31 offen lds
    s_add_u32 s36, s35, 128
    s_min_u32 s36, s36, 215
    s_mul_i32 s37, s36, 0x1556
    s_lshr_b32 s37, s37, 16
    s_mul_i32 s38, s37, 12
    s_sub_u32 s38, s36, s38
    s_mul_i32 s38, s38, 3
    s_lshl_b32 s37, s37, 6
    s_add_u32 s39, s38, 0
    s_cmp_ge_u32 s39, 32
    s_cbranch_scc1 LC_wo_rest20
    s_mul_i32 s40, s39, 20736
    s_add_u32 s40, s40, s37
    s_add_u32 s41, s40, 0
    buffer_load_ushort v12, v6, s[20:23], s41 offen
    s_add_u32 s41, s40, 1152
    buffer_load_ushort v13, v6, s[20:23], s41 offen
    s_add_u32 s41, s40, 2304
    buffer_load_ushort v14, v6, s[20:23], s41 offen
    s_add_u32 s41, s40, 3456
    buffer_load_ushort v15, v6, s[20:23], s41 offen
    s_add_u32 s41, s40, 9216
    buffer_load_ushort v16, v6, s[20:23], s41 offen
    s_add_u32 s41, s40, 10368
    buffer_load_ushort v17, v6, s[20:23], s41 offen
    s_add_u32 s41, s40, 11520
    buffer_load_ushort v18, v6, s[20:23], s41 offen
    s_add_u32 s41, s40, 12672
    buffer_load_ushort v19, v6, s[20:23], s41 offen
    s_branch LC_wo_done20
LC_wo_rest20:
    s_sub_u32 s39, s39, 32
    s_mul_i32 s40, s39, 165888
    s_add_u32 s40, s40, s37
    s_add_u32 s41, s40, 18432
    buffer_load_ushort v12, v7, s[20:23], s41 offen
    s_add_u32 s41, s40, 19584
    buffer_load_ushort v13, v7, s[20:23], s41 offen
    s_add_u32 s41, s40, 39168
    buffer_load_ushort v14, v7, s[20:23], s41 offen
    s_add_u32 s41, s40, 40320
    buffer_load_ushort v15, v7, s[20:23], s41 offen
    s_add_u32 s41, s40, 59904
    buffer_load_ushort v16, v7, s[20:23], s41 offen
    s_add_u32 s41, s40, 61056
    buffer_load_ushort v17, v7, s[20:23], s41 offen
    s_add_u32 s41, s40, 80640
    buffer_load_ushort v18, v7, s[20:23], s41 offen
    s_add_u32 s41, s40, 81792
    buffer_load_ushort v19, v7, s[20:23], s41 offen
LC_wo_done20:
    s_add_u32 s39, s38, 1
    s_cmp_ge_u32 s39, 32
    s_cbranch_scc1 LC_wo_rest21
    s_mul_i32 s40, s39, 20736
    s_add_u32 s40, s40, s37
    s_add_u32 s41, s40, 0
    buffer_load_ushort v20, v6, s[20:23], s41 offen
    s_add_u32 s41, s40, 1152
    buffer_load_ushort v21, v6, s[20:23], s41 offen
    s_add_u32 s41, s40, 2304
    buffer_load_ushort v22, v6, s[20:23], s41 offen
    s_add_u32 s41, s40, 3456
    buffer_load_ushort v23, v6, s[20:23], s41 offen
    s_add_u32 s41, s40, 9216
    buffer_load_ushort v24, v6, s[20:23], s41 offen
    s_add_u32 s41, s40, 10368
    buffer_load_ushort v25, v6, s[20:23], s41 offen
    s_add_u32 s41, s40, 11520
    buffer_load_ushort v26, v6, s[20:23], s41 offen
    s_add_u32 s41, s40, 12672
    buffer_load_ushort v27, v6, s[20:23], s41 offen
    s_branch LC_wo_done21
LC_wo_rest21:
    s_sub_u32 s39, s39, 32
    s_mul_i32 s40, s39, 165888
    s_add_u32 s40, s40, s37
    s_add_u32 s41, s40, 18432
    buffer_load_ushort v20, v7, s[20:23], s41 offen
    s_add_u32 s41, s40, 19584
    buffer_load_ushort v21, v7, s[20:23], s41 offen
    s_add_u32 s41, s40, 39168
    buffer_load_ushort v22, v7, s[20:23], s41 offen
    s_add_u32 s41, s40, 40320
    buffer_load_ushort v23, v7, s[20:23], s41 offen
    s_add_u32 s41, s40, 59904
    buffer_load_ushort v24, v7, s[20:23], s41 offen
    s_add_u32 s41, s40, 61056
    buffer_load_ushort v25, v7, s[20:23], s41 offen
    s_add_u32 s41, s40, 80640
    buffer_load_ushort v26, v7, s[20:23], s41 offen
    s_add_u32 s41, s40, 81792
    buffer_load_ushort v27, v7, s[20:23], s41 offen
LC_wo_done21:
    s_add_u32 s39, s38, 2
    s_cmp_ge_u32 s39, 32
    s_cbranch_scc1 LC_wo_rest22
    s_mul_i32 s40, s39, 20736
    s_add_u32 s40, s40, s37
    s_add_u32 s41, s40, 0
    buffer_load_ushort v28, v6, s[20:23], s41 offen
    s_add_u32 s41, s40, 1152
    buffer_load_ushort v29, v6, s[20:23], s41 offen
    s_add_u32 s41, s40, 2304
    buffer_load_ushort v30, v6, s[20:23], s41 offen
    s_add_u32 s41, s40, 3456
    buffer_load_ushort v31, v6, s[20:23], s41 offen
    s_add_u32 s41, s40, 9216
    buffer_load_ushort v32, v6, s[20:23], s41 offen
    s_add_u32 s41, s40, 10368
    buffer_load_ushort v33, v6, s[20:23], s41 offen
    s_add_u32 s41, s40, 11520
    buffer_load_ushort v34, v6, s[20:23], s41 offen
    s_add_u32 s41, s40, 12672
    buffer_load_ushort v35, v6, s[20:23], s41 offen
    s_branch LC_wo_done22
LC_wo_rest22:
    s_sub_u32 s39, s39, 32
    s_mul_i32 s40, s39, 165888
    s_add_u32 s40, s40, s37
    s_add_u32 s41, s40, 18432
    buffer_load_ushort v28, v7, s[20:23], s41 offen
    s_add_u32 s41, s40, 19584
    buffer_load_ushort v29, v7, s[20:23], s41 offen
    s_add_u32 s41, s40, 39168
    buffer_load_ushort v30, v7, s[20:23], s41 offen
    s_add_u32 s41, s40, 40320
    buffer_load_ushort v31, v7, s[20:23], s41 offen
    s_add_u32 s41, s40, 59904
    buffer_load_ushort v32, v7, s[20:23], s41 offen
    s_add_u32 s41, s40, 61056
    buffer_load_ushort v33, v7, s[20:23], s41 offen
    s_add_u32 s41, s40, 80640
    buffer_load_ushort v34, v7, s[20:23], s41 offen
    s_add_u32 s41, s40, 81792
    buffer_load_ushort v35, v7, s[20:23], s41 offen
LC_wo_done22:
    s_mul_i32 s36, s36, 3072
    s_add_u32 s36, s36, 5906432
    s_waitcnt vmcnt(30)
    s_barrier
    s_add_u32 m0, s26, 12288
    s_add_u32 s31, s25, 110592
    buffer_load_dwordx4 v1, s[16:19], s31 offen lds
    s_add_u32 m0, s26, 13312
    s_add_u32 s31, s25, 111616
    buffer_load_dwordx4 v1, s[16:19], s31 offen lds
    s_add_u32 m0, s26, 14336
    s_add_u32 s31, s25, 112640
    buffer_load_dwordx4 v1, s[16:19], s31 offen lds
    s_waitcnt vmcnt(27)
    s_barrier
    s_add_u32 m0, s26, 24576
    s_add_u32 s31, s25, 122880
    buffer_load_dwordx4 v1, s[16:19], s31 offen lds
    s_add_u32 m0, s26, 25600
    s_add_u32 s31, s25, 123904
    buffer_load_dwordx4 v1, s[16:19], s31 offen lds
    s_add_u32 m0, s26, 26624
    s_add_u32 s31, s25, 124928
    buffer_load_dwordx4 v1, s[16:19], s31 offen lds
    s_waitcnt vmcnt(6)
    v_lshl_or_b32 v12, v13, 16, v12
    v_lshl_or_b32 v13, v15, 16, v14
    v_lshl_or_b32 v14, v17, 16, v16
    v_lshl_or_b32 v15, v19, 16, v18
    buffer_store_dwordx4 v[12:15], v1, s[16:19], s36 offen offset:0 sc1
    v_lshl_or_b32 v20, v21, 16, v20
    v_lshl_or_b32 v21, v23, 16, v22
    v_lshl_or_b32 v22, v25, 16, v24
    v_lshl_or_b32 v23, v27, 16, v26
    buffer_store_dwordx4 v[20:23], v1, s[16:19], s36 offen offset:1024 sc1
    v_lshl_or_b32 v28, v29, 16, v28
    v_lshl_or_b32 v29, v31, 16, v30
    v_lshl_or_b32 v30, v33, 16, v32
    v_lshl_or_b32 v31, v35, 16, v34
    buffer_store_dwordx4 v[28:31], v1, s[16:19], s36 offen offset:2048 sc1
    s_waitcnt vmcnt(6)
    s_barrier
    s_add_u32 m0, s26, 36864
    s_add_u32 s31, s25, 135168
    buffer_load_dwordx4 v1, s[16:19], s31 offen lds
    s_add_u32 m0, s26, 37888
    s_add_u32 s31, s25, 136192
    buffer_load_dwordx4 v1, s[16:19], s31 offen lds
    s_add_u32 m0, s26, 38912
    s_add_u32 s31, s25, 137216
    buffer_load_dwordx4 v1, s[16:19], s31 offen lds
    s_add_u32 s36, s35, 192
    s_min_u32 s36, s36, 215
    s_mul_i32 s37, s36, 0x1556
    s_lshr_b32 s37, s37, 16
    s_mul_i32 s38, s37, 12
    s_sub_u32 s38, s36, s38
    s_mul_i32 s38, s38, 3
    s_lshl_b32 s37, s37, 6
    s_add_u32 s39, s38, 0
    s_cmp_ge_u32 s39, 32
    s_cbranch_scc1 LC_wo_rest30
    s_mul_i32 s40, s39, 20736
    s_add_u32 s40, s40, s37
    s_add_u32 s41, s40, 0
    buffer_load_ushort v12, v6, s[20:23], s41 offen
    s_add_u32 s41, s40, 1152
    buffer_load_ushort v13, v6, s[20:23], s41 offen
    s_add_u32 s41, s40, 2304
    buffer_load_ushort v14, v6, s[20:23], s41 offen
    s_add_u32 s41, s40, 3456
    buffer_load_ushort v15, v6, s[20:23], s41 offen
    s_add_u32 s41, s40, 9216
    buffer_load_ushort v16, v6, s[20:23], s41 offen
    s_add_u32 s41, s40, 10368
    buffer_load_ushort v17, v6, s[20:23], s41 offen
    s_add_u32 s41, s40, 11520
    buffer_load_ushort v18, v6, s[20:23], s41 offen
    s_add_u32 s41, s40, 12672
    buffer_load_ushort v19, v6, s[20:23], s41 offen
    s_branch LC_wo_done30
LC_wo_rest30:
    s_sub_u32 s39, s39, 32
    s_mul_i32 s40, s39, 165888
    s_add_u32 s40, s40, s37
    s_add_u32 s41, s40, 18432
    buffer_load_ushort v12, v7, s[20:23], s41 offen
    s_add_u32 s41, s40, 19584
    buffer_load_ushort v13, v7, s[20:23], s41 offen
    s_add_u32 s41, s40, 39168
    buffer_load_ushort v14, v7, s[20:23], s41 offen
    s_add_u32 s41, s40, 40320
    buffer_load_ushort v15, v7, s[20:23], s41 offen
    s_add_u32 s41, s40, 59904
    buffer_load_ushort v16, v7, s[20:23], s41 offen
    s_add_u32 s41, s40, 61056
    buffer_load_ushort v17, v7, s[20:23], s41 offen
    s_add_u32 s41, s40, 80640
    buffer_load_ushort v18, v7, s[20:23], s41 offen
    s_add_u32 s41, s40, 81792
    buffer_load_ushort v19, v7, s[20:23], s41 offen
LC_wo_done30:
    s_add_u32 s39, s38, 1
    s_cmp_ge_u32 s39, 32
    s_cbranch_scc1 LC_wo_rest31
    s_mul_i32 s40, s39, 20736
    s_add_u32 s40, s40, s37
    s_add_u32 s41, s40, 0
    buffer_load_ushort v20, v6, s[20:23], s41 offen
    s_add_u32 s41, s40, 1152
    buffer_load_ushort v21, v6, s[20:23], s41 offen
    s_add_u32 s41, s40, 2304
    buffer_load_ushort v22, v6, s[20:23], s41 offen
    s_add_u32 s41, s40, 3456
    buffer_load_ushort v23, v6, s[20:23], s41 offen
    s_add_u32 s41, s40, 9216
    buffer_load_ushort v24, v6, s[20:23], s41 offen
    s_add_u32 s41, s40, 10368
    buffer_load_ushort v25, v6, s[20:23], s41 offen
    s_add_u32 s41, s40, 11520
    buffer_load_ushort v26, v6, s[20:23], s41 offen
    s_add_u32 s41, s40, 12672
    buffer_load_ushort v27, v6, s[20:23], s41 offen
    s_branch LC_wo_done31
LC_wo_rest31:
    s_sub_u32 s39, s39, 32
    s_mul_i32 s40, s39, 165888
    s_add_u32 s40, s40, s37
    s_add_u32 s41, s40, 18432
    buffer_load_ushort v20, v7, s[20:23], s41 offen
    s_add_u32 s41, s40, 19584
    buffer_load_ushort v21, v7, s[20:23], s41 offen
    s_add_u32 s41, s40, 39168
    buffer_load_ushort v22, v7, s[20:23], s41 offen
    s_add_u32 s41, s40, 40320
    buffer_load_ushort v23, v7, s[20:23], s41 offen
    s_add_u32 s41, s40, 59904
    buffer_load_ushort v24, v7, s[20:23], s41 offen
    s_add_u32 s41, s40, 61056
    buffer_load_ushort v25, v7, s[20:23], s41 offen
    s_add_u32 s41, s40, 80640
    buffer_load_ushort v26, v7, s[20:23], s41 offen
    s_add_u32 s41, s40, 81792
    buffer_load_ushort v27, v7, s[20:23], s41 offen
LC_wo_done31:
    s_add_u32 s39, s38, 2
    s_cmp_ge_u32 s39, 32
    s_cbranch_scc1 LC_wo_rest32
    s_mul_i32 s40, s39, 20736
    s_add_u32 s40, s40, s37
    s_add_u32 s41, s40, 0
    buffer_load_ushort v28, v6, s[20:23], s41 offen
    s_add_u32 s41, s40, 1152
    buffer_load_ushort v29, v6, s[20:23], s41 offen
    s_add_u32 s41, s40, 2304
    buffer_load_ushort v30, v6, s[20:23], s41 offen
    s_add_u32 s41, s40, 3456
    buffer_load_ushort v31, v6, s[20:23], s41 offen
    s_add_u32 s41, s40, 9216
    buffer_load_ushort v32, v6, s[20:23], s41 offen
    s_add_u32 s41, s40, 10368
    buffer_load_ushort v33, v6, s[20:23], s41 offen
    s_add_u32 s41, s40, 11520
    buffer_load_ushort v34, v6, s[20:23], s41 offen
    s_add_u32 s41, s40, 12672
    buffer_load_ushort v35, v6, s[20:23], s41 offen
    s_branch LC_wo_done32
LC_wo_rest32:
    s_sub_u32 s39, s39, 32
    s_mul_i32 s40, s39, 165888
    s_add_u32 s40, s40, s37
    s_add_u32 s41, s40, 18432
    buffer_load_ushort v28, v7, s[20:23], s41 offen
    s_add_u32 s41, s40, 19584
    buffer_load_ushort v29, v7, s[20:23], s41 offen
    s_add_u32 s41, s40, 39168
    buffer_load_ushort v30, v7, s[20:23], s41 offen
    s_add_u32 s41, s40, 40320
    buffer_load_ushort v31, v7, s[20:23], s41 offen
    s_add_u32 s41, s40, 59904
    buffer_load_ushort v32, v7, s[20:23], s41 offen
    s_add_u32 s41, s40, 61056
    buffer_load_ushort v33, v7, s[20:23], s41 offen
    s_add_u32 s41, s40, 80640
    buffer_load_ushort v34, v7, s[20:23], s41 offen
    s_add_u32 s41, s40, 81792
    buffer_load_ushort v35, v7, s[20:23], s41 offen
LC_wo_done32:
    s_mul_i32 s36, s36, 3072
    s_add_u32 s36, s36, 5906432
    s_waitcnt vmcnt(30)
    s_barrier
    s_add_u32 m0, s26, 0
    s_add_u32 s31, s25, 147456
    buffer_load_dwordx4 v1, s[16:19], s31 offen lds
    s_add_u32 m0, s26, 1024
    s_add_u32 s31, s25, 148480
    buffer_load_dwordx4 v1, s[16:19], s31 offen lds
    s_add_u32 m0, s26, 2048
    s_add_u32 s31, s25, 149504
    buffer_load_dwordx4 v1, s[16:19], s31 offen lds
    s_waitcnt vmcnt(27)
    s_barrier
    s_add_u32 m0, s26, 12288
    s_add_u32 s31, s25, 159744
    buffer_load_dwordx4 v1, s[16:19], s31 offen lds
    s_add_u32 m0, s26, 13312
    s_add_u32 s31, s25, 160768
    buffer_load_dwordx4 v1, s[16:19], s31 offen lds
    s_add_u32 m0, s26, 14336
    s_add_u32 s31, s25, 161792
    buffer_load_dwordx4 v1, s[16:19], s31 offen lds
    s_waitcnt vmcnt(6)
    v_lshl_or_b32 v12, v13, 16, v12
    v_lshl_or_b32 v13, v15, 16, v14
    v_lshl_or_b32 v14, v17, 16, v16
    v_lshl_or_b32 v15, v19, 16, v18
    buffer_store_dwordx4 v[12:15], v1, s[16:19], s36 offen offset:0 sc1
    v_lshl_or_b32 v20, v21, 16, v20
    v_lshl_or_b32 v21, v23, 16, v22
    v_lshl_or_b32 v22, v25, 16, v24
    v_lshl_or_b32 v23, v27, 16, v26
    buffer_store_dwordx4 v[20:23], v1, s[16:19], s36 offen offset:1024 sc1
    v_lshl_or_b32 v28, v29, 16, v28
    v_lshl_or_b32 v29, v31, 16, v30
    v_lshl_or_b32 v30, v33, 16, v32
    v_lshl_or_b32 v31, v35, 16, v34
    buffer_store_dwordx4 v[28:31], v1, s[16:19], s36 offen offset:2048 sc1
    s_waitcnt vmcnt(6)
    s_barrier
    s_add_u32 m0, s26, 24576
    s_add_u32 s31, s25, 172032
    buffer_load_dwordx4 v1, s[16:19], s31 offen lds
    s_add_u32 m0, s26, 25600
    s_add_u32 s31, s25, 173056
    buffer_load_dwordx4 v1, s[16:19], s31 offen lds
    s_add_u32 m0, s26, 26624
    s_add_u32 s31, s25, 174080
    buffer_load_dwordx4 v1, s[16:19], s31 offen lds
    s_waitcnt vmcnt(6)
    s_barrier
    s_add_u32 m0, s26, 36864
    s_add_u32 s31, s25, 184320
    buffer_load_dwordx4 v1, s[16:19], s31 offen lds
    s_add_u32 m0, s26, 37888
    s_add_u32 s31, s25, 185344
    buffer_load_dwordx4 v1, s[16:19], s31 offen lds
    s_add_u32 m0, s26, 38912
    s_add_u32 s31, s25, 186368
    buffer_load_dwordx4 v1, s[16:19], s31 offen lds
    s_waitcnt vmcnt(0)
    v_mov_b32 v2, 1
    v_mov_b32 v3, 0
    s_mov_b32 s36, 36986880
    s_mov_b64 exec, 1
    buffer_atomic_add v2, v3, s[16:19], s36 offen
    s_mov_b64 exec, -1
    s_waitcnt vmcnt(4)
    s_barrier
    s_waitcnt vmcnt(1)
    s_barrier
    s_mov_b32 s50, 36986880
    v_mov_b32 v3, 0
    s_mov_b32 s51, 0x40000
LC_pollW2:
    buffer_load_dword v2, v3, s[16:19], s50 offen sc1
    s_waitcnt vmcnt(0)
    v_readfirstlane_b32 s52, v2
    s_nop 0
    s_cmp_ge_u32 s52, 64
    s_cbranch_scc1 LC_pdW2
    s_sub_u32 s51, s51, 1
    s_cmp_lg_u32 s51, 0
    s_cbranch_scc1 LC_pollW2
LC_pdW2:
    s_mul_i32 s42, s14, 43
    s_lshr_b32 s42, s42, 8
    s_mul_i32 s42, s42, 6
    s_sub_u32 s42, s14, s42
    s_mul_i32 s42, s42, 108
    s_mul_i32 s43, s24, 3
    s_add_u32 s43, s43, 0
    s_lshr_b32 s46, s43, 2
    s_mul_i32 s46, s46, 36
    s_add_u32 s46, s46, s42
    s_and_b32 s43, s43, 3
    s_add_u32 s47, s46, s43
    s_lshl_b32 s47, s47, 10
    s_add_u32 s81, s47, 5939200
    s_lshl_b32 s43, s43, 3
    s_add_u32 s43, s43, s46
    s_lshl_b32 s43, s43, 10
    s_add_u32 s78, s43, 5906432
    s_mul_i32 s43, s24, 3
    s_add_u32 s43, s43, 1
    s_lshr_b32 s46, s43, 2
    s_mul_i32 s46, s46, 36
    s_add_u32 s46, s46, s42
    s_and_b32 s43, s43, 3
    s_add_u32 s47, s46, s43
    s_lshl_b32 s47, s47, 10
    s_add_u32 s82, s47, 5939200
    s_lshl_b32 s43, s43, 3
    s_add_u32 s43, s43, s46
    s_lshl_b32 s43, s43, 10
    s_add_u32 s79, s43, 5906432
    s_mul_i32 s43, s24, 3
    s_add_u32 s43, s43, 2
    s_lshr_b32 s46, s43, 2
    s_mul_i32 s46, s46, 36
    s_add_u32 s46, s46, s42
    s_and_b32 s43, s43, 3
    s_add_u32 s47, s46, s43
    s_lshl_b32 s47, s47, 10
    s_add_u32 s83, s47, 5939200
    s_lshl_b32 s43, s43, 3
    s_add_u32 s43, s43, s46
    s_lshl_b32 s43, s43, 10
    s_add_u32 s80, s43, 5906432
    s_mul_i32 s84, s24, 3072
    s_add_u32 m0, s84, 122880
    s_add_u32 s31, s78, 0
    buffer_load_dwordx4 v1, s[16:19], s31 offen sc1 lds
    s_add_u32 m0, s84, 123904
    s_add_u32 s31, s79, 0
    buffer_load_dwordx4 v1, s[16:19], s31 offen sc1 lds
    s_add_u32 m0, s84, 124928
    s_add_u32 s31, s80, 0
    buffer_load_dwordx4 v1, s[16:19], s31 offen sc1 lds
    s_add_u32 m0, s84, 135168
    s_add_u32 s31, s78, 1024
    buffer_load_dwordx4 v1, s[16:19], s31 offen sc1 lds
    s_add_u32 m0, s84, 136192
    s_add_u32 s31, s79, 1024
    buffer_load_dwordx4 v1, s[16:19], s31 offen sc1 lds
    s_add_u32 m0, s84, 137216
    s_add_u32 s31, s80, 1024
    buffer_load_dwordx4 v1, s[16:19], s31 offen sc1 lds
    s_add_u32 m0, s84, 49152
    s_add_u32 s31, s78, 2048
    buffer_load_dwordx4 v1, s[16:19], s31 offen sc1 lds
    s_add_u32 m0, s84, 50176
    s_add_u32 s31, s79, 2048
    buffer_load_dwordx4 v1, s[16:19], s31 offen sc1 lds
    s_add_u32 m0, s84, 51200
    s_add_u32 s31, s80, 2048
    buffer_load_dwordx4 v1, s[16:19], s31 offen sc1 lds
    s_add_u32 m0, s84, 61440
    s_add_u32 s31, s78, 3072
    buffer_load_dwordx4 v1, s[16:19], s31 offen sc1 lds
    s_add_u32 m0, s84, 62464
    s_add_u32 s31, s79, 3072
    buffer_load_dwordx4 v1, s[16:19], s31 offen sc1 lds
    s_add_u32 m0, s84, 63488
    s_add_u32 s31, s80, 3072
    buffer_load_dwordx4 v1, s[16:19], s31 offen sc1 lds
    s_add_u32 m0, s84, 73728
    s_add_u32 s31, s78, 4096
    buffer_load_dwordx4 v1, s[16:19], s31 offen sc1 lds
    s_add_u32 m0, s84, 74752
    s_add_u32 s31, s79, 4096
    buffer_load_dwordx4 v1, s[16:19], s31 offen sc1 lds
    s_add_u32 m0, s84, 75776
    s_add_u32 s31, s80, 4096
    buffer_load_dwordx4 v1, s[16:19], s31 offen sc1 lds
    s_add_u32 m0, s84, 86016
    s_add_u32 s31, s78, 5120
    buffer_load_dwordx4 v1, s[16:19], s31 offen sc1 lds
    s_add_u32 m0, s84, 87040
    s_add_u32 s31, s79, 5120
    buffer_load_dwordx4 v1, s[16:19], s31 offen sc1 lds
    s_add_u32 m0, s84, 88064
    s_add_u32 s31, s80, 5120
    buffer_load_dwordx4 v1, s[16:19], s31 offen sc1 lds
    s_add_u32 m0, s84, 98304
    s_add_u32 s31, s78, 6144
    buffer_load_dwordx4 v1, s[16:19], s31 offen sc1 lds
    s_add_u32 m0, s84, 99328
    s_add_u32 s31, s79, 6144
    buffer_load_dwordx4 v1, s[16:19], s31 offen sc1 lds
    s_add_u32 m0, s84, 100352
    s_add_u32 s31, s80, 6144
    buffer_load_dwordx4 v1, s[16:19], s31 offen sc1 lds
    s_add_u32 m0, s84, 110592
    s_add_u32 s31, s78, 7168
    buffer_load_dwordx4 v1, s[16:19], s31 offen sc1 lds
    s_add_u32 m0, s84, 111616
    s_add_u32 s31, s79, 7168
    buffer_load_dwordx4 v1, s[16:19], s31 offen sc1 lds
    s_add_u32 m0, s84, 112640
    s_add_u32 s31, s80, 7168
    buffer_load_dwordx4 v1, s[16:19], s31 offen sc1 lds
    s_add_u32 m0, s84, 0
    s_nop 0
    buffer_load_dwordx4 v1, s[16:19], s81 offen sc1 lds
    s_add_u32 m0, s84, 1024
    s_nop 0
    buffer_load_dwordx4 v1, s[16:19], s82 offen sc1 lds
    s_add_u32 m0, s84, 2048
    s_nop 0
    buffer_load_dwordx4 v1, s[16:19], s83 offen sc1 lds
    s_barrier
LC_tail:
    s_cmp_ge_u32 s14, 24
    s_cbranch_scc1 LC_nod
    s_mul_i32 s28, s14, 43
    s_lshr_b32 s28, s28, 8
    s_mul_i32 s29, s28, 6
    s_sub_u32 s29, s14, s29
    s_lshl_b32 s30, s12, 2
    s_add_u32 s28, s28, s30
    s_and_b32 s30, s3, 3
    s_lshr_b32 s31, s3, 2
    s_mul_i32 s35, s28, 6
    s_add_u32 s35, s35, s29
    s_mul_i32 s35, s35, 61568
    s_add_u32 s35, s35, 37027840
    s_cmp_lg_u32 s3, 8
    s_cbranch_scc1 LC_np
    s_add_u32 s36, s35, 61440
    s_mov_b32 s50, s36
    v_mov_b32 v3, 0
    s_mov_b32 s51, 0x40000
LC_pollP:
    buffer_load_dword v2, v3, s[16:19], s50 offen sc1
    s_waitcnt vmcnt(0)
    v_readfirstlane_b32 s52, v2
    s_nop 0
    s_cmp_ge_u32 s52, 5
    s_cbranch_scc1 LC_pdP
    s_sub_u32 s51, s51, 1
    s_cmp_lg_u32 s51, 0
    s_cbranch_scc1 LC_pollP
LC_pdP:
LC_np:
    s_cmp_lt_u32 s3, 8
    s_cbranch_scc1 LC_n18
    s_waitcnt vmcnt(0)
LC_n18:
    s_waitcnt lgkmcnt(0)
    s_barrier
    s_lshl_b32 s36, s31, 2
    s_add_u32 s36, s36, s30
    s_lshl_b32 s36, s36, 10
    s_add_u32 s35, s35, s36
    s_cmp_eq_u32 s3, 11
    s_cbranch_scc1 LC_p1
    buffer_load_dwordx4 v[124:127], v1, s[16:19], s35 offen sc1
    s_add_u32 s35, s35, 12288
    buffer_load_dwordx4 v[128:131], v1, s[16:19], s35 offen sc1
    s_add_u32 s35, s35, 12288
    buffer_load_dwordx4 v[132:135], v1, s[16:19], s35 offen sc1
    s_add_u32 s35, s35, 12288
    buffer_load_dwordx4 v[136:139], v1, s[16:19], s35 offen sc1
    s_add_u32 s35, s35, 12288
    buffer_load_dwordx4 v[140:143], v1, s[16:19], s35 offen sc1
LC_p1:
    s_lshl_b32 s32, s30, 7
    v_xor_b32 v4, s32, v1
    s_lshl_b32 s32, s3, 10
    v_add_u32 v4, s32, v4
    v_add_u32 v2, 0x10000, v4
    v_add_u32 v3, 0x20000, v4
    ds_read_b128 v[16:19], v2 offset:57344
    ds_read_b128 v[20:23], v3 offset:4096
    ds_read_b128 v[24:27], v4 offset:49152
    ds_read_b128 v[28:31], v4 offset:61440
    ds_read_b128 v[32:35], v2 offset:8192
    ds_read_b128 v[36:39], v2 offset:20480
    ds_read_b128 v[40:43], v2 offset:32768
    ds_read_b128 v[44:47], v2 offset:45056
    ds_read_b128 v[48:51], v4 offset:0
    s_lshl_b32 s34, s3, 6
    v_add_u32 v2, s34, v0
    v_mul_u32_u24 v3, 0x1556, v2
    v_lshrrev_b32 v3, 16, v3
    v_mul_u32_u24 v13, 12, v3
    v_sub_u32 v13, v2, v13
    v_lshlrev_b32 v13, 4, v13
    v_mul_u32_u24 v14, 1152, v3
    v_add_u32 v6, v14, v13
    v_mul_u32_u24 v3, 208, v3
    s_mov_b32 s34, 73728
    v_add3_u32 v7, v3, v13, s34
    s_mul_i32 s37, s28, 73728
    s_mul_i32 s38, s29, 192
    s_add_u32 s37, s37, s38
    s_mov_b32 s20, s4
    s_mov_b32 s21, s5
    s_mov_b32 s22, 2359296
    s_mov_b32 s23, 0x20000
    s_mov_b32 s24, s6
    s_mov_b32 s25, s7
    s_mov_b32 s26, 2359296
    s_mov_b32 s27, 0x20000
    s_cmp_eq_u32 s3, 11
    s_cbranch_scc1 LC_p2
    buffer_load_dwordx4 v[164:167], v6, s[20:23], s37 offen
LC_p2:
    v_and_b32 v2, 31, v0
    v_lshrrev_b32 v3, 5, v0
    v_lshlrev_b32 v5, 2, v2
    v_lshl_add_u32 v5, v3, 9, v5
    v_mul_u32_u24 v2, 208, v2
    v_lshl_add_u32 v2, v3, 3, v2
    s_lshl_b32 s36, s31, 6
    s_lshl_b32 s38, s30, 4
    s_add_u32 s36, s36, s38
    s_add_u32 s36, s36, 73728
    v_add_u32 v8, s36, v2
    s_mul_i32 s36, s3, 6144
    v_add_u32 v9, s36, v1
    s_xor_b32 s36, s3, 1
    s_mul_i32 s36, s36, 6144
    s_add_u32 s36, s36, 0
    v_add_u32 v10, s36, v1
    s_xor_b32 s36, s3, 2
    s_mul_i32 s36, s36, 6144
    s_add_u32 s36, s36, 2048
    v_add_u32 v11, s36, v1
    s_xor_b32 s36, s3, 3
    s_mul_i32 s36, s36, 6144
    s_add_u32 s36, s36, 4096
    v_add_u32 v12, s36, v1
    s_mul_i32 s40, s28, 72
    s_lshl_b32 s36, s30, 3
    s_add_u32 s40, s40, s36
    s_lshl_b32 s40, s40, 10
    s_add_u32 s40, s40, 34357248
    s_add_u32 s41, s40, 36864
    s_lshl_b32 s42, s28, 6
    s_add_u32 s42, s42, s36
    s_lshl_b32 s42, s42, 7
    s_add_u32 s42, s42, 36716544
    s_add_u32 s43, s42, 4096
    s_cmp_lg_u32 s3, 11
    s_cbranch_scc1 LC_no
    s_lshl_b32 s36, s28, 8
    s_add_u32 s36, s36, 36978688
    s_mov_b32 s50, s36
    v_and_b32 v3, 1, v0
    v_lshlrev_b32 v3, 7, v3
    s_mov_b32 s51, 0x40000
LC_pollO:
    buffer_load_dword v2, v3, s[16:19], s50 offen sc1
    s_waitcnt vmcnt(0)
    v_readfirstlane_b32 s52, v2
    v_readlane_b32 s53, v2, 1
    s_nop 0
    s_min_u32 s52, s52, s53
    s_cmp_ge_u32 s52, 32
    s_cbranch_scc1 LC_pdO
    s_sub_u32 s51, s51, 1
    s_cmp_lg_u32 s51, 0
    s_cbranch_scc1 LC_pollO
LC_pdO:
    buffer_load_dwordx4 v[124:127], v1, s[16:19], s35 offen sc1
    s_add_u32 s35, s35, 12288
    buffer_load_dwordx4 v[128:131], v1, s[16:19], s35 offen sc1
    s_add_u32 s35, s35, 12288
    buffer_load_dwordx4 v[132:135], v1, s[16:19], s35 offen sc1
    s_add_u32 s35, s35, 12288
    buffer_load_dwordx4 v[136:139], v1, s[16:19], s35 offen sc1
    s_add_u32 s35, s35, 12288
    buffer_load_dwordx4 v[140:143], v1, s[16:19], s35 offen sc1
    buffer_load_dwordx4 v[164:167], v6, s[20:23], s37 offen
LC_no:
    s_waitcnt lgkmcnt(0)
    s_barrier
    buffer_load_dwordx4 v[52:55], v1, s[16:19], s40 offen offset:0 sc1
    buffer_load_dwordx4 v[56:59], v1, s[16:19], s41 offen offset:0 sc1
    buffer_load_dwordx4 v[60:63], v1, s[16:19], s40 offen offset:1024 sc1
    buffer_load_dwordx4 v[64:67], v1, s[16:19], s41 offen offset:1024 sc1
    buffer_load_dwordx4 v[68:71], v1, s[16:19], s40 offen offset:2048 sc1
    buffer_load_dwordx4 v[72:75], v1, s[16:19], s41 offen offset:2048 sc1
    buffer_load_dwordx4 v[76:79], v1, s[16:19], s40 offen offset:3072 sc1
    buffer_load_dwordx4 v[80:83], v1, s[16:19], s41 offen offset:3072 sc1
    s_add_u32 s40, s40, 4096
    buffer_load_dwordx4 v[84:87], v1, s[16:19], s40 offen offset:0 sc1
    s_add_u32 s41, s41, 4096
    buffer_load_dwordx4 v[88:91], v1, s[16:19], s41 offen offset:0 sc1
    buffer_load_dwordx4 v[92:95], v1, s[16:19], s40 offen offset:1024 sc1
    buffer_load_dwordx4 v[96:99], v1, s[16:19], s41 offen offset:1024 sc1
    buffer_load_dwordx4 v[100:103], v1, s[16:19], s40 offen offset:2048 sc1
    buffer_load_dwordx4 v[104:107], v1, s[16:19], s41 offen offset:2048 sc1
    buffer_load_dwordx4 v[108:111], v1, s[16:19], s40 offen offset:3072 sc1
    buffer_load_dwordx4 v[112:115], v1, s[16:19], s41 offen offset:3072 sc1
    buffer_load_dword v116, v5, s[16:19], s42 offen offset:0 sc1
    buffer_load_dword v117, v5, s[16:19], s42 offen offset:128 sc1
    buffer_load_dword v118, v5, s[16:19], s42 offen offset:256 sc1
    buffer_load_dword v119, v5, s[16:19], s42 offen offset:384 sc1
    buffer_load_dword v120, v5, s[16:19], s43 offen offset:0 sc1
    buffer_load_dword v121, v5, s[16:19], s43 offen offset:128 sc1
    buffer_load_dword v122, v5, s[16:19], s43 offen offset:256 sc1
    buffer_load_dword v123, v5, s[16:19], s43 offen offset:384 sc1
    s_waitcnt vmcnt(29)
    v_lshlrev_b32 v156, 16, v124
    v_and_b32 v157, 0xffff0000, v124
    v_lshlrev_b32 v158, 16, v125
    v_and_b32 v159, 0xffff0000, v125
    v_lshlrev_b32 v160, 16, v126
    v_and_b32 v161, 0xffff0000, v126
    v_lshlrev_b32 v162, 16, v127
    v_and_b32 v163, 0xffff0000, v127
    s_waitcnt vmcnt(28)
    v_lshlrev_b32 v144, 16, v128
    v_and_b32 v145, 0xffff0000, v128
    v_lshlrev_b32 v146, 16, v129
    v_and_b32 v147, 0xffff0000, v129
    v_lshlrev_b32 v148, 16, v130
    v_and_b32 v149, 0xffff0000, v130
    v_lshlrev_b32 v150, 16, v131
    v_and_b32 v151, 0xffff0000, v131
    v_pk_add_f32 v[156:157], v[156:157], v[144:145]
    v_pk_add_f32 v[158:159], v[158:159], v[146:147]
    v_pk_add_f32 v[160:161], v[160:161], v[148:149]
    v_pk_add_f32 v[162:163], v[162:163], v[150:151]
    s_waitcnt vmcnt(27)
    v_lshlrev_b32 v144, 16, v132
    v_and_b32 v145, 0xffff0000, v132
    v_lshlrev_b32 v146, 16, v133
    v_and_b32 v147, 0xffff0000, v133
    v_lshlrev_b32 v148, 16, v134
    v_and_b32 v149, 0xffff0000, v134
    v_lshlrev_b32 v150, 16, v135
    v_and_b32 v151, 0xffff0000, v135
    v_pk_add_f32 v[156:157], v[156:157], v[144:145]
    v_pk_add_f32 v[158:159], v[158:159], v[146:147]
    v_pk_add_f32 v[160:161], v[160:161], v[148:149]
    v_pk_add_f32 v[162:163], v[162:163], v[150:151]
    s_waitcnt vmcnt(26)
    v_lshlrev_b32 v144, 16, v136
    v_and_b32 v145, 0xffff0000, v136
    v_lshlrev_b32 v146, 16, v137
    v_and_b32 v147, 0xffff0000, v137
    v_lshlrev_b32 v148, 16, v138
    v_and_b32 v149, 0xffff0000, v138
    v_lshlrev_b32 v150, 16, v139
    v_and_b32 v151, 0xffff0000, v139
    v_pk_add_f32 v[156:157], v[156:157], v[144:145]
    v_pk_add_f32 v[158:159], v[158:159], v[146:147]
    v_pk_add_f32 v[160:161], v[160:161], v[148:149]
    v_pk_add_f32 v[162:163], v[162:163], v[150:151]
    s_waitcnt vmcnt(25)
    v_lshlrev_b32 v144, 16, v140
    v_and_b32 v145, 0xffff0000, v140
    v_lshlrev_b32 v146, 16, v141
    v_and_b32 v147, 0xffff0000, v141
    v_lshlrev_b32 v148, 16, v142
    v_and_b32 v149, 0xffff0000, v142
    v_lshlrev_b32 v150, 16, v143
    v_and_b32 v151, 0xffff0000, v143
    v_pk_add_f32 v[156:157], v[156:157], v[144:145]
    v_pk_add_f32 v[158:159], v[158:159], v[146:147]
    v_pk_add_f32 v[160:161], v[160:161], v[148:149]
    v_pk_add_f32 v[162:163], v[162:163], v[150:151]
    v_mul_f32 v144, 0xbfb8aa3b, v156
    v_mul_f32 v145, 0xbfb8aa3b, v157
    v_mul_f32 v146, 0xbfb8aa3b, v158
    v_mul_f32 v147, 0xbfb8aa3b, v159
    v_mul_f32 v148, 0xbfb8aa3b, v160
    v_mul_f32 v149, 0xbfb8aa3b, v161
    v_mul_f32 v150, 0xbfb8aa3b, v162
    v_mul_f32 v151, 0xbfb8aa3b, v163
    v_exp_f32 v144, v144
    v_exp_f32 v145, v145
    v_exp_f32 v146, v146
    v_exp_f32 v147, v147
    v_exp_f32 v148, v148
    v_exp_f32 v149, v149
    v_exp_f32 v150, v150
    v_exp_f32 v151, v151
    v_pk_add_f32 v[144:145], v[144:145], 1.0 op_sel_hi:[1,0]
    v_pk_add_f32 v[146:147], v[146:147], 1.0 op_sel_hi:[1,0]
    v_pk_add_f32 v[148:149], v[148:149], 1.0 op_sel_hi:[1,0]
    v_pk_add_f32 v[150:151], v[150:151], 1.0 op_sel_hi:[1,0]
    v_rcp_f32 v144, v144
    v_rcp_f32 v145, v145
    v_rcp_f32 v146, v146
    v_rcp_f32 v147, v147
    v_rcp_f32 v148, v148
    v_rcp_f32 v149, v149
    v_rcp_f32 v150, v150
    v_rcp_f32 v151, v151
    v_pk_mul_f32 v[156:157], v[156:157], v[144:145]
    v_pk_mul_f32 v[158:159], v[158:159], v[146:147]
    v_pk_mul_f32 v[160:161], v[160:161], v[148:149]
    v_pk_mul_f32 v[162:163], v[162:163], v[150:151]
    s_waitcnt vmcnt(22)
    v_mfma_f32_32x32x16_bf16 v[124:139], v[16:19], v[52:55], 0
    v_mfma_f32_32x32x16_bf16 v[140:155], v[16:19], v[56:59], 0
    s_waitcnt vmcnt(20)
    v_mfma_f32_32x32x16_bf16 v[124:139], v[20:23], v[60:63], v[124:139]
    v_mfma_f32_32x32x16_bf16 v[140:155], v[20:23], v[64:67], v[140:155]
    s_waitcnt vmcnt(18)
    v_mfma_f32_32x32x16_bf16 v[124:139], v[24:27], v[68:71], v[124:139]
    v_mfma_f32_32x32x16_bf16 v[140:155], v[24:27], v[72:75], v[140:155]
    s_waitcnt vmcnt(16)
    v_mfma_f32_32x32x16_bf16 v[124:139], v[28:31], v[76:79], v[124:139]
    v_mfma_f32_32x32x16_bf16 v[140:155], v[28:31], v[80:83], v[140:155]
    s_waitcnt vmcnt(14)
    v_mfma_f32_32x32x16_bf16 v[124:139], v[32:35], v[84:87], v[124:139]
    v_mfma_f32_32x32x16_bf16 v[140:155], v[32:35], v[88:91], v[140:155]
    s_waitcnt vmcnt(12)
    v_mfma_f32_32x32x16_bf16 v[124:139], v[36:39], v[92:95], v[124:139]
    v_mfma_f32_32x32x16_bf16 v[140:155], v[36:39], v[96:99], v[140:155]
    s_waitcnt vmcnt(10)
    v_mfma_f32_32x32x16_bf16 v[124:139], v[40:43], v[100:103], v[124:139]
    v_mfma_f32_32x32x16_bf16 v[140:155], v[40:43], v[104:107], v[140:155]
    s_waitcnt vmcnt(8)
    v_mfma_f32_32x32x16_bf16 v[124:139], v[44:47], v[108:111], v[124:139]
    v_mfma_f32_32x32x16_bf16 v[140:155], v[44:47], v[112:115], v[140:155]
    s_waitcnt vmcnt(0)
    v_mfma_f32_32x32x16_bf16 v[124:139], v[48:51], v[116:119], v[124:139]
    v_mfma_f32_32x32x16_bf16 v[140:155], v[48:51], v[120:123], v[140:155]
    s_nop 10
    ds_write_b128 v10, v[128:131] offset:0
    ds_write_b128 v11, v[132:135] offset:0
    ds_write_b128 v12, v[136:139] offset:0
    ds_write_b128 v10, v[144:147] offset:1024
    ds_write_b128 v11, v[148:151] offset:1024
    ds_write_b128 v12, v[152:155] offset:1024
    v_lshlrev_b32 v16, 16, v164
    v_and_b32 v17, 0xffff0000, v164
    v_lshlrev_b32 v18, 16, v165
    v_and_b32 v19, 0xffff0000, v165
    v_lshlrev_b32 v20, 16, v166
    v_and_b32 v21, 0xffff0000, v166
    v_lshlrev_b32 v22, 16, v167
    v_and_b32 v23, 0xffff0000, v167
    s_waitcnt lgkmcnt(0)
    s_barrier
    ds_read_b128 v[128:131], v9 offset:0
    ds_read_b128 v[132:135], v9 offset:2048
    ds_read_b128 v[136:139], v9 offset:4096
    ds_read_b128 v[144:147], v9 offset:1024
    ds_read_b128 v[148:151], v9 offset:3072
    ds_read_b128 v[152:155], v9 offset:5120
    s_waitcnt lgkmcnt(3)
    v_pk_add_f32 v[124:125], v[124:125], v[128:129]
    v_pk_add_f32 v[126:127], v[126:127], v[130:131]
    v_pk_add_f32 v[132:133], v[132:133], v[136:137]
    v_pk_add_f32 v[134:135], v[134:135], v[138:139]
    v_pk_add_f32 v[124:125], v[124:125], v[132:133]
    v_pk_add_f32 v[126:127], v[126:127], v[134:135]
    v_pk_mul_f32 v[124:125], v[124:125], v[156:157]
    v_pk_mul_f32 v[126:127], v[126:127], v[158:159]
    v_cvt_pk_bf16_f32 v124, v124, v125
    v_cvt_pk_bf16_f32 v125, v126, v127
    ds_write_b64 v8, v[124:125] offset:0
    s_waitcnt lgkmcnt(1)
    v_pk_add_f32 v[140:141], v[140:141], v[144:145]
    v_pk_add_f32 v[142:143], v[142:143], v[146:147]
    v_pk_add_f32 v[148:149], v[148:149], v[152:153]
    v_pk_add_f32 v[150:151], v[150:151], v[154:155]
    v_pk_add_f32 v[140:141], v[140:141], v[148:149]
    v_pk_add_f32 v[142:143], v[142:143], v[150:151]
    v_pk_mul_f32 v[140:141], v[140:141], v[160:161]
    v_pk_mul_f32 v[142:143], v[142:143], v[162:163]
    v_cvt_pk_bf16_f32 v140, v140, v141
    v_cvt_pk_bf16_f32 v141, v142, v143
    ds_write_b64 v8, v[140:141] offset:6656
    s_waitcnt lgkmcnt(0)
    s_barrier
    ds_read_b128 v[52:55], v7
    s_waitcnt lgkmcnt(0)
    v_lshlrev_b32 v56, 16, v52
    v_and_b32 v57, 0xffff0000, v52
    v_lshlrev_b32 v58, 16, v53
    v_and_b32 v59, 0xffff0000, v53
    v_lshlrev_b32 v60, 16, v54
    v_and_b32 v61, 0xffff0000, v54
    v_lshlrev_b32 v62, 16, v55
    v_and_b32 v63, 0xffff0000, v55
    v_pk_add_f32 v[16:17], v[16:17], v[56:57]
    v_pk_add_f32 v[18:19], v[18:19], v[58:59]
    v_pk_add_f32 v[20:21], v[20:21], v[60:61]
    v_pk_add_f32 v[22:23], v[22:23], v[62:63]
    v_cvt_pk_bf16_f32 v164, v16, v17
    v_cvt_pk_bf16_f32 v165, v18, v19
    v_cvt_pk_bf16_f32 v166, v20, v21
    v_cvt_pk_bf16_f32 v167, v22, v23
    buffer_store_dwordx4 v[164:167], v6, s[24:27], s37 offen
    s_branch LC_end
LC_nod:
LC_end:
    s_endpgm
.section .rodata,"a"
.p2align 6
.amdhsa_kernel gemm1_kernel
  .amdhsa_next_free_vgpr 256
  .amdhsa_next_free_sgpr 102
  .amdhsa_accum_offset 112
  .amdhsa_group_segment_fixed_size 0
  .amdhsa_kernarg_size 80
  .amdhsa_user_sgpr_count 2
  .amdhsa_user_sgpr_kernarg_segment_ptr 1
  .amdhsa_system_sgpr_workgroup_id_x 1
  .amdhsa_float_denorm_mode_32 3
.end_amdhsa_kernel
.section .rodata,"a"
.p2align 6
.amdhsa_kernel attn_down_kernel
  .amdhsa_next_free_vgpr 168
  .amdhsa_next_free_sgpr 102
  .amdhsa_accum_offset 168
  .amdhsa_group_segment_fixed_size 0
  .amdhsa_kernarg_size 80
  .amdhsa_user_sgpr_count 2
  .amdhsa_user_sgpr_kernarg_segment_ptr 1
  .amdhsa_system_sgpr_workgroup_id_x 1
  .amdhsa_float_denorm_mode_32 3
.end_amdhsa_kernel
```
